```python
import torch

def _softmax(x, axis=-1):
    return torch.softmax(x, dim=axis)
def _gelu(x):
    return torch.nn.functional.gelu(x, approximate="tanh")
def _silu(x):
    return torch.nn.functional.silu(x)
def _sigmoid(x):
    return torch.sigmoid(x)
def _layernorm(x, axis=-1, eps=1e-5):
    m = x.mean(dim=axis, keepdim=True)
    v = x.var(dim=axis, keepdim=True, unbiased=False)
    return (x - m) / torch.sqrt(v + eps)
def _scatter_add(tgt, idx, src, axis=0):
    return tgt.clone().index_add_(axis, idx, src)
def _segment_sum(src, seg, n):
    out = torch.zeros((n,) + src.shape[1:], dtype=src.dtype)
    return out.index_add_(0, seg, src)
def _pad(x, pw):
    flat = tuple(v for pair in reversed(pw) for v in pair)
    return torch.nn.functional.pad(x, flat)

kernel_name = 'interleave_layers__sliding_block__linear_kernel_hedgehog__prompt'

def setup_inputs():

    _w = (lambda a: (lambda t: t.to(torch.bfloat16) if t.is_floating_point() else t)(torch.as_tensor(a)))
    def _A_setup():
        B, S, D = 1, 2048, 512
        return {
            "x": _w((lambda *s: torch.randn(*s, dtype=torch.bfloat16) * 0.05)(B, S, D)),
            "wqkv": _w((lambda *s: torch.randn(*s, dtype=torch.bfloat16) * 0.05)(D, 3 * D)),
            "wo": _w((lambda *s: torch.randn(*s, dtype=torch.bfloat16) * 0.05)(D, D)),
        }
    _A_in = _A_setup()

    def _B_setup():
        B, S, D, H = 1, 2048, 512, 32
        Dh = D // H
        return {
            "x": _w((lambda *s: torch.randn(*s, dtype=torch.bfloat16) * 0.05)(B, S, D)),
            "wqkv": _w((lambda *s: torch.randn(*s, dtype=torch.bfloat16) * 0.4)(D, 3 * D)),
            "w_phi": _w((lambda *s: torch.randn(*s, dtype=torch.bfloat16) * 0.4)(H, Dh, Dh) * (Dh ** -0.5)),
            "wo": _w((lambda *s: torch.randn(*s, dtype=torch.bfloat16) * 0.05)(D, D)),
        }
    _B_in = _B_setup()

    return {
        "A_x": _A_in["x"],
        "A_wqkv": _A_in["wqkv"],
        "A_wo": _A_in["wo"],
        "B_x": _B_in["x"],
        "B_wqkv": _B_in["wqkv"],
        "B_w_phi": _B_in["w_phi"],
        "B_wo": _B_in["wo"],
    }

def reference(A_x, A_wqkv, A_wo, B_x, B_wqkv, B_w_phi, B_wo):
    def _A_ref(x, wqkv, wo):
        B, S, D = x.shape
        H = 32; Dh = D // H; W = 256
        qkv = (lambda x, *d: x.permute(*d))((x @ wqkv).reshape(B, S, 3, H, Dh), 2, 0, 3, 1, 4)
        q, k, v = qkv[0], qkv[1], qkv[2]
        scores = torch.einsum("bhqd,bhkd->bhqk", q, k) * (Dh ** -0.5)
        idx = torch.arange(S)
        mask = (idx[:, None] - idx[None, :] >= 0) & (idx[:, None] - idx[None, :] < W)
        scores = torch.where(mask[None, None], scores, -1e9)
        p = _softmax(scores, axis=-1)
        o = torch.einsum("bhqk,bhkd->bhqd", p, v)
        return (lambda x, *d: x.permute(*d))(o, 0, 2, 1, 3).reshape(B, S, D) @ wo

    def _B_ref(x, wqkv, w_phi, wo):
        B, S, D = x.shape
        H = 32; Dh = D // H
        qkv = (lambda x, *d: x.permute(*d))((x @ wqkv).reshape(B, S, 3, H, Dh), 2, 0, 3, 1, 4)
        q, k, v = qkv[0], qkv[1], qkv[2]
        pq = torch.einsum("bhsd,hdf->bhsf", q, w_phi)
        pk = torch.einsum("bhsd,hdf->bhsf", k, w_phi)
        phi_q = torch.concatenate([_softmax(pq, axis=-1), _softmax(-pq, axis=-1)], axis=-1)
        phi_k = torch.concatenate([_softmax(pk, axis=-1), _softmax(-pk, axis=-1)], axis=-1)
        kv = torch.einsum("bhsf,bhsd->bhfd", phi_k, v)
        z  = torch.einsum("bhsf->bhf", phi_k)
        num = torch.einsum("bhqf,bhfd->bhqd", phi_q, kv)
        den = torch.einsum("bhqf,bhf->bhq", phi_q, z)[..., None] + 1e-6
        o = num / den
        return (lambda x, *d: x.permute(*d))(o, 0, 2, 1, 3).reshape(B, S, D) @ wo

    x = A_x
    x = x + _A_ref(_layernorm(x, axis=-1), A_wqkv, A_wo)
    x = x + _B_ref(_layernorm(x, axis=-1), B_wqkv, B_w_phi, B_wo)
    x = x + _A_ref(_layernorm(x, axis=-1), A_wqkv, A_wo)
    x = x + _B_ref(_layernorm(x, axis=-1), B_wqkv, B_w_phi, B_wo)
    return x
```

```asm
; @launch grid=(256,1,1) block=(512,1,1) lds=163536
.amdgcn_target "amdgcn-amd-amdhsa--gfx950"
.text
.globl interleave_layers__sliding_block__linear_kernel_hedgehog__prompt_kernel
.p2align 8
.type interleave_layers__sliding_block__linear_kernel_hedgehog__prompt_kernel,@function
interleave_layers__sliding_block__linear_kernel_hedgehog__prompt_kernel:
    s_cmp_ge_u32 s2, 256
    s_cbranch_scc1 L_end
    s_load_dwordx16 s[64:79], s[0:1], 0
    s_load_dwordx4 s[80:83], s[0:1], 64
    s_getpc_b64 s[84:85]
    v_lshrrev_b32 v1, 6, v0
    s_lshr_b32 s47, s2, 3
    v_readfirstlane_b32 s38, v1
    v_and_b32 v1, 63, v0
    v_lshlrev_b32 v2, 4, v1
    s_cmp_lt_u32 s38, 6
    s_cbranch_scc1 Lx_1
    s_and_b32 s46, s38, 1
    s_lshl_b32 s46, s46, 5
    s_add_u32 s46, s46, s47
    s_lshl_b32 s46, s46, 10
    s_cmp_ge_u32 s46, (L_end - interleave_layers__sliding_block__linear_kernel_hedgehog__prompt_kernel - 1088)
    s_cbranch_scc1 Lx_1
    v_add_u32 v254, s46, v2
    v_mov_b32 v255, s85
    v_add_co_u32 v254, vcc, s84, v254
    s_nop 1
    v_addc_co_u32 v255, vcc, 0, v255, vcc
    global_load_dword v253, v[254:255], off
Lx_1:
    s_and_b32 s46, s2, 7
    s_add_u32 s37, s47, 0
    s_and_b32 s37, s37, 15
    s_lshr_b32 s47, s47, 4
    s_lshl_b32 s36, s46, 1
    s_add_u32 s36, s36, s47
    s_and_b32 s39, s38, 3
    s_lshr_b32 s40, s38, 2
    s_lshl_b32 s41, s36, 2
    s_add_u32 s41, s41, s39
    s_add_u32 s3, s46, s47
    s_lshl_b32 s47, s37, 1
    s_add_u32 s3, s3, s47
    s_and_b32 s3, s3, 3
    s_lshr_b32 s58, s37, 1
    s_lshl1_add_u32 s58, s3, s58
    s_and_b32 s58, s58, 7
    v_mov_b32 v8, 0
    v_mov_b32 v9, 0
    v_mov_b32 v10, 0
    v_mov_b32 v11, 0
    v_mov_b32 v90, 0
    v_mov_b32 v24, 0
    v_mov_b32 v91, 0
    v_mov_b32 v93, 0
    v_mov_b32 v4, 161424
    ds_write_b128 v4, v[8:11]
    ds_write_b128 v4, v[8:11] offset:16
    ds_write_b128 v4, v[8:11] offset:32
    v_lshrrev_b32 v28, 3, v1
    v_lshlrev_b32 v28, 10, v28
    v_lshrrev_b32 v29, 4, v1
    v_xor_b32 v29, v29, v1
    v_and_b32 v29, 7, v29
    v_lshl_add_u32 v28, v29, 4, v28
    v_xor_b32 v29, 64, v28
    v_add_u32 v30, 14336, v28
    v_add_u32 v31, 21504, v29
    v_add_u32 v29, 7168, v29
    s_lshl_b32 s89, s41, 15
    s_lshl_b32 s90, s58, 7
    s_mul_i32 s86, s39, 16384
    s_add_u32 s86, s86, 65536
    s_waitcnt lgkmcnt(0)
    s_load_dword s43, s[82:83], 0
    s_mov_b32 s8, s64
    s_and_b32 s9, s65, 0xffff
    s_mov_b32 s10, 2097152
    s_mov_b32 s11, 0x20000
    s_cmp_lg_u32 s40, 0
    s_cbranch_scc1 L_pro1
    s_add_u32 m0, s86, 0
    s_add_u32 s49, s89, s90
    buffer_load_dwordx4 v28, s[8:11], s49 offen offset:0 lds
    buffer_load_dwordx4 v29, s[8:11], s49 offen offset:1024 lds
    buffer_load_dwordx4 v30, s[8:11], s49 offen offset:2048 lds
    buffer_load_dwordx4 v31, s[8:11], s49 offen offset:3072 lds
    s_add_u32 s90, s90, 128
    s_and_b32 s90, s90, 0x3ff
    s_add_u32 m0, s86, 4096
    s_add_u32 s49, s89, s90
    buffer_load_dwordx4 v28, s[8:11], s49 offen offset:0 lds
    buffer_load_dwordx4 v29, s[8:11], s49 offen offset:1024 lds
    buffer_load_dwordx4 v30, s[8:11], s49 offen offset:2048 lds
    buffer_load_dwordx4 v31, s[8:11], s49 offen offset:3072 lds
    s_add_u32 s90, s90, 128
    s_and_b32 s90, s90, 0x3ff
L_pro1:
L_pro2:
    s_barrier
    s_mov_b32 s4, s82
    s_and_b32 s5, s83, 0xffff
    s_mov_b32 s6, 33554432
    s_mov_b32 s7, 0x20000
    s_mov_b32 s12, s66
    s_and_b32 s13, s67, 0xffff
    s_mov_b32 s14, 1572864
    s_mov_b32 s15, 0x20000
    s_mov_b32 s16, s68
    s_and_b32 s17, s69, 0xffff
    s_mov_b32 s18, 524288
    s_mov_b32 s19, 0x20000
    s_mov_b32 s20, s72
    s_and_b32 s21, s73, 0xffff
    s_mov_b32 s22, 1572864
    s_mov_b32 s23, 0x20000
    s_mov_b32 s28, s74
    s_and_b32 s29, s75, 0xffff
    s_mov_b32 s30, 16384
    s_mov_b32 s31, 0x20000
    s_mov_b32 s24, s76
    s_and_b32 s25, s77, 0xffff
    s_mov_b32 s26, 524288
    s_mov_b32 s27, 0x20000
    s_mov_b32 s32, s78
    s_and_b32 s33, s79, 0xffff
    s_mov_b32 s34, 2097152
    s_mov_b32 s35, 0x20000
    s_mul_i32 s46, s40, 3
    s_xor_b32 s42, s39, s46
    s_mov_b32 s45, 0x100000
    s_mov_b32 s50, 0xffff
    s_mov_b32 s51, 0xffff
    s_mov_b32 s60, -1
    s_mov_b32 s61, 0
    s_mov_b32 s44, 0
    s_mov_b32 s59, 0
    s_mov_b32 s55, 0x3fb8aa3b
    s_mov_b32 s63, 0x07060302
    s_lshl_b32 s3, s3, 13
    s_getreg_b32 s52, hwreg(HW_REG_XCC_ID, 0, 4)
    v_lshrrev_b32 v64, 5, v1
    v_and_b32 v65, 31, v1
    v_lshlrev_b32 v3, 2, v1
    v_mov_b32 v7, 0
    v_bfe_u32 v5, v1, 2, 2
    v_lshl_add_u32 v5, v64, 2, v5
    v_lshlrev_b32 v6, 6, v5
    v_bfe_u32 v5, v1, 4, 1
    v_lshl_add_u32 v6, v5, 5, v6
    v_and_b32 v5, 3, v1
    v_lshl_add_u32 v6, v5, 3, v6
    v_lshl_add_u32 v5, v64, 8, v6
    v_add_u32 v5, 65536, v5
    v_add_u32 v6, 98304, v6
    s_lshl_b32 s46, s39, 7
    s_add_u32 s46, s46, 158720
    v_lshl_add_u32 v25, v65, 2, s46
    v_lshl_add_u32 v26, v64, 4, s46
    v_lshlrev_b32 v27, 2, v64
    v_sub_u32 v27, v65, v27
    v_cvt_f32_i32 v27, v27
    v_mul_f32 v27, 0x71800000, v27
    s_waitcnt lgkmcnt(0)
    s_and_b32 s43, s43, -16
    s_add_u32 s43, s43, 0x9e3779b0
    s_or_b32 s52, s52, s43
    s_lshl_b32 s46, s36, 2
    s_add_u32 s46, s46, s42
    s_lshl_b32 s46, s46, 5
    s_lshl_b32 s47, s37, 1
    s_add_u32 s46, s46, s47
    s_add_u32 s46, s46, s40
    s_lshl_b32 s72, s46, 10
    s_lshl_b32 s73, s46, 2
    s_lshr_b32 s46, s39, 1
    s_add_u32 s46, s46, s36
    s_sub_u32 s46, s46, 2
    s_cselect_b32 s75, 0, 1
    s_lshl_b32 s46, s46, 1
    s_and_b32 s47, s39, 1
    s_add_u32 s46, s46, s47
    s_lshl_b32 s46, s46, 5
    s_add_u32 s46, s46, s37
    s_mul_i32 s74, s46, 4480
    s_cmp_lt_u32 s42, 2
    s_cselect_b32 s75, s75, 0
    s_cmp_eq_u32 s36, 1
    s_cselect_b32 s46, 4, s42
    s_sub_u32 s77, 8, s46
    s_lshl_b32 s76, s46, 12
    s_add_u32 s76, s76, 65536
    s_mul_i32 s78, s42, 6144
    s_add_u32 s78, s78, 131072
    s_lshl_b32 s46, s41, 4
    s_add_u32 s46, s46, s37
    s_mul_i32 s79, s46, 4480
    s_lshl_b32 s80, s46, 11
    s_lshl_b32 s81, s46, 8
    s_lshl_b32 s82, s41, 7
    s_lshl_b32 s83, s41, 15
    s_cmp_eq_u32 s40, 0
    s_cbranch_scc1 L_main_0
    s_lshl_b32 s48, s36, 7
    s_lshl_b32 s49, s37, 2
    s_add_u32 s48, s48, s49
    s_add_u32 s48, s48, 4096
    s_cmp_lg_u32 s39, 0
    s_cbranch_scc1 Lx_2
    v_mov_b32 v23, s52
    s_mov_b64 exec, 1
    buffer_store_dword v23, off, s[4:7], s48 sc1
    s_mov_b64 exec, -1
Lx_2:
    s_cmp_lg_u32 s39, 1
    s_cbranch_scc1 Lx_5
    v_lshlrev_b32 v5, 10, v1
    s_lshr_b32 s46, s2, 3
    s_lshl_b32 s46, s46, 16
    s_lshl_b32 s47, s39, 8
    s_add_u32 s46, s46, s47
    s_cmp_ge_u32 s2, 192
    s_cbranch_scc1 Lx_4
    buffer_load_dword v26, v5, s[12:15], s46 offen offset:128
    s_branch Lx_5
Lx_4:
    s_sub_u32 s46, s46, 1572864
    buffer_load_dword v26, v5, s[16:19], s46 offen offset:128
Lx_5:
    v_lshrrev_b32 v28, 2, v1
    v_and_b32 v29, 3, v1
    v_lshlrev_b32 v29, 4, v29
    s_lshl_b32 s46, s37, 6
    v_add_u32 v29, s46, v29
    v_mul_u32_u24 v8, 3072, v28
    v_add_u32 v8, v8, v29
    v_lshl_add_u32 v9, v28, 10, v29
    s_lshl_b32 s86, s39, 11
    s_lshr_b32 s46, s39, 1
    s_add_u32 s46, s46, s58
    s_and_b32 s46, s46, 7
    s_lshl_b32 s62, s46, 16
    s_xor_b32 s46, s39, s37
    s_and_b32 s46, s46, 1
    s_lshl_b32 s46, s46, 15
    s_add_u32 s62, s62, s46
    v_add_u32 v10, s86, v2
    v_subrev_u32 v11, 98304, v6
    v_add_u32 v11, s86, v11
    v_lshl_add_u32 v31, v64, 8, v11
    v_mov_b32 v12, 0x3f803f80
    v_mov_b32 v13, 0x3f803f80
    v_mov_b32 v14, 0x3f803f80
    v_mov_b32 v15, 0x3f803f80
    v_lshlrev_b32 v30, 10, v64
    v_add_u32 v30, 161472, v30
    ds_write_b128 v30, v[12:15]
    s_lshl_b32 s46, s39, 2
    s_add_u32 s46, s46, 155648
    v_and_b32 v28, 31, v1
    v_lshl_add_u32 v28, v28, 4, s46
    v_lshl_add_u32 v30, v64, 9, v28
    v_mov_b32 v88, 0x3f803f80
    v_mov_b32 v89, v88
    v_mov_b32 v90, v88
    v_mov_b32 v91, v88
    v_mov_b32 v92, v88
    v_mov_b32 v93, v88
    v_mov_b32 v94, v88
    v_mov_b32 v95, v88
    v_subrev_f32 v96, 0x0, v27
    v_subrev_f32 v97, 0x71800000, v27
    v_subrev_f32 v98, 0x72000000, v27
    v_subrev_f32 v99, 0x72400000, v27
    v_subrev_f32 v100, 0x73000000, v27
    v_subrev_f32 v101, 0x73100000, v27
    v_subrev_f32 v102, 0x73200000, v27
    v_subrev_f32 v103, 0x73300000, v27
    v_subrev_f32 v104, 0x73800000, v27
    v_subrev_f32 v105, 0x73880000, v27
    v_subrev_f32 v106, 0x73900000, v27
    v_subrev_f32 v107, 0x73980000, v27
    v_subrev_f32 v108, 0x73c00000, v27
    v_subrev_f32 v109, 0x73c80000, v27
    v_subrev_f32 v110, 0x73d00000, v27
    v_subrev_f32 v111, 0x73d80000, v27
    v_min_f32 v96, 0, v96
    v_min_f32 v97, 0, v97
    v_min_f32 v98, 0, v98
    v_min_f32 v99, 0, v99
    v_min_f32 v100, 0, v100
    v_min_f32 v101, 0, v101
    v_min_f32 v102, 0, v102
    v_min_f32 v103, 0, v103
    v_min_f32 v104, 0, v104
    v_min_f32 v105, 0, v105
    v_min_f32 v106, 0, v106
    v_min_f32 v107, 0, v107
    v_min_f32 v108, 0, v108
    v_min_f32 v109, 0, v109
    v_min_f32 v110, 0, v110
    v_min_f32 v111, 0, v111
    v_mov_b32 v48, 0
    v_mov_b32 v49, 0
    v_mov_b32 v50, 0
    v_mov_b32 v51, 0
    v_mov_b32 v52, 0
    v_mov_b32 v53, 0
    v_mov_b32 v54, 0
    v_mov_b32 v55, 0
    v_mov_b32 v56, 0
    v_mov_b32 v57, 0
    v_mov_b32 v58, 0
    v_mov_b32 v59, 0
    v_mov_b32 v60, 0
    v_mov_b32 v61, 0
    v_mov_b32 v62, 0
    v_mov_b32 v63, 0
    v_sub_f32 v112, 0xf1800000, v27
    v_sub_f32 v113, 0x0, v27
    v_sub_f32 v114, 0x71800000, v27
    v_sub_f32 v115, 0x72000000, v27
    v_sub_f32 v116, 0x72e00000, v27
    v_sub_f32 v117, 0x73000000, v27
    v_sub_f32 v118, 0x73100000, v27
    v_sub_f32 v119, 0x73200000, v27
    v_sub_f32 v120, 0x73700000, v27
    v_sub_f32 v121, 0x73800000, v27
    v_sub_f32 v122, 0x73880000, v27
    v_sub_f32 v123, 0x73900000, v27
    v_sub_f32 v124, 0x73b80000, v27
    v_sub_f32 v125, 0x73c00000, v27
    v_sub_f32 v126, 0x73c80000, v27
    v_sub_f32 v127, 0x73d00000, v27
    v_min_f32 v112, 0, v112
    v_min_f32 v113, 0, v113
    v_min_f32 v114, 0, v114
    v_min_f32 v115, 0, v115
    v_min_f32 v116, 0, v116
    v_min_f32 v117, 0, v117
    v_min_f32 v118, 0, v118
    v_min_f32 v119, 0, v119
    v_min_f32 v120, 0, v120
    v_min_f32 v121, 0, v121
    v_min_f32 v122, 0, v122
    v_min_f32 v123, 0, v123
    v_min_f32 v124, 0, v124
    v_min_f32 v125, 0, v125
    v_min_f32 v126, 0, v126
    v_min_f32 v127, 0, v127
Llw_6:
    ds_read_b32 v23, v4 offset:20
    s_waitcnt lgkmcnt(0)
    v_cmp_gt_u32 vcc, 2, v23
    s_cbranch_vccnz Llw_6
    s_add_u32 s46, s62, 0
    s_and_b32 s46, s46, 0x7ffff
    s_mul_i32 s46, s46, 3
    s_add_u32 m0, s86, 0
    s_add_u32 s47, s46, 1024
    buffer_load_dwordx4 v8, s[12:15], s47 offen lds
    s_add_u32 m0, s86, 32768
    s_add_u32 s47, s46, 2048
    buffer_load_dwordx4 v8, s[12:15], s47 offen lds
    s_add_u32 m0, s86, 1024
    s_add_u32 s47, s46, 50176
    buffer_load_dwordx4 v8, s[12:15], s47 offen lds
    s_add_u32 m0, s86, 33792
    s_add_u32 s47, s46, 51200
    buffer_load_dwordx4 v8, s[12:15], s47 offen lds
    s_add_u32 s46, s62, 131072
    s_and_b32 s46, s46, 0x7ffff
    s_mul_i32 s46, s46, 3
    s_add_u32 m0, s86, 8192
    s_add_u32 s47, s46, 1024
    buffer_load_dwordx4 v8, s[12:15], s47 offen lds
    s_add_u32 m0, s86, 40960
    s_add_u32 s47, s46, 2048
    buffer_load_dwordx4 v8, s[12:15], s47 offen lds
    s_add_u32 m0, s86, 9216
    s_add_u32 s47, s46, 50176
    buffer_load_dwordx4 v8, s[12:15], s47 offen lds
    s_add_u32 m0, s86, 41984
    s_add_u32 s47, s46, 51200
    buffer_load_dwordx4 v8, s[12:15], s47 offen lds
    s_add_u32 s46, s62, 262144
    s_and_b32 s46, s46, 0x7ffff
    s_mul_i32 s46, s46, 3
    s_add_u32 m0, s86, 16384
    s_add_u32 s47, s46, 1024
    buffer_load_dwordx4 v8, s[12:15], s47 offen lds
    s_add_u32 m0, s86, 49152
    s_add_u32 s47, s46, 2048
    buffer_load_dwordx4 v8, s[12:15], s47 offen lds
    s_add_u32 m0, s86, 17408
    s_add_u32 s47, s46, 50176
    buffer_load_dwordx4 v8, s[12:15], s47 offen lds
    s_add_u32 m0, s86, 50176
    s_add_u32 s47, s46, 51200
    buffer_load_dwordx4 v8, s[12:15], s47 offen lds
    s_waitcnt vmcnt(8)
    v_mov_b32 v23, 1
    s_mov_b64 exec, 1
    s_waitcnt lgkmcnt(0)
    ds_add_u32 v4, v23 offset:0
    s_mov_b64 exec, -1
    ds_read_b64_tr_b16 v[128:129], v31 offset:0
    ds_read_b64_tr_b16 v[130:131], v31 offset:256
    ds_read_b64_tr_b16 v[132:133], v31 offset:1024
    ds_read_b64_tr_b16 v[134:135], v31 offset:1280
    ds_read_b64_tr_b16 v[160:161], v31 offset:32768
    ds_read_b64_tr_b16 v[162:163], v31 offset:33024
    ds_read_b64_tr_b16 v[164:165], v31 offset:33792
    ds_read_b64_tr_b16 v[166:167], v31 offset:34048
    s_waitcnt lgkmcnt(6)
    v_mfma_f32_32x32x16_bf16 v[32:47], v[12:15], v[128:131], 0
    s_waitcnt lgkmcnt(4)
    v_mfma_f32_32x32x16_bf16 v[32:47], v[12:15], v[132:135], v[32:47]
    s_waitcnt lgkmcnt(2)
    v_mfma_f32_32x32x16_bf16 v[64:79], v[12:15], v[160:163], 0
    s_waitcnt lgkmcnt(0)
    v_mfma_f32_32x32x16_bf16 v[64:79], v[12:15], v[164:167], v[64:79]
    s_add_u32 s46, s62, 393216
    s_and_b32 s46, s46, 0x7ffff
    s_mul_i32 s46, s46, 3
    s_add_u32 m0, s86, 24576
    s_add_u32 s47, s46, 1024
    buffer_load_dwordx4 v8, s[12:15], s47 offen lds
    s_add_u32 m0, s86, 57344
    s_add_u32 s47, s46, 2048
    buffer_load_dwordx4 v8, s[12:15], s47 offen lds
    s_add_u32 m0, s86, 25600
    s_add_u32 s47, s46, 50176
    buffer_load_dwordx4 v8, s[12:15], s47 offen lds
    s_add_u32 m0, s86, 58368
    s_add_u32 s47, s46, 51200
    buffer_load_dwordx4 v8, s[12:15], s47 offen lds
    s_waitcnt vmcnt(8)
    v_mov_b32 v23, 1
    s_mov_b64 exec, 1
    s_waitcnt lgkmcnt(0)
    ds_add_u32 v4, v23 offset:4
    s_mov_b64 exec, -1
    ds_read_b64_tr_b16 v[136:137], v31 offset:8192
    ds_read_b64_tr_b16 v[138:139], v31 offset:8448
    ds_read_b64_tr_b16 v[140:141], v31 offset:9216
    ds_read_b64_tr_b16 v[142:143], v31 offset:9472
    ds_read_b64_tr_b16 v[168:169], v31 offset:40960
    ds_read_b64_tr_b16 v[170:171], v31 offset:41216
    ds_read_b64_tr_b16 v[172:173], v31 offset:41984
    ds_read_b64_tr_b16 v[174:175], v31 offset:42240
    s_waitcnt lgkmcnt(6)
    v_mfma_f32_32x32x16_bf16 v[32:47], v[12:15], v[136:139], v[32:47]
    s_waitcnt lgkmcnt(4)
    v_mfma_f32_32x32x16_bf16 v[32:47], v[12:15], v[140:143], v[32:47]
    s_waitcnt lgkmcnt(2)
    v_mfma_f32_32x32x16_bf16 v[64:79], v[12:15], v[168:171], v[64:79]
    s_waitcnt lgkmcnt(0)
    v_mfma_f32_32x32x16_bf16 v[64:79], v[12:15], v[172:175], v[64:79]
Llw_7:
    ds_read_b32 v23, v4 offset:16
    s_waitcnt lgkmcnt(0)
    v_cmp_gt_u32 vcc, 4, v23
    s_cbranch_vccnz Llw_7
    s_setprio 3
    s_add_u32 s46, s62, 0
    s_and_b32 s46, s46, 0x7ffff
    s_mul_i32 s46, s46, 3
    s_add_u32 m0, s86, 65536
    s_add_u32 s47, s46, 0
    buffer_load_dwordx4 v8, s[12:15], s47 offen lds
    s_add_u32 m0, s86, 66560
    s_add_u32 s47, s46, 49152
    buffer_load_dwordx4 v8, s[12:15], s47 offen lds
    s_add_u32 s46, s62, 131072
    s_and_b32 s46, s46, 0x7ffff
    s_mul_i32 s46, s46, 3
    s_add_u32 m0, s86, 73728
    s_add_u32 s47, s46, 0
    buffer_load_dwordx4 v8, s[12:15], s47 offen lds
    s_add_u32 m0, s86, 74752
    s_add_u32 s47, s46, 49152
    buffer_load_dwordx4 v8, s[12:15], s47 offen lds
    s_waitcnt vmcnt(8)
    v_mov_b32 v23, 1
    s_mov_b64 exec, 1
    s_waitcnt lgkmcnt(0)
    ds_add_u32 v4, v23 offset:8
    s_mov_b64 exec, -1
    ds_read_b64_tr_b16 v[144:145], v31 offset:16384
    ds_read_b64_tr_b16 v[146:147], v31 offset:16640
    ds_read_b64_tr_b16 v[148:149], v31 offset:17408
    ds_read_b64_tr_b16 v[150:151], v31 offset:17664
    ds_read_b64_tr_b16 v[176:177], v31 offset:49152
    ds_read_b64_tr_b16 v[178:179], v31 offset:49408
    ds_read_b64_tr_b16 v[180:181], v31 offset:50176
    ds_read_b64_tr_b16 v[182:183], v31 offset:50432
    s_waitcnt lgkmcnt(6)
    v_mfma_f32_32x32x16_bf16 v[32:47], v[12:15], v[144:147], v[32:47]
    s_waitcnt lgkmcnt(4)
    v_mfma_f32_32x32x16_bf16 v[32:47], v[12:15], v[148:151], v[32:47]
    s_waitcnt lgkmcnt(2)
    v_mfma_f32_32x32x16_bf16 v[64:79], v[12:15], v[176:179], v[64:79]
    s_waitcnt lgkmcnt(0)
    v_mfma_f32_32x32x16_bf16 v[64:79], v[12:15], v[180:183], v[64:79]
    s_add_u32 s46, s62, 262144
    s_and_b32 s46, s46, 0x7ffff
    s_mul_i32 s46, s46, 3
    s_add_u32 m0, s86, 81920
    s_add_u32 s47, s46, 0
    buffer_load_dwordx4 v8, s[12:15], s47 offen lds
    s_add_u32 m0, s86, 82944
    s_add_u32 s47, s46, 49152
    buffer_load_dwordx4 v8, s[12:15], s47 offen lds
    s_add_u32 s46, s62, 393216
    s_and_b32 s46, s46, 0x7ffff
    s_mul_i32 s46, s46, 3
    s_add_u32 m0, s86, 90112
    s_add_u32 s47, s46, 0
    buffer_load_dwordx4 v8, s[12:15], s47 offen lds
    s_add_u32 m0, s86, 91136
    s_add_u32 s47, s46, 49152
    buffer_load_dwordx4 v8, s[12:15], s47 offen lds
    s_waitcnt vmcnt(8)
    v_mov_b32 v23, 1
    s_mov_b64 exec, 1
    s_waitcnt lgkmcnt(0)
    ds_add_u32 v4, v23 offset:12
    s_mov_b64 exec, -1
    ds_read_b64_tr_b16 v[152:153], v31 offset:24576
    ds_read_b64_tr_b16 v[154:155], v31 offset:24832
    ds_read_b64_tr_b16 v[156:157], v31 offset:25600
    ds_read_b64_tr_b16 v[158:159], v31 offset:25856
    ds_read_b64_tr_b16 v[184:185], v31 offset:57344
    ds_read_b64_tr_b16 v[186:187], v31 offset:57600
    ds_read_b64_tr_b16 v[188:189], v31 offset:58368
    ds_read_b64_tr_b16 v[190:191], v31 offset:58624
    s_waitcnt lgkmcnt(6)
    v_mfma_f32_32x32x16_bf16 v[32:47], v[12:15], v[152:155], v[32:47]
    s_waitcnt lgkmcnt(4)
    v_mfma_f32_32x32x16_bf16 v[32:47], v[12:15], v[156:159], v[32:47]
    s_waitcnt lgkmcnt(2)
    v_mfma_f32_32x32x16_bf16 v[64:79], v[12:15], v[184:187], v[64:79]
    s_waitcnt lgkmcnt(0)
    v_mfma_f32_32x32x16_bf16 v[64:79], v[12:15], v[188:191], v[64:79]
    s_nop 7
    ds_write_b32 v28, v32 offset:512
    s_nop 2
    ds_write_b32 v28, v64 offset:1024
    v_mov_b32 v23, 1
    s_mov_b64 exec, 1
    ds_add_u32 v4, v23 offset:24
    s_mov_b64 exec, -1
    s_setprio 0
    s_add_u32 s46, s62, 0
    s_and_b32 s46, s46, 0x7ffff
    s_add_u32 s49, s3, 0
    s_and_b32 s49, s49, 0x7fff
    s_add_u32 s49, s49, s86
    s_add_u32 m0, s49, 98304
    s_add_u32 s47, s46, 0
    buffer_load_dwordx4 v9, s[16:19], s47 offen lds
    s_add_u32 m0, s49, 99328
    s_add_u32 s47, s46, 16384
    buffer_load_dwordx4 v9, s[16:19], s47 offen lds
    s_add_u32 s46, s62, 131072
    s_and_b32 s46, s46, 0x7ffff
    s_add_u32 s49, s3, 8192
    s_and_b32 s49, s49, 0x7fff
    s_add_u32 s49, s49, s86
    s_add_u32 m0, s49, 98304
    s_add_u32 s47, s46, 0
    buffer_load_dwordx4 v9, s[16:19], s47 offen lds
    s_add_u32 m0, s49, 99328
    s_add_u32 s47, s46, 16384
    buffer_load_dwordx4 v9, s[16:19], s47 offen lds
    s_add_u32 s46, s62, 262144
    s_and_b32 s46, s46, 0x7ffff
    s_add_u32 s49, s3, 16384
    s_and_b32 s49, s49, 0x7fff
    s_add_u32 s49, s49, s86
    s_add_u32 m0, s49, 98304
    s_add_u32 s47, s46, 0
    buffer_load_dwordx4 v9, s[16:19], s47 offen lds
    s_add_u32 m0, s49, 99328
    s_add_u32 s47, s46, 16384
    buffer_load_dwordx4 v9, s[16:19], s47 offen lds
    s_add_u32 s46, s62, 393216
    s_and_b32 s46, s46, 0x7ffff
    s_add_u32 s49, s3, 24576
    s_and_b32 s49, s49, 0x7fff
    s_add_u32 s49, s49, s86
    s_add_u32 m0, s49, 98304
    s_add_u32 s47, s46, 0
    buffer_load_dwordx4 v9, s[16:19], s47 offen lds
    s_add_u32 m0, s49, 99328
    s_add_u32 s47, s46, 16384
    buffer_load_dwordx4 v9, s[16:19], s47 offen lds
    v_add_u32 v31, 65536, v31
    s_waitcnt vmcnt(8)
    v_mov_b32 v23, 1
    s_mov_b64 exec, 1
    s_waitcnt lgkmcnt(0)
    ds_add_u32 v4, v23 offset:28
    s_mov_b64 exec, -1
    ds_read_b64_tr_b16 v[192:193], v31 offset:0
    ds_read_b64_tr_b16 v[194:195], v31 offset:256
    ds_read_b64_tr_b16 v[196:197], v31 offset:1024
    ds_read_b64_tr_b16 v[198:199], v31 offset:1280
    ds_read_b64_tr_b16 v[200:201], v31 offset:8192
    ds_read_b64_tr_b16 v[202:203], v31 offset:8448
    ds_read_b64_tr_b16 v[204:205], v31 offset:9216
    ds_read_b64_tr_b16 v[206:207], v31 offset:9472
    s_waitcnt lgkmcnt(6)
    v_mfma_f32_32x32x16_bf16 v[32:47], v[12:15], v[192:195], 0
    s_waitcnt lgkmcnt(4)
    v_mfma_f32_32x32x16_bf16 v[32:47], v[12:15], v[196:199], v[32:47]
    s_waitcnt lgkmcnt(2)
    v_mfma_f32_32x32x16_bf16 v[32:47], v[12:15], v[200:203], v[32:47]
    s_waitcnt lgkmcnt(0)
    v_mfma_f32_32x32x16_bf16 v[32:47], v[12:15], v[204:207], v[32:47]
    ds_read_b64_tr_b16 v[208:209], v31 offset:16384
    ds_read_b64_tr_b16 v[210:211], v31 offset:16640
    ds_read_b64_tr_b16 v[212:213], v31 offset:17408
    ds_read_b64_tr_b16 v[214:215], v31 offset:17664
    ds_read_b64_tr_b16 v[216:217], v31 offset:24576
    ds_read_b64_tr_b16 v[218:219], v31 offset:24832
    ds_read_b64_tr_b16 v[220:221], v31 offset:25600
    ds_read_b64_tr_b16 v[222:223], v31 offset:25856
    s_waitcnt lgkmcnt(6)
    v_mfma_f32_32x32x16_bf16 v[32:47], v[12:15], v[208:211], v[32:47]
    s_waitcnt lgkmcnt(4)
    v_mfma_f32_32x32x16_bf16 v[32:47], v[12:15], v[212:215], v[32:47]
    s_waitcnt lgkmcnt(2)
    v_mfma_f32_32x32x16_bf16 v[32:47], v[12:15], v[216:219], v[32:47]
    s_waitcnt lgkmcnt(0)
    v_mfma_f32_32x32x16_bf16 v[32:47], v[12:15], v[220:223], v[32:47]
    s_nop 11
    ds_write_b32 v28, v32
    v_mov_b32 v23, 1
    s_mov_b64 exec, 1
    ds_add_u32 v4, v23 offset:36
    s_mov_b64 exec, -1
    s_cmp_lg_u32 s39, 0
    s_cbranch_scc1 Lx_8
    s_mov_b32 m0, 162512
    s_lshl_b32 s46, s37, 10
    buffer_load_dwordx4 v2, s[28:31], s46 offen lds
Lx_8:
    s_cmp_lg_u32 s39, 2
    s_cbranch_scc1 Lx_3
    v_lshlrev_b32 v6, 7, v1
    s_mul_i32 s46, s2, 6144
    buffer_load_dword v26, v6, s[20:23], s46 offen
    v_and_b32 v6, 0x780, v6
    s_lshl_b32 s46, s2, 11
    buffer_load_dword v26, v6, s[24:27], s46 offen
Lx_3:
    s_branch L_aux_0
L_main_0:
    v_subrev_u32 v127, 65536, v5
    v_and_b32 v0, 0x1f0, v2
    v_add_u32 v0, 155648, v0
    v_bfe_u32 v114, v1, 1, 3
    v_xor_b32 v114, v114, v64
    v_lshlrev_b32 v114, 4, v114
    v_lshl_add_u32 v114, v65, 7, v114
    s_and_b32 s46, s37, 1
    s_lshl_b32 s46, s46, 6
    v_xor_b32 v114, s46, v114
    v_add_u32 v114, s86, v114
    v_xor_b32 v115, 32, v114
    v_xor_b32 v116, 64, v114
    v_xor_b32 v117, 96, v114
    s_mov_b32 s94, 0x3f803f80
    v_mov_b32 v96, 0
    v_mov_b32 v97, 0
    v_mov_b32 v98, 0
    v_mov_b32 v99, 0
    v_add_u32 v21, s78, v2
    s_add_u32 s91, s79, 18874368
    s_add_u32 s93, s91, 4096
    s_add_u32 m0, s86, 8192
    s_add_u32 s49, s89, s90
    buffer_load_dwordx4 v28, s[8:11], s49 offen offset:0 lds
    buffer_load_dwordx4 v29, s[8:11], s49 offen offset:1024 lds
    buffer_load_dwordx4 v30, s[8:11], s49 offen offset:2048 lds
    buffer_load_dwordx4 v31, s[8:11], s49 offen offset:3072 lds
    s_add_u32 s90, s90, 128
    s_and_b32 s90, s90, 0x3ff
    v_mov_b32 v112, v114
    v_mov_b32 v113, v115
    s_lshr_b32 s48, s37, 1
    s_sub_u32 s48, s48, s58
    s_and_b32 s48, s48, 7
    s_cmp_lg_u32 s48, 0
    s_waitcnt vmcnt(8)
    s_cbranch_scc1 Lx_9
    ds_read_b128 v[8:11], v112 offset:0
    ds_read_b128 v[12:15], v113 offset:0
Lx_9:
    ds_read_b128 v[128:131], v114 offset:0
    ds_read_b128 v[132:135], v115 offset:0
    ds_read_b128 v[136:139], v116 offset:0
    ds_read_b128 v[140:143], v117 offset:0
    s_add_u32 m0, s86, 12288
    s_add_u32 s49, s89, s90
    buffer_load_dwordx4 v28, s[8:11], s49 offen offset:0 lds
    buffer_load_dwordx4 v29, s[8:11], s49 offen offset:1024 lds
    buffer_load_dwordx4 v30, s[8:11], s49 offen offset:2048 lds
    buffer_load_dwordx4 v31, s[8:11], s49 offen offset:3072 lds
    s_add_u32 s90, s90, 128
    s_and_b32 s90, s90, 0x3ff
    s_cmp_lg_u32 s48, 1
    s_waitcnt vmcnt(8)
    s_cbranch_scc1 Lx_10
    ds_read_b128 v[8:11], v112 offset:4096
    ds_read_b128 v[12:15], v113 offset:4096
Lx_10:
    ds_read_b128 v[144:147], v114 offset:4096
    ds_read_b128 v[148:151], v115 offset:4096
    ds_read_b128 v[152:155], v116 offset:4096
    ds_read_b128 v[156:159], v117 offset:4096
    s_waitcnt lgkmcnt(4)
    s_add_u32 m0, s86, 0
    s_add_u32 s49, s89, s90
    buffer_load_dwordx4 v28, s[8:11], s49 offen offset:0 lds
    buffer_load_dwordx4 v29, s[8:11], s49 offen offset:1024 lds
    buffer_load_dwordx4 v30, s[8:11], s49 offen offset:2048 lds
    buffer_load_dwordx4 v31, s[8:11], s49 offen offset:3072 lds
    s_add_u32 s90, s90, 128
    s_and_b32 s90, s90, 0x3ff
    v_dot2_f32_bf16 v96, v128, s94, v96
    v_dot2_f32_bf16 v98, v128, v128, v98
    v_dot2_f32_bf16 v97, v129, s94, v97
    v_dot2_f32_bf16 v99, v129, v129, v99
    v_dot2_f32_bf16 v96, v130, s94, v96
    v_dot2_f32_bf16 v98, v130, v130, v98
    v_dot2_f32_bf16 v97, v131, s94, v97
    v_dot2_f32_bf16 v99, v131, v131, v99
    v_dot2_f32_bf16 v96, v132, s94, v96
    v_dot2_f32_bf16 v98, v132, v132, v98
    v_dot2_f32_bf16 v97, v133, s94, v97
    v_dot2_f32_bf16 v99, v133, v133, v99
    v_dot2_f32_bf16 v96, v134, s94, v96
    v_dot2_f32_bf16 v98, v134, v134, v98
    v_dot2_f32_bf16 v97, v135, s94, v97
    v_dot2_f32_bf16 v99, v135, v135, v99
    v_dot2_f32_bf16 v96, v136, s94, v96
    v_dot2_f32_bf16 v98, v136, v136, v98
    v_dot2_f32_bf16 v97, v137, s94, v97
    v_dot2_f32_bf16 v99, v137, v137, v99
    v_dot2_f32_bf16 v96, v138, s94, v96
    v_dot2_f32_bf16 v98, v138, v138, v98
    v_dot2_f32_bf16 v97, v139, s94, v97
    v_dot2_f32_bf16 v99, v139, v139, v99
    v_dot2_f32_bf16 v96, v140, s94, v96
    v_dot2_f32_bf16 v98, v140, v140, v98
    v_dot2_f32_bf16 v97, v141, s94, v97
    v_dot2_f32_bf16 v99, v141, v141, v99
    v_dot2_f32_bf16 v96, v142, s94, v96
    v_dot2_f32_bf16 v98, v142, v142, v98
    v_dot2_f32_bf16 v97, v143, s94, v97
    v_dot2_f32_bf16 v99, v143, v143, v99
    v_mov_b32 v23, 1
    s_mov_b64 exec, 1
    s_waitcnt lgkmcnt(0)
    ds_add_u32 v4, v23 offset:20
    s_mov_b64 exec, -1
    s_cmp_lg_u32 s48, 2
    s_waitcnt vmcnt(8)
    s_cbranch_scc1 Lx_11
    ds_read_b128 v[8:11], v112 offset:8192
    ds_read_b128 v[12:15], v113 offset:8192
Lx_11:
    ds_read_b128 v[160:163], v114 offset:8192
    ds_read_b128 v[164:167], v115 offset:8192
    ds_read_b128 v[168:171], v116 offset:8192
    ds_read_b128 v[172:175], v117 offset:8192
    s_waitcnt lgkmcnt(4)
    s_add_u32 m0, s86, 4096
    s_add_u32 s49, s89, s90
    buffer_load_dwordx4 v28, s[8:11], s49 offen offset:0 lds
    buffer_load_dwordx4 v29, s[8:11], s49 offen offset:1024 lds
    buffer_load_dwordx4 v30, s[8:11], s49 offen offset:2048 lds
    buffer_load_dwordx4 v31, s[8:11], s49 offen offset:3072 lds
    s_add_u32 s90, s90, 128
    s_and_b32 s90, s90, 0x3ff
    v_dot2_f32_bf16 v96, v144, s94, v96
    v_dot2_f32_bf16 v98, v144, v144, v98
    v_dot2_f32_bf16 v97, v145, s94, v97
    v_dot2_f32_bf16 v99, v145, v145, v99
    v_dot2_f32_bf16 v96, v146, s94, v96
    v_dot2_f32_bf16 v98, v146, v146, v98
    v_dot2_f32_bf16 v97, v147, s94, v97
    v_dot2_f32_bf16 v99, v147, v147, v99
    v_dot2_f32_bf16 v96, v148, s94, v96
    v_dot2_f32_bf16 v98, v148, v148, v98
    v_dot2_f32_bf16 v97, v149, s94, v97
    v_dot2_f32_bf16 v99, v149, v149, v99
    v_dot2_f32_bf16 v96, v150, s94, v96
    v_dot2_f32_bf16 v98, v150, v150, v98
    v_dot2_f32_bf16 v97, v151, s94, v97
    v_dot2_f32_bf16 v99, v151, v151, v99
    v_dot2_f32_bf16 v96, v152, s94, v96
    v_dot2_f32_bf16 v98, v152, v152, v98
    v_dot2_f32_bf16 v97, v153, s94, v97
    v_dot2_f32_bf16 v99, v153, v153, v99
    v_dot2_f32_bf16 v96, v154, s94, v96
    v_dot2_f32_bf16 v98, v154, v154, v98
    v_dot2_f32_bf16 v97, v155, s94, v97
    v_dot2_f32_bf16 v99, v155, v155, v99
    v_dot2_f32_bf16 v96, v156, s94, v96
    v_dot2_f32_bf16 v98, v156, v156, v98
    v_dot2_f32_bf16 v97, v157, s94, v97
    v_dot2_f32_bf16 v99, v157, v157, v99
    v_dot2_f32_bf16 v96, v158, s94, v96
    v_dot2_f32_bf16 v98, v158, v158, v98
    v_dot2_f32_bf16 v97, v159, s94, v97
    v_dot2_f32_bf16 v99, v159, v159, v99
    s_cmp_lg_u32 s48, 3
    s_waitcnt vmcnt(8)
    s_cbranch_scc1 Lx_12
    ds_read_b128 v[8:11], v112 offset:12288
    ds_read_b128 v[12:15], v113 offset:12288
Lx_12:
    ds_read_b128 v[176:179], v114 offset:12288
    ds_read_b128 v[180:183], v115 offset:12288
    ds_read_b128 v[184:187], v116 offset:12288
    ds_read_b128 v[188:191], v117 offset:12288
    s_waitcnt lgkmcnt(4)
    s_add_u32 m0, s86, 8192
    s_add_u32 s49, s89, s90
    buffer_load_dwordx4 v28, s[8:11], s49 offen offset:0 lds
    buffer_load_dwordx4 v29, s[8:11], s49 offen offset:1024 lds
    buffer_load_dwordx4 v30, s[8:11], s49 offen offset:2048 lds
    buffer_load_dwordx4 v31, s[8:11], s49 offen offset:3072 lds
    s_add_u32 s90, s90, 128
    s_and_b32 s90, s90, 0x3ff
    v_dot2_f32_bf16 v96, v160, s94, v96
    v_dot2_f32_bf16 v98, v160, v160, v98
    v_dot2_f32_bf16 v97, v161, s94, v97
    v_dot2_f32_bf16 v99, v161, v161, v99
    v_dot2_f32_bf16 v96, v162, s94, v96
    v_dot2_f32_bf16 v98, v162, v162, v98
    v_dot2_f32_bf16 v97, v163, s94, v97
    v_dot2_f32_bf16 v99, v163, v163, v99
    v_dot2_f32_bf16 v96, v164, s94, v96
    v_dot2_f32_bf16 v98, v164, v164, v98
    v_dot2_f32_bf16 v97, v165, s94, v97
    v_dot2_f32_bf16 v99, v165, v165, v99
    v_dot2_f32_bf16 v96, v166, s94, v96
    v_dot2_f32_bf16 v98, v166, v166, v98
    v_dot2_f32_bf16 v97, v167, s94, v97
    v_dot2_f32_bf16 v99, v167, v167, v99
    v_dot2_f32_bf16 v96, v168, s94, v96
    v_dot2_f32_bf16 v98, v168, v168, v98
    v_dot2_f32_bf16 v97, v169, s94, v97
    v_dot2_f32_bf16 v99, v169, v169, v99
    v_dot2_f32_bf16 v96, v170, s94, v96
    v_dot2_f32_bf16 v98, v170, v170, v98
    v_dot2_f32_bf16 v97, v171, s94, v97
    v_dot2_f32_bf16 v99, v171, v171, v99
    v_dot2_f32_bf16 v96, v172, s94, v96
    v_dot2_f32_bf16 v98, v172, v172, v98
    v_dot2_f32_bf16 v97, v173, s94, v97
    v_dot2_f32_bf16 v99, v173, v173, v99
    v_dot2_f32_bf16 v96, v174, s94, v96
    v_dot2_f32_bf16 v98, v174, v174, v98
    v_dot2_f32_bf16 v97, v175, s94, v97
    v_dot2_f32_bf16 v99, v175, v175, v99
    s_cmp_lg_u32 s48, 4
    s_waitcnt vmcnt(8)
    s_cbranch_scc1 Lx_13
    ds_read_b128 v[8:11], v112 offset:0
    ds_read_b128 v[12:15], v113 offset:0
Lx_13:
    ds_read_b128 v[192:195], v114 offset:0
    ds_read_b128 v[196:199], v115 offset:0
    ds_read_b128 v[200:203], v116 offset:0
    ds_read_b128 v[204:207], v117 offset:0
    s_waitcnt lgkmcnt(4)
    s_add_u32 m0, s86, 12288
    s_add_u32 s49, s89, s90
    buffer_load_dwordx4 v28, s[8:11], s49 offen offset:0 lds
    buffer_load_dwordx4 v29, s[8:11], s49 offen offset:1024 lds
    buffer_load_dwordx4 v30, s[8:11], s49 offen offset:2048 lds
    buffer_load_dwordx4 v31, s[8:11], s49 offen offset:3072 lds
    s_add_u32 s90, s90, 128
    s_and_b32 s90, s90, 0x3ff
    v_dot2_f32_bf16 v96, v176, s94, v96
    v_dot2_f32_bf16 v98, v176, v176, v98
    v_dot2_f32_bf16 v97, v177, s94, v97
    v_dot2_f32_bf16 v99, v177, v177, v99
    v_dot2_f32_bf16 v96, v178, s94, v96
    v_dot2_f32_bf16 v98, v178, v178, v98
    v_dot2_f32_bf16 v97, v179, s94, v97
    v_dot2_f32_bf16 v99, v179, v179, v99
    v_dot2_f32_bf16 v96, v180, s94, v96
    v_dot2_f32_bf16 v98, v180, v180, v98
    v_dot2_f32_bf16 v97, v181, s94, v97
    v_dot2_f32_bf16 v99, v181, v181, v99
    v_dot2_f32_bf16 v96, v182, s94, v96
    v_dot2_f32_bf16 v98, v182, v182, v98
    v_dot2_f32_bf16 v97, v183, s94, v97
    v_dot2_f32_bf16 v99, v183, v183, v99
    v_dot2_f32_bf16 v96, v184, s94, v96
    v_dot2_f32_bf16 v98, v184, v184, v98
    v_dot2_f32_bf16 v97, v185, s94, v97
    v_dot2_f32_bf16 v99, v185, v185, v99
    v_dot2_f32_bf16 v96, v186, s94, v96
    v_dot2_f32_bf16 v98, v186, v186, v98
    v_dot2_f32_bf16 v97, v187, s94, v97
    v_dot2_f32_bf16 v99, v187, v187, v99
    v_dot2_f32_bf16 v96, v188, s94, v96
    v_dot2_f32_bf16 v98, v188, v188, v98
    v_dot2_f32_bf16 v97, v189, s94, v97
    v_dot2_f32_bf16 v99, v189, v189, v99
    v_dot2_f32_bf16 v96, v190, s94, v96
    v_dot2_f32_bf16 v98, v190, v190, v98
    v_dot2_f32_bf16 v97, v191, s94, v97
    v_dot2_f32_bf16 v99, v191, v191, v99
    s_cmp_lg_u32 s48, 5
    s_waitcnt vmcnt(8)
    s_cbranch_scc1 Lx_14
    ds_read_b128 v[8:11], v112 offset:4096
    ds_read_b128 v[12:15], v113 offset:4096
Lx_14:
    ds_read_b128 v[208:211], v114 offset:4096
    ds_read_b128 v[212:215], v115 offset:4096
    ds_read_b128 v[216:219], v116 offset:4096
    ds_read_b128 v[220:223], v117 offset:4096
    s_waitcnt lgkmcnt(4)
    v_dot2_f32_bf16 v96, v192, s94, v96
    v_dot2_f32_bf16 v98, v192, v192, v98
    v_dot2_f32_bf16 v97, v193, s94, v97
    v_dot2_f32_bf16 v99, v193, v193, v99
    v_dot2_f32_bf16 v96, v194, s94, v96
    v_dot2_f32_bf16 v98, v194, v194, v98
    v_dot2_f32_bf16 v97, v195, s94, v97
    v_dot2_f32_bf16 v99, v195, v195, v99
    v_dot2_f32_bf16 v96, v196, s94, v96
    v_dot2_f32_bf16 v98, v196, v196, v98
    v_dot2_f32_bf16 v97, v197, s94, v97
    v_dot2_f32_bf16 v99, v197, v197, v99
    v_dot2_f32_bf16 v96, v198, s94, v96
    v_dot2_f32_bf16 v98, v198, v198, v98
    v_dot2_f32_bf16 v97, v199, s94, v97
    v_dot2_f32_bf16 v99, v199, v199, v99
    v_dot2_f32_bf16 v96, v200, s94, v96
    v_dot2_f32_bf16 v98, v200, v200, v98
    v_dot2_f32_bf16 v97, v201, s94, v97
    v_dot2_f32_bf16 v99, v201, v201, v99
    v_dot2_f32_bf16 v96, v202, s94, v96
    v_dot2_f32_bf16 v98, v202, v202, v98
    v_dot2_f32_bf16 v97, v203, s94, v97
    v_dot2_f32_bf16 v99, v203, v203, v99
    v_dot2_f32_bf16 v96, v204, s94, v96
    v_dot2_f32_bf16 v98, v204, v204, v98
    v_dot2_f32_bf16 v97, v205, s94, v97
    v_dot2_f32_bf16 v99, v205, v205, v99
    v_dot2_f32_bf16 v96, v206, s94, v96
    v_dot2_f32_bf16 v98, v206, v206, v98
    v_dot2_f32_bf16 v97, v207, s94, v97
    v_dot2_f32_bf16 v99, v207, v207, v99
    s_cmp_lg_u32 s48, 6
    s_waitcnt vmcnt(4)
    s_cbranch_scc1 Lx_15
    ds_read_b128 v[8:11], v112 offset:8192
    ds_read_b128 v[12:15], v113 offset:8192
Lx_15:
    ds_read_b128 v[224:227], v114 offset:8192
    ds_read_b128 v[228:231], v115 offset:8192
    ds_read_b128 v[232:235], v116 offset:8192
    ds_read_b128 v[236:239], v117 offset:8192
    s_waitcnt lgkmcnt(4)
    v_dot2_f32_bf16 v96, v208, s94, v96
    v_dot2_f32_bf16 v98, v208, v208, v98
    v_dot2_f32_bf16 v97, v209, s94, v97
    v_dot2_f32_bf16 v99, v209, v209, v99
    v_dot2_f32_bf16 v96, v210, s94, v96
    v_dot2_f32_bf16 v98, v210, v210, v98
    v_dot2_f32_bf16 v97, v211, s94, v97
    v_dot2_f32_bf16 v99, v211, v211, v99
    v_dot2_f32_bf16 v96, v212, s94, v96
    v_dot2_f32_bf16 v98, v212, v212, v98
    v_dot2_f32_bf16 v97, v213, s94, v97
    v_dot2_f32_bf16 v99, v213, v213, v99
    v_dot2_f32_bf16 v96, v214, s94, v96
    v_dot2_f32_bf16 v98, v214, v214, v98
    v_dot2_f32_bf16 v97, v215, s94, v97
    v_dot2_f32_bf16 v99, v215, v215, v99
    v_dot2_f32_bf16 v96, v216, s94, v96
    v_dot2_f32_bf16 v98, v216, v216, v98
    v_dot2_f32_bf16 v97, v217, s94, v97
    v_dot2_f32_bf16 v99, v217, v217, v99
    v_dot2_f32_bf16 v96, v218, s94, v96
    v_dot2_f32_bf16 v98, v218, v218, v98
    v_dot2_f32_bf16 v97, v219, s94, v97
    v_dot2_f32_bf16 v99, v219, v219, v99
    v_dot2_f32_bf16 v96, v220, s94, v96
    v_dot2_f32_bf16 v98, v220, v220, v98
    v_dot2_f32_bf16 v97, v221, s94, v97
    v_dot2_f32_bf16 v99, v221, v221, v99
    v_dot2_f32_bf16 v96, v222, s94, v96
    v_dot2_f32_bf16 v98, v222, v222, v98
    v_dot2_f32_bf16 v97, v223, s94, v97
    v_dot2_f32_bf16 v99, v223, v223, v99
    s_cmp_lg_u32 s48, 7
    s_waitcnt vmcnt(0)
    s_cbranch_scc1 Lx_16
    ds_read_b128 v[8:11], v112 offset:12288
    ds_read_b128 v[12:15], v113 offset:12288
Lx_16:
    ds_read_b128 v[240:243], v114 offset:12288
    ds_read_b128 v[244:247], v115 offset:12288
    ds_read_b128 v[248:251], v116 offset:12288
    ds_read_b128 v[252:255], v117 offset:12288
    s_waitcnt lgkmcnt(4)
    v_dot2_f32_bf16 v96, v224, s94, v96
    v_dot2_f32_bf16 v98, v224, v224, v98
    v_dot2_f32_bf16 v97, v225, s94, v97
    v_dot2_f32_bf16 v99, v225, v225, v99
    v_dot2_f32_bf16 v96, v226, s94, v96
    v_dot2_f32_bf16 v98, v226, v226, v98
    v_dot2_f32_bf16 v97, v227, s94, v97
    v_dot2_f32_bf16 v99, v227, v227, v99
    v_dot2_f32_bf16 v96, v228, s94, v96
    v_dot2_f32_bf16 v98, v228, v228, v98
    v_dot2_f32_bf16 v97, v229, s94, v97
    v_dot2_f32_bf16 v99, v229, v229, v99
    v_dot2_f32_bf16 v96, v230, s94, v96
    v_dot2_f32_bf16 v98, v230, v230, v98
    v_dot2_f32_bf16 v97, v231, s94, v97
    v_dot2_f32_bf16 v99, v231, v231, v99
    v_dot2_f32_bf16 v96, v232, s94, v96
    v_dot2_f32_bf16 v98, v232, v232, v98
    v_dot2_f32_bf16 v97, v233, s94, v97
    v_dot2_f32_bf16 v99, v233, v233, v99
    v_dot2_f32_bf16 v96, v234, s94, v96
    v_dot2_f32_bf16 v98, v234, v234, v98
    v_dot2_f32_bf16 v97, v235, s94, v97
    v_dot2_f32_bf16 v99, v235, v235, v99
    v_dot2_f32_bf16 v96, v236, s94, v96
    v_dot2_f32_bf16 v98, v236, v236, v98
    v_dot2_f32_bf16 v97, v237, s94, v97
    v_dot2_f32_bf16 v99, v237, v237, v99
    v_dot2_f32_bf16 v96, v238, s94, v96
    v_dot2_f32_bf16 v98, v238, v238, v98
    v_dot2_f32_bf16 v97, v239, s94, v97
    v_dot2_f32_bf16 v99, v239, v239, v99
    v_mov_b32 v23, 1
    s_mov_b64 exec, 1
    s_waitcnt lgkmcnt(0)
    ds_add_u32 v4, v23 offset:16
    s_mov_b64 exec, -1
    ds_read_b32 v23, v4 offset:0
    v_dot2_f32_bf16 v96, v240, s94, v96
    v_dot2_f32_bf16 v98, v240, v240, v98
    v_dot2_f32_bf16 v97, v241, s94, v97
    v_dot2_f32_bf16 v99, v241, v241, v99
    v_dot2_f32_bf16 v96, v242, s94, v96
    v_dot2_f32_bf16 v98, v242, v242, v98
    v_dot2_f32_bf16 v97, v243, s94, v97
    v_dot2_f32_bf16 v99, v243, v243, v99
    v_dot2_f32_bf16 v96, v244, s94, v96
    v_dot2_f32_bf16 v98, v244, v244, v98
    v_dot2_f32_bf16 v97, v245, s94, v97
    v_dot2_f32_bf16 v99, v245, v245, v99
    v_dot2_f32_bf16 v96, v246, s94, v96
    v_dot2_f32_bf16 v98, v246, v246, v98
    v_dot2_f32_bf16 v97, v247, s94, v97
    v_dot2_f32_bf16 v99, v247, v247, v99
    v_dot2_f32_bf16 v96, v248, s94, v96
    v_dot2_f32_bf16 v98, v248, v248, v98
    v_dot2_f32_bf16 v97, v249, s94, v97
    v_dot2_f32_bf16 v99, v249, v249, v99
    v_dot2_f32_bf16 v96, v250, s94, v96
    v_dot2_f32_bf16 v98, v250, v250, v98
    v_dot2_f32_bf16 v97, v251, s94, v97
    v_dot2_f32_bf16 v99, v251, v251, v99
    v_dot2_f32_bf16 v96, v252, s94, v96
    v_dot2_f32_bf16 v98, v252, v252, v98
    v_dot2_f32_bf16 v97, v253, s94, v97
    v_dot2_f32_bf16 v99, v253, v253, v99
    v_dot2_f32_bf16 v96, v254, s94, v96
    v_dot2_f32_bf16 v98, v254, v254, v98
    v_dot2_f32_bf16 v97, v255, s94, v97
    v_dot2_f32_bf16 v99, v255, v255, v99
    s_waitcnt lgkmcnt(0)
    v_cmp_gt_u32 vcc, 4, v23
    s_cbranch_vccz Llc_17
Llw_18:
    ds_read_b32 v23, v4 offset:0
    s_waitcnt lgkmcnt(0)
    v_cmp_gt_u32 vcc, 4, v23
    s_cbranch_vccnz Llw_18
Llc_17:
    ds_read_b64_tr_b16 v[64:65], v127 offset:0
    ds_read_b64_tr_b16 v[66:67], v127 offset:256
    ds_read_b64_tr_b16 v[68:69], v127 offset:32768
    ds_read_b64_tr_b16 v[70:71], v127 offset:33024
    ds_read_b64_tr_b16 v[72:73], v127 offset:1024
    ds_read_b64_tr_b16 v[74:75], v127 offset:1280
    ds_read_b64_tr_b16 v[76:77], v127 offset:33792
    ds_read_b64_tr_b16 v[78:79], v127 offset:34048
    ds_read_b64_tr_b16 v[80:81], v127 offset:2048
    ds_read_b64_tr_b16 v[82:83], v127 offset:2304
    ds_read_b64_tr_b16 v[84:85], v127 offset:34816
    ds_read_b64_tr_b16 v[86:87], v127 offset:35072
    v_add_f32 v96, v96, v97
    v_add_f32 v98, v98, v99
    s_nop 1
    v_permlane32_swap_b32 v96, v98
    v_add_f32 v96, v96, v98
    v_mov_b32 v97, v96
    v_mov_b32 v30, 0
    v_mov_b32 v31, 0
    v_permlane32_swap_b32 v96, v97
    v_mul_f32 v96, 0x3b000000, v96
    v_mul_f32 v97, 0x3b000000, v97
    v_fma_f32 v97, -v96, v96, v97
    v_max_f32 v97, 0, v97
    v_add_f32 v97, 0x3727c5ac, v97
    v_rsq_f32 v20, v97
    s_waitcnt lgkmcnt(10)
    v_mfma_f32_32x32x16_bf16 v[32:47], v[64:67], v[128:131], 0
    ds_read_b64_tr_b16 v[64:65], v127 offset:3072
    ds_read_b64_tr_b16 v[66:67], v127 offset:3328
    v_cndmask_b32 v96, 0, v96, s[60:61]
    v_and_b32 v98, 0xffff0000, v96
    v_sub_f32 v99, v96, v98
    s_waitcnt lgkmcnt(10)
    v_mfma_f32_32x32x16_bf16 v[48:63], v[128:131], v[68:71], 0
    ds_read_b64_tr_b16 v[68:69], v127 offset:35840
    ds_read_b64_tr_b16 v[70:71], v127 offset:36096
    v_cvt_pk_bf16_f32 v28, -v98, -v98
    v_cvt_pk_bf16_f32 v29, -v99, 0
    ds_write_b32 v25, v20
    s_waitcnt lgkmcnt(11)
    v_mfma_f32_32x32x16_bf16 v[32:47], v[72:75], v[132:135], v[32:47]
    ds_read_b64_tr_b16 v[72:73], v127 offset:4096
    ds_read_b64_tr_b16 v[74:75], v127 offset:4352
    ds_read_b128 v[96:99], v26 offset:0
    ds_read_b128 v[100:103], v26 offset:32
    ds_read_b128 v[104:107], v26 offset:64
    s_waitcnt lgkmcnt(14)
    v_mfma_f32_32x32x16_bf16 v[48:63], v[132:135], v[76:79], v[48:63]
    ds_read_b64_tr_b16 v[76:77], v127 offset:36864
    ds_read_b64_tr_b16 v[78:79], v127 offset:37120
    ds_read_b128 v[108:111], v26 offset:96
    s_waitcnt lgkmcnt(15)
    v_mfma_f32_32x32x16_bf16 v[32:47], v[80:83], v[136:139], v[32:47]
    ds_read_b64_tr_b16 v[80:81], v127 offset:5120
    ds_read_b64_tr_b16 v[82:83], v127 offset:5376
    ds_read_b32 v23, v4 offset:4
    s_waitcnt lgkmcnt(15)
    v_mfma_f32_32x32x16_bf16 v[48:63], v[136:139], v[84:87], v[48:63]
    ds_read_b64_tr_b16 v[84:85], v127 offset:37888
    ds_read_b64_tr_b16 v[86:87], v127 offset:38144
    s_waitcnt lgkmcnt(15)
    v_mfma_f32_32x32x16_bf16 v[32:47], v[64:67], v[140:143], v[32:47]
    ds_read_b64_tr_b16 v[64:65], v127 offset:6144
    ds_read_b64_tr_b16 v[66:67], v127 offset:6400
    s_waitcnt lgkmcnt(15)
    v_mfma_f32_32x32x16_bf16 v[48:63], v[140:143], v[68:71], v[48:63]
    ds_read_b64_tr_b16 v[68:69], v127 offset:38912
    ds_read_b64_tr_b16 v[70:71], v127 offset:39168
    s_waitcnt lgkmcnt(15)
    v_mfma_f32_32x32x16_bf16 v[32:47], v[72:75], v[144:147], v[32:47]
    ds_read_b64_tr_b16 v[72:73], v127 offset:7168
    ds_read_b64_tr_b16 v[74:75], v127 offset:7424
    s_waitcnt lgkmcnt(12)
    v_mfma_f32_32x32x16_bf16 v[48:63], v[144:147], v[76:79], v[48:63]
    ds_read_b64_tr_b16 v[76:77], v127 offset:39936
    ds_read_b64_tr_b16 v[78:79], v127 offset:40192
    s_waitcnt lgkmcnt(11)
    v_mfma_f32_32x32x16_bf16 v[32:47], v[80:83], v[148:151], v[32:47]
    s_waitcnt lgkmcnt(10)
    v_cmp_gt_u32 vcc, 4, v23
    s_cbranch_vccz Llc_19
Llw_20:
    ds_read_b32 v23, v4 offset:4
    s_waitcnt lgkmcnt(0)
    v_cmp_gt_u32 vcc, 4, v23
    s_cbranch_vccnz Llw_20
Llc_19:
    ds_read_b64_tr_b16 v[80:81], v127 offset:8192
    ds_read_b64_tr_b16 v[82:83], v127 offset:8448
    s_waitcnt lgkmcnt(10)
    v_mfma_f32_32x32x16_bf16 v[48:63], v[148:151], v[84:87], v[48:63]
    ds_read_b64_tr_b16 v[84:85], v127 offset:40960
    ds_read_b64_tr_b16 v[86:87], v127 offset:41216
    s_waitcnt lgkmcnt(10)
    v_mfma_f32_32x32x16_bf16 v[32:47], v[64:67], v[152:155], v[32:47]
    ds_read_b64_tr_b16 v[64:65], v127 offset:9216
    ds_read_b64_tr_b16 v[66:67], v127 offset:9472
    s_waitcnt lgkmcnt(10)
    v_mfma_f32_32x32x16_bf16 v[48:63], v[152:155], v[68:71], v[48:63]
    ds_read_b64_tr_b16 v[68:69], v127 offset:41984
    ds_read_b64_tr_b16 v[70:71], v127 offset:42240
    s_waitcnt lgkmcnt(10)
    v_mfma_f32_32x32x16_bf16 v[32:47], v[72:75], v[156:159], v[32:47]
    ds_read_b64_tr_b16 v[72:73], v127 offset:10240
    ds_read_b64_tr_b16 v[74:75], v127 offset:10496
    s_waitcnt lgkmcnt(10)
    v_mfma_f32_32x32x16_bf16 v[48:63], v[156:159], v[76:79], v[48:63]
    ds_read_b64_tr_b16 v[76:77], v127 offset:43008
    ds_read_b64_tr_b16 v[78:79], v127 offset:43264
    s_waitcnt lgkmcnt(10)
    v_mfma_f32_32x32x16_bf16 v[32:47], v[80:83], v[160:163], v[32:47]
    ds_read_b64_tr_b16 v[80:81], v127 offset:11264
    ds_read_b64_tr_b16 v[82:83], v127 offset:11520
    s_waitcnt lgkmcnt(10)
    v_mfma_f32_32x32x16_bf16 v[48:63], v[160:163], v[84:87], v[48:63]
    ds_read_b64_tr_b16 v[84:85], v127 offset:44032
    ds_read_b64_tr_b16 v[86:87], v127 offset:44288
    s_waitcnt lgkmcnt(10)
    v_mfma_f32_32x32x16_bf16 v[32:47], v[64:67], v[164:167], v[32:47]
    ds_read_b64_tr_b16 v[64:65], v127 offset:12288
    ds_read_b64_tr_b16 v[66:67], v127 offset:12544
    s_waitcnt lgkmcnt(10)
    v_mfma_f32_32x32x16_bf16 v[48:63], v[164:167], v[68:71], v[48:63]
    ds_read_b64_tr_b16 v[68:69], v127 offset:45056
    ds_read_b64_tr_b16 v[70:71], v127 offset:45312
    s_waitcnt lgkmcnt(10)
    v_mfma_f32_32x32x16_bf16 v[32:47], v[72:75], v[168:171], v[32:47]
    ds_read_b64_tr_b16 v[72:73], v127 offset:13312
    ds_read_b64_tr_b16 v[74:75], v127 offset:13568
    ds_read_b32 v23, v4 offset:8
    s_waitcnt lgkmcnt(11)
    v_mfma_f32_32x32x16_bf16 v[48:63], v[168:171], v[76:79], v[48:63]
    ds_read_b64_tr_b16 v[76:77], v127 offset:46080
    ds_read_b64_tr_b16 v[78:79], v127 offset:46336
    s_waitcnt lgkmcnt(11)
    v_mfma_f32_32x32x16_bf16 v[32:47], v[80:83], v[172:175], v[32:47]
    ds_read_b64_tr_b16 v[80:81], v127 offset:14336
    ds_read_b64_tr_b16 v[82:83], v127 offset:14592
    s_waitcnt lgkmcnt(11)
    v_mfma_f32_32x32x16_bf16 v[48:63], v[172:175], v[84:87], v[48:63]
    ds_read_b64_tr_b16 v[84:85], v127 offset:47104
    ds_read_b64_tr_b16 v[86:87], v127 offset:47360
    s_waitcnt lgkmcnt(11)
    v_mfma_f32_32x32x16_bf16 v[32:47], v[64:67], v[176:179], v[32:47]
    ds_read_b64_tr_b16 v[64:65], v127 offset:15360
    ds_read_b64_tr_b16 v[66:67], v127 offset:15616
    s_waitcnt lgkmcnt(11)
    v_mfma_f32_32x32x16_bf16 v[48:63], v[176:179], v[68:71], v[48:63]
    ds_read_b64_tr_b16 v[68:69], v127 offset:48128
    ds_read_b64_tr_b16 v[70:71], v127 offset:48384
    s_waitcnt lgkmcnt(11)
    v_mfma_f32_32x32x16_bf16 v[32:47], v[72:75], v[180:183], v[32:47]
    s_waitcnt lgkmcnt(10)
    v_cmp_gt_u32 vcc, 4, v23
    s_cbranch_vccz Llc_21
Llw_22:
    ds_read_b32 v23, v4 offset:8
    s_waitcnt lgkmcnt(0)
    v_cmp_gt_u32 vcc, 4, v23
    s_cbranch_vccnz Llw_22
Llc_21:
    ds_read_b64_tr_b16 v[72:73], v127 offset:16384
    ds_read_b64_tr_b16 v[74:75], v127 offset:16640
    s_waitcnt lgkmcnt(10)
    v_mfma_f32_32x32x16_bf16 v[48:63], v[180:183], v[76:79], v[48:63]
    ds_read_b64_tr_b16 v[76:77], v127 offset:49152
    ds_read_b64_tr_b16 v[78:79], v127 offset:49408
    s_waitcnt lgkmcnt(10)
    v_mfma_f32_32x32x16_bf16 v[32:47], v[80:83], v[184:187], v[32:47]
    ds_read_b64_tr_b16 v[80:81], v127 offset:17408
    ds_read_b64_tr_b16 v[82:83], v127 offset:17664
    s_waitcnt lgkmcnt(10)
    v_mfma_f32_32x32x16_bf16 v[48:63], v[184:187], v[84:87], v[48:63]
    ds_read_b64_tr_b16 v[84:85], v127 offset:50176
    ds_read_b64_tr_b16 v[86:87], v127 offset:50432
    s_waitcnt lgkmcnt(10)
    v_mfma_f32_32x32x16_bf16 v[32:47], v[64:67], v[188:191], v[32:47]
    ds_read_b64_tr_b16 v[64:65], v127 offset:18432
    ds_read_b64_tr_b16 v[66:67], v127 offset:18688
    s_waitcnt lgkmcnt(10)
    v_mfma_f32_32x32x16_bf16 v[48:63], v[188:191], v[68:71], v[48:63]
    ds_read_b64_tr_b16 v[68:69], v127 offset:51200
    ds_read_b64_tr_b16 v[70:71], v127 offset:51456
    s_waitcnt lgkmcnt(10)
    v_mfma_f32_32x32x16_bf16 v[32:47], v[72:75], v[192:195], v[32:47]
    ds_read_b64_tr_b16 v[72:73], v127 offset:19456
    ds_read_b64_tr_b16 v[74:75], v127 offset:19712
    s_waitcnt lgkmcnt(10)
    v_mfma_f32_32x32x16_bf16 v[48:63], v[192:195], v[76:79], v[48:63]
    ds_read_b64_tr_b16 v[76:77], v127 offset:52224
    ds_read_b64_tr_b16 v[78:79], v127 offset:52480
    s_waitcnt lgkmcnt(10)
    v_mfma_f32_32x32x16_bf16 v[32:47], v[80:83], v[196:199], v[32:47]
    ds_read_b64_tr_b16 v[80:81], v127 offset:20480
    ds_read_b64_tr_b16 v[82:83], v127 offset:20736
    s_waitcnt lgkmcnt(10)
    v_mfma_f32_32x32x16_bf16 v[48:63], v[196:199], v[84:87], v[48:63]
    ds_read_b64_tr_b16 v[84:85], v127 offset:53248
    ds_read_b64_tr_b16 v[86:87], v127 offset:53504
    s_waitcnt lgkmcnt(10)
    v_mfma_f32_32x32x16_bf16 v[32:47], v[64:67], v[200:203], v[32:47]
    ds_read_b64_tr_b16 v[64:65], v127 offset:21504
    ds_read_b64_tr_b16 v[66:67], v127 offset:21760
    ds_read_b32 v23, v4 offset:12
    s_waitcnt lgkmcnt(11)
    v_mfma_f32_32x32x16_bf16 v[48:63], v[200:203], v[68:71], v[48:63]
    ds_read_b64_tr_b16 v[68:69], v127 offset:54272
    ds_read_b64_tr_b16 v[70:71], v127 offset:54528
    s_waitcnt lgkmcnt(11)
    v_mfma_f32_32x32x16_bf16 v[32:47], v[72:75], v[204:207], v[32:47]
    ds_read_b64_tr_b16 v[72:73], v127 offset:22528
    ds_read_b64_tr_b16 v[74:75], v127 offset:22784
    s_waitcnt lgkmcnt(11)
    v_mfma_f32_32x32x16_bf16 v[48:63], v[204:207], v[76:79], v[48:63]
    ds_read_b64_tr_b16 v[76:77], v127 offset:55296
    ds_read_b64_tr_b16 v[78:79], v127 offset:55552
    s_waitcnt lgkmcnt(11)
    v_mfma_f32_32x32x16_bf16 v[32:47], v[80:83], v[208:211], v[32:47]
    ds_read_b64_tr_b16 v[80:81], v127 offset:23552
    ds_read_b64_tr_b16 v[82:83], v127 offset:23808
    s_waitcnt lgkmcnt(11)
    v_mfma_f32_32x32x16_bf16 v[48:63], v[208:211], v[84:87], v[48:63]
    ds_read_b64_tr_b16 v[84:85], v127 offset:56320
    ds_read_b64_tr_b16 v[86:87], v127 offset:56576
    s_waitcnt lgkmcnt(11)
    v_mfma_f32_32x32x16_bf16 v[32:47], v[64:67], v[212:215], v[32:47]
    s_waitcnt lgkmcnt(10)
    v_cmp_gt_u32 vcc, 4, v23
    s_cbranch_vccz Llc_23
Llw_24:
    ds_read_b32 v23, v4 offset:12
    s_waitcnt lgkmcnt(0)
    v_cmp_gt_u32 vcc, 4, v23
    s_cbranch_vccnz Llw_24
Llc_23:
    ds_read_b64_tr_b16 v[64:65], v127 offset:24576
    ds_read_b64_tr_b16 v[66:67], v127 offset:24832
    s_waitcnt lgkmcnt(10)
    v_mfma_f32_32x32x16_bf16 v[48:63], v[212:215], v[68:71], v[48:63]
    ds_read_b64_tr_b16 v[68:69], v127 offset:57344
    ds_read_b64_tr_b16 v[70:71], v127 offset:57600
    s_waitcnt lgkmcnt(10)
    v_mfma_f32_32x32x16_bf16 v[32:47], v[72:75], v[216:219], v[32:47]
    ds_read_b64_tr_b16 v[72:73], v127 offset:25600
    ds_read_b64_tr_b16 v[74:75], v127 offset:25856
    s_waitcnt lgkmcnt(10)
    v_mfma_f32_32x32x16_bf16 v[48:63], v[216:219], v[76:79], v[48:63]
    ds_read_b64_tr_b16 v[76:77], v127 offset:58368
    ds_read_b64_tr_b16 v[78:79], v127 offset:58624
    s_waitcnt lgkmcnt(10)
    v_mfma_f32_32x32x16_bf16 v[32:47], v[80:83], v[220:223], v[32:47]
    ds_read_b64_tr_b16 v[80:81], v127 offset:26624
    ds_read_b64_tr_b16 v[82:83], v127 offset:26880
    s_waitcnt lgkmcnt(10)
    v_mfma_f32_32x32x16_bf16 v[48:63], v[220:223], v[84:87], v[48:63]
    ds_read_b64_tr_b16 v[84:85], v127 offset:59392
    ds_read_b64_tr_b16 v[86:87], v127 offset:59648
    s_waitcnt lgkmcnt(10)
    v_mfma_f32_32x32x16_bf16 v[32:47], v[64:67], v[224:227], v[32:47]
    ds_read_b64_tr_b16 v[64:65], v127 offset:27648
    ds_read_b64_tr_b16 v[66:67], v127 offset:27904
    s_waitcnt lgkmcnt(10)
    v_mfma_f32_32x32x16_bf16 v[48:63], v[224:227], v[68:71], v[48:63]
    ds_read_b64_tr_b16 v[68:69], v127 offset:60416
    ds_read_b64_tr_b16 v[70:71], v127 offset:60672
    s_waitcnt lgkmcnt(10)
    v_mfma_f32_32x32x16_bf16 v[32:47], v[72:75], v[228:231], v[32:47]
    ds_read_b64_tr_b16 v[72:73], v127 offset:28672
    ds_read_b64_tr_b16 v[74:75], v127 offset:28928
    s_waitcnt lgkmcnt(10)
    v_mfma_f32_32x32x16_bf16 v[48:63], v[228:231], v[76:79], v[48:63]
    ds_read_b64_tr_b16 v[76:77], v127 offset:61440
    ds_read_b64_tr_b16 v[78:79], v127 offset:61696
    s_waitcnt lgkmcnt(10)
    v_mfma_f32_32x32x16_bf16 v[32:47], v[80:83], v[232:235], v[32:47]
    ds_read_b64_tr_b16 v[80:81], v127 offset:29696
    ds_read_b64_tr_b16 v[82:83], v127 offset:29952
    ds_read_b32 v23, v4 offset:24
    s_waitcnt lgkmcnt(11)
    v_mfma_f32_32x32x16_bf16 v[48:63], v[232:235], v[84:87], v[48:63]
    ds_read_b64_tr_b16 v[84:85], v127 offset:62464
    ds_read_b64_tr_b16 v[86:87], v127 offset:62720
    s_waitcnt lgkmcnt(11)
    v_mfma_f32_32x32x16_bf16 v[32:47], v[64:67], v[236:239], v[32:47]
    ds_read_b64_tr_b16 v[64:65], v127 offset:30720
    ds_read_b64_tr_b16 v[66:67], v127 offset:30976
    s_waitcnt lgkmcnt(11)
    v_mfma_f32_32x32x16_bf16 v[48:63], v[236:239], v[68:71], v[48:63]
    ds_read_b64_tr_b16 v[68:69], v127 offset:63488
    ds_read_b64_tr_b16 v[70:71], v127 offset:63744
    s_waitcnt lgkmcnt(11)
    v_mfma_f32_32x32x16_bf16 v[32:47], v[72:75], v[240:243], v[32:47]
    s_waitcnt lgkmcnt(6)
    v_cmp_gt_u32 vcc, 4, v23
    s_cbranch_vccz Llc_25
Llw_26:
    ds_read_b32 v23, v4 offset:24
    s_waitcnt lgkmcnt(0)
    v_cmp_gt_u32 vcc, 4, v23
    s_cbranch_vccnz Llw_26
Llc_25:
    ds_read_b64_tr_b16 v[72:73], v127 offset:31744
    ds_read_b64_tr_b16 v[74:75], v127 offset:32000
    ds_read_b128 v[88:91], v0 offset:512
    ds_read_b128 v[92:95], v0 offset:1024
    ds_read_b32 v23, v4 offset:28
    v_mfma_f32_32x32x16_bf16 v[48:63], v[240:243], v[76:79], v[48:63]
    ds_read_b64_tr_b16 v[76:77], v127 offset:64512
    ds_read_b64_tr_b16 v[78:79], v127 offset:64768
    s_nop 0
    s_nop 0
    s_nop 0
    v_mfma_f32_32x32x16_bf16 v[32:47], v[80:83], v[244:247], v[32:47]
    s_waitcnt lgkmcnt(3)
    v_add_f32 v88, v88, v89
    v_add_f32 v90, v90, v91
    v_mfma_f32_32x32x16_bf16 v[48:63], v[244:247], v[84:87], v[48:63]
    v_add_f32 v88, v88, v90
    v_and_b32 v90, 0xffff0000, v88
    v_sub_f32 v91, v88, v90
    v_mfma_f32_32x32x16_bf16 v[32:47], v[64:67], v[248:251], v[32:47]
    v_cvt_pk_bf16_f32 v88, v90, v91
    v_cvt_pk_bf16_f32 v89, v90, 0
    v_mov_b32 v90, 0
    v_mfma_f32_32x32x16_bf16 v[48:63], v[248:251], v[68:71], v[48:63]
    v_mov_b32 v91, 0
    v_add_f32 v92, v92, v93
    v_mfma_f32_32x32x16_bf16 v[32:47], v[72:75], v[252:255], v[32:47]
    v_add_f32 v94, v94, v95
    v_add_f32 v92, v92, v94
    v_and_b32 v94, 0xffff0000, v92
    s_waitcnt lgkmcnt(0)
    v_mfma_f32_32x32x16_bf16 v[48:63], v[252:255], v[76:79], v[48:63]
    v_sub_f32 v95, v92, v94
    v_cvt_pk_bf16_f32 v92, v94, v95
    v_cvt_pk_bf16_f32 v93, v94, 0
    v_mov_b32 v94, 0
    v_mov_b32 v95, 0
    v_mfma_f32_32x32x16_bf16 v[32:47], v[88:91], v[28:31], v[32:47]
    s_nop 0
    v_mfma_f32_32x32x16_bf16 v[48:63], v[28:31], v[92:95], v[48:63]
    v_cmp_gt_u32 vcc, 4, v23
    s_cbranch_vccz Llc_27
Llw_28:
    ds_read_b32 v23, v4 offset:28
    s_waitcnt lgkmcnt(0)
    v_cmp_gt_u32 vcc, 4, v23
    s_cbranch_vccnz Llw_28
Llc_27:
    ds_read_b64_tr_b16 v[64:65], v5 offset:0
    ds_read_b64_tr_b16 v[66:67], v5 offset:256
    ds_read_b64_tr_b16 v[68:69], v5 offset:1024
    ds_read_b64_tr_b16 v[70:71], v5 offset:1280
    ds_read_b64_tr_b16 v[72:73], v5 offset:2048
    ds_read_b64_tr_b16 v[74:75], v5 offset:2304
    ds_read_b64_tr_b16 v[76:77], v5 offset:3072
    ds_read_b64_tr_b16 v[78:79], v5 offset:3328
    ds_read_b64_tr_b16 v[80:81], v5 offset:4096
    ds_read_b64_tr_b16 v[82:83], v5 offset:4352
    v_pk_mul_f32 v[32:33], v[32:33], v[20:21] op_sel_hi:[1,0]
    v_pk_mul_f32 v[34:35], v[34:35], v[20:21] op_sel_hi:[1,0]
    v_pk_mul_f32 v[36:37], v[36:37], v[20:21] op_sel_hi:[1,0]
    v_pk_mul_f32 v[38:39], v[38:39], v[20:21] op_sel_hi:[1,0]
    v_pk_mul_f32 v[40:41], v[40:41], v[20:21] op_sel_hi:[1,0]
    v_pk_mul_f32 v[42:43], v[42:43], v[20:21] op_sel_hi:[1,0]
    v_pk_mul_f32 v[44:45], v[44:45], v[20:21] op_sel_hi:[1,0]
    v_pk_mul_f32 v[46:47], v[46:47], v[20:21] op_sel_hi:[1,0]
    v_cvt_pk_bf16_f32 v112, v32, v33
    v_cvt_pk_bf16_f32 v113, v34, v35
    v_cvt_pk_bf16_f32 v114, v36, v37
    v_cvt_pk_bf16_f32 v115, v38, v39
    v_cvt_pk_bf16_f32 v116, v40, v41
    v_cvt_pk_bf16_f32 v117, v42, v43
    v_cvt_pk_bf16_f32 v118, v44, v45
    v_cvt_pk_bf16_f32 v119, v46, v47
    s_waitcnt lgkmcnt(8)
    v_mfma_f32_32x32x16_bf16 v[32:47], v[64:67], v[128:131], 0
    ds_read_b64_tr_b16 v[64:65], v5 offset:5120
    ds_read_b64_tr_b16 v[66:67], v5 offset:5376
    buffer_store_dwordx4 v[112:115], v2, s[4:7], s91 offen offset:0 sc1
    buffer_store_dwordx4 v[116:119], v2, s[4:7], s91 offen offset:1024 sc1
    v_mul_f32 v48, v96, v48
    v_mul_f32 v49, v97, v49
    s_waitcnt lgkmcnt(8)
    v_mfma_f32_32x32x16_bf16 v[32:47], v[68:71], v[132:135], v[32:47]
    ds_read_b64_tr_b16 v[68:69], v5 offset:6144
    ds_read_b64_tr_b16 v[70:71], v5 offset:6400
    v_mul_f32 v50, v98, v50
    v_mul_f32 v51, v99, v51
    v_mul_f32 v52, v100, v52
    v_mul_f32 v53, v101, v53
    s_waitcnt lgkmcnt(8)
    v_mfma_f32_32x32x16_bf16 v[32:47], v[72:75], v[136:139], v[32:47]
    ds_read_b64_tr_b16 v[72:73], v5 offset:7168
    ds_read_b64_tr_b16 v[74:75], v5 offset:7424
    v_mul_f32 v54, v102, v54
    v_mul_f32 v55, v103, v55
    v_cvt_pk_bf16_f32 v120, v48, v49
    v_cvt_pk_bf16_f32 v121, v50, v51
    s_waitcnt lgkmcnt(8)
    v_mfma_f32_32x32x16_bf16 v[32:47], v[76:79], v[140:143], v[32:47]
    ds_read_b64_tr_b16 v[76:77], v5 offset:8192
    ds_read_b64_tr_b16 v[78:79], v5 offset:8448
    v_cvt_pk_bf16_f32 v122, v52, v53
    v_cvt_pk_bf16_f32 v123, v54, v55
    buffer_store_dwordx4 v[120:123], v2, s[4:7], s91 offen offset:2048 sc1
    v_mul_f32 v56, v104, v56
    s_waitcnt lgkmcnt(8)
    v_mfma_f32_32x32x16_bf16 v[32:47], v[80:83], v[144:147], v[32:47]
    ds_read_b64_tr_b16 v[80:81], v5 offset:9216
    ds_read_b64_tr_b16 v[82:83], v5 offset:9472
    v_mul_f32 v57, v105, v57
    v_mul_f32 v58, v106, v58
    v_mul_f32 v59, v107, v59
    v_mul_f32 v60, v108, v60
    s_waitcnt lgkmcnt(8)
    v_mfma_f32_32x32x16_bf16 v[32:47], v[64:67], v[148:151], v[32:47]
    ds_read_b64_tr_b16 v[64:65], v5 offset:10240
    ds_read_b64_tr_b16 v[66:67], v5 offset:10496
    v_mul_f32 v61, v109, v61
    v_mul_f32 v62, v110, v62
    v_mul_f32 v63, v111, v63
    v_cvt_pk_bf16_f32 v124, v56, v57
    s_waitcnt lgkmcnt(8)
    v_mfma_f32_32x32x16_bf16 v[32:47], v[68:71], v[152:155], v[32:47]
    ds_read_b64_tr_b16 v[68:69], v5 offset:11264
    ds_read_b64_tr_b16 v[70:71], v5 offset:11520
    v_cvt_pk_bf16_f32 v125, v58, v59
    v_cvt_pk_bf16_f32 v126, v60, v61
    v_cvt_pk_bf16_f32 v127, v62, v63
    buffer_store_dwordx4 v[124:127], v2, s[4:7], s91 offen offset:3072 sc1
    s_waitcnt lgkmcnt(8)
    v_mfma_f32_32x32x16_bf16 v[32:47], v[72:75], v[156:159], v[32:47]
    ds_read_b64_tr_b16 v[72:73], v5 offset:12288
    ds_read_b64_tr_b16 v[74:75], v5 offset:12544
    v_add3_u32 v23, s43, v112, v113
    v_add3_u32 v23, v23, v114, v115
    v_add3_u32 v23, v23, v116, v117
    v_add3_u32 v23, v23, v118, v119
    s_waitcnt lgkmcnt(8)
    v_mfma_f32_32x32x16_bf16 v[32:47], v[76:79], v[160:163], v[32:47]
    ds_read_b64_tr_b16 v[76:77], v5 offset:13312
    ds_read_b64_tr_b16 v[78:79], v5 offset:13568
    v_add3_u32 v23, v23, v120, v121
    v_add3_u32 v23, v23, v122, v123
    v_add3_u32 v23, v23, v124, v125
    v_add3_u32 v23, v23, v126, v127
    s_waitcnt lgkmcnt(8)
    v_mfma_f32_32x32x16_bf16 v[32:47], v[80:83], v[164:167], v[32:47]
    ds_read_b64_tr_b16 v[80:81], v5 offset:14336
    ds_read_b64_tr_b16 v[82:83], v5 offset:14592
    buffer_store_dword v23, v3, s[4:7], s93 offen sc1
    ds_write_b128 v21, v[112:115] offset:0
    ds_write_b128 v21, v[116:119] offset:1024
    ds_write_b128 v21, v[120:123] offset:2048
    s_waitcnt lgkmcnt(11)
    v_mfma_f32_32x32x16_bf16 v[32:47], v[64:67], v[168:171], v[32:47]
    ds_read_b64_tr_b16 v[64:65], v5 offset:15360
    ds_read_b64_tr_b16 v[66:67], v5 offset:15616
    ds_write_b128 v21, v[124:127] offset:3072
    v_subrev_f32 v96, 0x0, v27
    v_subrev_f32 v97, 0x71800000, v27
    v_subrev_f32 v98, 0x72000000, v27
    s_waitcnt lgkmcnt(12)
    v_mfma_f32_32x32x16_bf16 v[32:47], v[68:71], v[172:175], v[32:47]
    ds_read_b64_tr_b16 v[68:69], v5 offset:16384
    ds_read_b64_tr_b16 v[70:71], v5 offset:16640
    v_subrev_f32 v99, 0x72400000, v27
    ds_read_b32 v23, v4 offset:36
    v_subrev_f32 v100, 0x73000000, v27
    v_subrev_f32 v101, 0x73100000, v27
    s_waitcnt lgkmcnt(13)
    v_mfma_f32_32x32x16_bf16 v[32:47], v[72:75], v[176:179], v[32:47]
    ds_read_b64_tr_b16 v[72:73], v5 offset:17408
    ds_read_b64_tr_b16 v[74:75], v5 offset:17664
    v_subrev_f32 v102, 0x73200000, v27
    v_subrev_f32 v103, 0x73300000, v27
    v_subrev_f32 v104, 0x73800000, v27
    v_subrev_f32 v105, 0x73880000, v27
    s_waitcnt lgkmcnt(13)
    v_mfma_f32_32x32x16_bf16 v[32:47], v[76:79], v[180:183], v[32:47]
    ds_read_b64_tr_b16 v[76:77], v5 offset:18432
    ds_read_b64_tr_b16 v[78:79], v5 offset:18688
    v_subrev_f32 v106, 0x73900000, v27
    v_subrev_f32 v107, 0x73980000, v27
    v_subrev_f32 v108, 0x73c00000, v27
    v_subrev_f32 v109, 0x73c80000, v27
    s_waitcnt lgkmcnt(13)
    v_mfma_f32_32x32x16_bf16 v[32:47], v[80:83], v[184:187], v[32:47]
    ds_read_b64_tr_b16 v[80:81], v5 offset:19456
    ds_read_b64_tr_b16 v[82:83], v5 offset:19712
    v_subrev_f32 v110, 0x73d00000, v27
    v_subrev_f32 v111, 0x73d80000, v27
    s_waitcnt lgkmcnt(6)
    v_cmp_gt_u32 vcc, 4, v23
    s_cbranch_vccz Llc_29
Llw_30:
    ds_read_b32 v23, v4 offset:36
    s_waitcnt lgkmcnt(0)
    v_cmp_gt_u32 vcc, 4, v23
    s_cbranch_vccnz Llw_30
Llc_29:
    ds_read_b128 v[84:87], v0
    v_min_f32 v96, 0, v96
    v_mfma_f32_32x32x16_bf16 v[32:47], v[64:67], v[188:191], v[32:47]
    ds_read_b64_tr_b16 v[64:65], v5 offset:20480
    ds_read_b64_tr_b16 v[66:67], v5 offset:20736
    v_min_f32 v97, 0, v97
    v_min_f32 v98, 0, v98
    v_min_f32 v99, 0, v99
    v_min_f32 v100, 0, v100
    v_mfma_f32_32x32x16_bf16 v[32:47], v[68:71], v[192:195], v[32:47]
    ds_read_b64_tr_b16 v[68:69], v5 offset:21504
    ds_read_b64_tr_b16 v[70:71], v5 offset:21760
    v_min_f32 v101, 0, v101
    v_min_f32 v102, 0, v102
    v_min_f32 v103, 0, v103
    v_min_f32 v104, 0, v104
    s_waitcnt lgkmcnt(9)
    v_mfma_f32_32x32x16_bf16 v[32:47], v[72:75], v[196:199], v[32:47]
    ds_read_b64_tr_b16 v[72:73], v5 offset:22528
    ds_read_b64_tr_b16 v[74:75], v5 offset:22784
    v_min_f32 v105, 0, v105
    v_min_f32 v106, 0, v106
    v_min_f32 v107, 0, v107
    v_min_f32 v108, 0, v108
    s_waitcnt lgkmcnt(9)
    v_mfma_f32_32x32x16_bf16 v[32:47], v[76:79], v[200:203], v[32:47]
    ds_read_b64_tr_b16 v[76:77], v5 offset:23552
    ds_read_b64_tr_b16 v[78:79], v5 offset:23808
    v_min_f32 v109, 0, v109
    v_min_f32 v110, 0, v110
    v_min_f32 v111, 0, v111
    v_mul_f32 v20, 0x3eb8aa3b, v20
    s_waitcnt lgkmcnt(9)
    v_mfma_f32_32x32x16_bf16 v[32:47], v[80:83], v[204:207], v[32:47]
    ds_read_b64_tr_b16 v[80:81], v5 offset:24576
    ds_read_b64_tr_b16 v[82:83], v5 offset:24832
    s_waitcnt lgkmcnt(10)
    v_add_f32 v84, v84, v85
    v_add_f32 v86, v86, v87
    v_add_f32 v84, v84, v86
    v_and_b32 v86, 0xffff0000, v84
    s_waitcnt lgkmcnt(8)
    v_mfma_f32_32x32x16_bf16 v[32:47], v[64:67], v[208:211], v[32:47]
    ds_read_b64_tr_b16 v[64:65], v5 offset:25600
    ds_read_b64_tr_b16 v[66:67], v5 offset:25856
    v_sub_f32 v87, v84, v86
    v_cvt_pk_bf16_f32 v84, v86, v87
    v_cvt_pk_bf16_f32 v85, v86, 0
    v_mov_b32 v86, 0
    s_waitcnt lgkmcnt(8)
    v_mfma_f32_32x32x16_bf16 v[32:47], v[68:71], v[212:215], v[32:47]
    ds_read_b64_tr_b16 v[68:69], v5 offset:26624
    ds_read_b64_tr_b16 v[70:71], v5 offset:26880
    v_mov_b32 v87, 0
    v_sub_f32 v112, 0xf1800000, v27
    v_sub_f32 v113, 0x0, v27
    v_sub_f32 v114, 0x71800000, v27
    s_waitcnt lgkmcnt(8)
    v_mfma_f32_32x32x16_bf16 v[32:47], v[72:75], v[216:219], v[32:47]
    ds_read_b64_tr_b16 v[72:73], v5 offset:27648
    ds_read_b64_tr_b16 v[74:75], v5 offset:27904
    v_sub_f32 v115, 0x72000000, v27
    v_sub_f32 v116, 0x72e00000, v27
    v_sub_f32 v117, 0x73000000, v27
    v_sub_f32 v118, 0x73100000, v27
    s_waitcnt lgkmcnt(8)
    v_mfma_f32_32x32x16_bf16 v[32:47], v[76:79], v[220:223], v[32:47]
    ds_read_b64_tr_b16 v[76:77], v5 offset:28672
    ds_read_b64_tr_b16 v[78:79], v5 offset:28928
    v_sub_f32 v119, 0x73200000, v27
    v_sub_f32 v120, 0x73700000, v27
    v_sub_f32 v121, 0x73800000, v27
    v_sub_f32 v122, 0x73880000, v27
    s_waitcnt lgkmcnt(8)
    v_mfma_f32_32x32x16_bf16 v[32:47], v[80:83], v[224:227], v[32:47]
    ds_read_b64_tr_b16 v[80:81], v5 offset:29696
    ds_read_b64_tr_b16 v[82:83], v5 offset:29952
    v_sub_f32 v123, 0x73900000, v27
    v_sub_f32 v124, 0x73b80000, v27
    v_sub_f32 v125, 0x73c00000, v27
    v_sub_f32 v126, 0x73c80000, v27
    s_waitcnt lgkmcnt(8)
    v_mfma_f32_32x32x16_bf16 v[32:47], v[64:67], v[228:231], v[32:47]
    ds_read_b64_tr_b16 v[64:65], v5 offset:30720
    ds_read_b64_tr_b16 v[66:67], v5 offset:30976
    v_sub_f32 v127, 0x73d00000, v27
    v_min_f32 v112, 0, v112
    v_min_f32 v113, 0, v113
    v_min_f32 v114, 0, v114
    s_waitcnt lgkmcnt(8)
    v_mfma_f32_32x32x16_bf16 v[32:47], v[68:71], v[232:235], v[32:47]
    ds_read_b64_tr_b16 v[68:69], v5 offset:31744
    ds_read_b64_tr_b16 v[70:71], v5 offset:32000
    v_min_f32 v115, 0, v115
    v_min_f32 v116, 0, v116
    v_min_f32 v117, 0, v117
    v_min_f32 v118, 0, v118
    s_waitcnt lgkmcnt(8)
    v_mfma_f32_32x32x16_bf16 v[32:47], v[72:75], v[236:239], v[32:47]
    v_min_f32 v119, 0, v119
    v_min_f32 v120, 0, v120
    v_min_f32 v121, 0, v121
    v_min_f32 v122, 0, v122
    s_waitcnt lgkmcnt(6)
    v_mfma_f32_32x32x16_bf16 v[32:47], v[76:79], v[240:243], v[32:47]
    v_min_f32 v123, 0, v123
    v_min_f32 v124, 0, v124
    v_min_f32 v125, 0, v125
    v_min_f32 v126, 0, v126
    s_waitcnt lgkmcnt(4)
    v_mfma_f32_32x32x16_bf16 v[32:47], v[80:83], v[244:247], v[32:47]
    v_min_f32 v127, 0, v127
    s_waitcnt lgkmcnt(2)
    v_mfma_f32_32x32x16_bf16 v[32:47], v[64:67], v[248:251], v[32:47]
    s_waitcnt lgkmcnt(0)
    v_mfma_f32_32x32x16_bf16 v[32:47], v[68:71], v[252:255], v[32:47]
    v_mfma_f32_32x32x16_bf16 v[32:47], v[84:87], v[28:31], v[32:47]
    s_add_u32 s91, s72, 10485760
    s_add_u32 s92, s73, 36864
    s_add_u32 s53, s42, 0
    s_mov_b32 s54, -6144
    s_add_u32 s96, s74, 18874368
    s_add_u32 s97, s96, 71680
    s_lshl_b32 s70, s39, 13
    s_add_u32 s70, s70, 65536
    v_add_u32 v67, 4096, v3
    v_mov_b32 v22, v21
    v_mov_b32 v64, 159424
    v_cndmask_b32 v22, v64, v22, s[50:51]
    v_mov_b32 v64, s54
    v_cndmask_b32 v64, 0, v64, s[50:51]
    v_mov_b32 v84, 0
    v_mov_b32 v85, 0
    v_mov_b32 v86, 0
    v_mov_b32 v87, 0
    s_nop 1
    v_mfma_f32_32x32x16_bf16 v[48:63], v[84:87], v[84:87], 0
    v_pk_mul_f32 v[40:41], v[40:41], v[20:21] op_sel_hi:[1,0]
    v_pk_mul_f32 v[42:43], v[42:43], v[20:21] op_sel_hi:[1,0]
    v_pk_mul_f32 v[44:45], v[44:45], v[20:21] op_sel_hi:[1,0]
    v_pk_mul_f32 v[46:47], v[46:47], v[20:21] op_sel_hi:[1,0]
    v_cvt_pk_bf16_f32 v76, v40, v41
    v_cvt_pk_bf16_f32 v77, v42, v43
    v_cvt_pk_bf16_f32 v78, v44, v45
    v_cvt_pk_bf16_f32 v79, v46, v47
    ds_write_b128 v21, v[76:79] offset:5120
    v_pk_mul_f32 v[32:33], v[32:33], v[20:21] op_sel_hi:[1,0]
    v_pk_mul_f32 v[34:35], v[34:35], v[20:21] op_sel_hi:[1,0]
    v_pk_mul_f32 v[36:37], v[36:37], v[20:21] op_sel_hi:[1,0]
    v_pk_mul_f32 v[38:39], v[38:39], v[20:21] op_sel_hi:[1,0]
    v_cvt_pk_bf16_f32 v72, v32, v33
    v_cvt_pk_bf16_f32 v73, v34, v35
    v_cvt_pk_bf16_f32 v74, v36, v37
    v_cvt_pk_bf16_f32 v75, v38, v39
    s_setprio 1
    s_cmp_ge_u32 s42, 2
    s_cbranch_scc0 Lpr_31
    s_setprio 2
Lpr_31:
    s_waitcnt lgkmcnt(0)
    s_barrier
    s_branch L_j1_0
L_aux_0:
    s_mov_b32 s59, 4
    s_mov_b32 s87, s62
    s_add_u32 s88, s86, s3
    v_and_b32 v24, 60, v3
    s_lshl_b32 s93, s36, 7
    s_add_u32 s93, s93, 4096
    buffer_load_dword v25, v24, s[4:7], s93 offen sc1
    s_lshl_b32 s47, s40, 10
    s_add_u32 s47, s47, s78
    v_add_u32 v21, s47, v2
    s_lshl_b32 s47, s40, 8
    v_xor_b32 v22, s47, v2
    v_add_u32 v22, s78, v22
    s_add_u32 s91, s72, 10485760
    s_add_u32 s92, s73, 36864
    s_add_u32 s53, s42, 0
    s_mov_b32 s54, -6144
    s_add_u32 s96, s74, 18874368
    s_add_u32 s97, s96, 71680
    s_lshl_b32 s70, s39, 13
    s_add_u32 s70, s70, 65536
    v_add_u32 v67, 4096, v3
    v_mov_b32 v64, 159424
    v_cndmask_b32 v22, v64, v22, s[50:51]
    v_mov_b32 v64, s54
    v_cndmask_b32 v64, 0, v64, s[50:51]
    v_mov_b32 v84, 0
    v_mov_b32 v85, 0
    v_mov_b32 v86, 0
    v_mov_b32 v87, 0
    s_setprio 1
    s_cmp_ge_u32 s42, 2
    s_cbranch_scc0 Lpr_32
    s_setprio 2
Lpr_32:
    s_barrier
    ds_read_b128 v[72:75], v21 offset:4096
L_j1_0:
    s_cmp_eq_u32 s75, 0
    s_cbranch_scc1 Lx_33
    s_add_u32 m0, s70, 0
    s_nop 0
    buffer_load_dwordx4 v2, s[4:7], s96 offen offset:0 sc1 lds
    buffer_load_dwordx4 v2, s[4:7], s96 offen offset:1024 sc1 lds
    buffer_load_dwordx4 v2, s[4:7], s96 offen offset:2048 sc1 lds
    buffer_load_dwordx4 v2, s[4:7], s96 offen offset:3072 sc1 lds
    buffer_load_dword v65, v67, s[4:7], s96 offen sc1
    s_add_u32 m0, s70, 4096
    s_nop 0
    buffer_load_dwordx4 v2, s[4:7], s97 offen offset:0 sc1 lds
    buffer_load_dwordx4 v2, s[4:7], s97 offen offset:1024 sc1 lds
    buffer_load_dwordx4 v2, s[4:7], s97 offen offset:2048 sc1 lds
    buffer_load_dwordx4 v2, s[4:7], s97 offen offset:3072 sc1 lds
    buffer_load_dword v66, v67, s[4:7], s97 offen sc1
Lx_33:
    ds_read_b128 v[80:83], v21
    v_add_u32 v21, s54, v21
    ds_read_b128 v[76:79], v21
    v_add_u32 v21, s54, v21
    ds_read_b128 v[88:91], v22 offset:2048
    s_waitcnt lgkmcnt(2)
    v_mfma_f32_32x32x16_bf16 v[96:111], v[80:83], v[72:75], v[96:111]
    s_waitcnt lgkmcnt(1)
    s_nop 6
Latt_34:
    s_waitcnt lgkmcnt(2)
    v_mfma_f32_32x32x16_bf16 v[32:47], v[76:79], v[72:75], 0
    ds_read_b128 v[76:79], v21
    v_add_u32 v21, s54, v21
    v_exp_f32 v96, v96
    v_exp_f32 v97, v97
    v_exp_f32 v98, v98
    v_exp_f32 v99, v99
    s_waitcnt lgkmcnt(2)
    v_mfma_f32_32x32x16_bf16 v[48:63], v[92:95], v[84:87], v[48:63]
    ds_read_b128 v[92:95], v22 offset:3072
    v_add_u32 v22, v64, v22
    v_exp_f32 v100, v100
    v_exp_f32 v101, v101
    v_exp_f32 v102, v102
    v_exp_f32 v103, v103
    v_exp_f32 v104, v104
    v_exp_f32 v105, v105
    v_perm_b32 v80, v97, v96, s63
    v_perm_b32 v81, v99, v98, s63
    v_perm_b32 v82, v101, v100, s63
    v_perm_b32 v83, v103, v102, s63
    v_exp_f32 v106, v106
    v_exp_f32 v107, v107
    s_waitcnt lgkmcnt(2)
    v_mfma_f32_32x32x16_bf16 v[48:63], v[88:91], v[80:83], v[48:63]
    ds_read_b128 v[88:91], v22 offset:2048
    v_exp_f32 v108, v108
    v_exp_f32 v109, v109
    v_exp_f32 v110, v110
    v_exp_f32 v111, v111
    s_sub_u32 s53, s53, 1
    v_perm_b32 v84, v105, v104, s63
    v_perm_b32 v85, v107, v106, s63
    v_perm_b32 v86, v109, v108, s63
    v_perm_b32 v87, v111, v110, s63
    s_cbranch_scc1 Lattd_35
    s_waitcnt lgkmcnt(2)
    v_mfma_f32_32x32x16_bf16 v[96:111], v[76:79], v[72:75], 0
    ds_read_b128 v[76:79], v21
    v_add_u32 v21, s54, v21
    v_exp_f32 v32, v32
    v_exp_f32 v33, v33
    v_exp_f32 v34, v34
    v_exp_f32 v35, v35
    s_waitcnt lgkmcnt(2)
    v_mfma_f32_32x32x16_bf16 v[48:63], v[92:95], v[84:87], v[48:63]
    ds_read_b128 v[92:95], v22 offset:3072
    v_add_u32 v22, v64, v22
    v_exp_f32 v36, v36
    v_exp_f32 v37, v37
    v_exp_f32 v38, v38
    v_exp_f32 v39, v39
    v_exp_f32 v40, v40
    v_exp_f32 v41, v41
    v_perm_b32 v80, v33, v32, s63
    v_perm_b32 v81, v35, v34, s63
    v_perm_b32 v82, v37, v36, s63
    v_perm_b32 v83, v39, v38, s63
    v_exp_f32 v42, v42
    v_exp_f32 v43, v43
    s_waitcnt lgkmcnt(2)
    v_mfma_f32_32x32x16_bf16 v[48:63], v[88:91], v[80:83], v[48:63]
    ds_read_b128 v[88:91], v22 offset:2048
    v_exp_f32 v44, v44
    v_exp_f32 v45, v45
    v_exp_f32 v46, v46
    v_exp_f32 v47, v47
    s_sub_u32 s53, s53, 1
    v_perm_b32 v84, v41, v40, s63
    v_perm_b32 v85, v43, v42, s63
    v_perm_b32 v86, v45, v44, s63
    v_perm_b32 v87, v47, v46, s63
    s_cbranch_scc0 Latt_34
Lattd_35:
    s_lshl_b32 s47, s40, 10
    s_add_u32 s47, s47, s76
    v_add_u32 v21, s47, v2
    s_lshl_b32 s47, s40, 8
    v_xor_b32 v22, s47, v2
    v_add_u32 v22, s76, v22
    s_sub_u32 s53, s77, 1
    s_mov_b32 s54, 4096
    v_mov_b32 v64, 159424
    v_cndmask_b32 v22, v64, v22, s[50:51]
    v_mov_b32 v64, s54
    v_cndmask_b32 v64, 0, v64, s[50:51]
    s_setprio 1
    s_cmp_lt_u32 s42, 2
    s_cbranch_scc0 Lpr_36
    s_setprio 2
Lpr_36:
    s_cmp_eq_u32 s75, 0
    s_cbranch_scc1 Lnh_40
    v_add_u32 v0, s70, v2
    s_branch Lhchk_38
Lhalo_37:
    s_add_u32 m0, s70, 0
    s_nop 0
    buffer_load_dwordx4 v2, s[4:7], s96 offen offset:0 sc1 lds
    buffer_load_dwordx4 v2, s[4:7], s96 offen offset:1024 sc1 lds
    buffer_load_dwordx4 v2, s[4:7], s96 offen offset:2048 sc1 lds
    buffer_load_dwordx4 v2, s[4:7], s96 offen offset:3072 sc1 lds
    buffer_load_dword v65, v67, s[4:7], s96 offen sc1
    s_add_u32 m0, s70, 4096
    s_nop 0
    buffer_load_dwordx4 v2, s[4:7], s97 offen offset:0 sc1 lds
    buffer_load_dwordx4 v2, s[4:7], s97 offen offset:1024 sc1 lds
    buffer_load_dwordx4 v2, s[4:7], s97 offen offset:2048 sc1 lds
    buffer_load_dwordx4 v2, s[4:7], s97 offen offset:3072 sc1 lds
    buffer_load_dword v66, v67, s[4:7], s97 offen sc1
Lhchk_38:
    s_waitcnt vmcnt(5)
    ds_read_b128 v[32:35], v0 offset:0
    ds_read_b128 v[36:39], v0 offset:1024
    ds_read_b128 v[40:43], v0 offset:2048
    ds_read_b128 v[44:47], v0 offset:3072
    s_waitcnt vmcnt(0)
    ds_read_b128 v[96:99], v0 offset:4096
    ds_read_b128 v[100:103], v0 offset:5120
    ds_read_b128 v[104:107], v0 offset:6144
    ds_read_b128 v[108:111], v0 offset:7168
    s_waitcnt lgkmcnt(7)
    v_add3_u32 v68, s43, v32, v33
    v_add3_u32 v68, v68, v34, v35
    s_waitcnt lgkmcnt(6)
    v_add3_u32 v68, v68, v36, v37
    v_add3_u32 v68, v68, v38, v39
    s_waitcnt lgkmcnt(5)
    v_add3_u32 v68, v68, v40, v41
    v_add3_u32 v68, v68, v42, v43
    s_waitcnt lgkmcnt(4)
    v_add3_u32 v68, v68, v44, v45
    v_add3_u32 v68, v68, v46, v47
    v_cmp_ne_u32 s[64:65], v65, v68
    s_waitcnt lgkmcnt(3)
    v_add3_u32 v69, s43, v96, v97
    v_add3_u32 v69, v69, v98, v99
    s_waitcnt lgkmcnt(2)
    v_add3_u32 v69, v69, v100, v101
    v_add3_u32 v69, v69, v102, v103
    s_waitcnt lgkmcnt(1)
    v_add3_u32 v69, v69, v104, v105
    v_add3_u32 v69, v69, v106, v107
    s_waitcnt lgkmcnt(0)
    v_add3_u32 v69, v69, v108, v109
    v_add3_u32 v69, v69, v110, v111
    v_cmp_ne_u32 s[66:67], v66, v69
    s_nop 0
    s_or_b64 s[64:65], s[64:65], s[66:67]
    s_cbranch_scc0 Lhdone_39
    s_sub_u32 s45, s45, 1
    s_cbranch_scc0 Lhalo_37
    s_mov_b32 s45, 0
Lhdone_39:
Lnh_40:
    s_cmp_lg_u32 s40, 0
    s_cbranch_scc1 L_ax2_0
    s_branch L_j2_0
L_ax2_0:
    s_waitcnt vmcnt(0) lgkmcnt(0)
    v_mov_b32 v23, v25
    v_and_b32 v0, -16, v25
    v_cmp_ne_u32 vcc, s43, v0
    s_cbranch_vccz Lx_41
Lpoll_42:
    buffer_load_dword v23, v24, s[4:7], s93 offen sc1
    s_waitcnt vmcnt(0)
    v_and_b32 v0, -16, v23
    v_cmp_ne_u32 vcc, s43, v0
    s_cbranch_vccz Lpolld_43
    s_sleep 1
    s_sub_u32 s45, s45, 1
    s_cbranch_scc0 Lpoll_42
    s_mov_b32 s45, 0
Lpolld_43:
Lx_41:
    v_cmp_ne_u32 vcc, s52, v23
    s_nop 0
    s_cmp_eq_u64 vcc, 0
    s_cselect_b32 s44, 1, 0
    v_mov_b32 v0, s44
    ds_write_b32 v4, v0 offset:44
    v_lshlrev_b32 v5, 3, v2
    v_and_b32 v5, 0x780, v5
    s_add_u32 s46, s80, 10485760
    s_add_u32 s47, s81, 1048576
    s_mov_b64 exec, 0xffff
    buffer_load_dword v26, v5, s[4:7], s46 offen sc1
    buffer_load_dword v26, v5, s[32:35], s80 offen sc1
    s_mov_b64 exec, 3
    buffer_load_dword v26, v5, s[4:7], s47 offen sc1
    v_mul_u32_u24 v5, 24576, v1
    s_add_u32 s47, s82, 12288
    buffer_load_dword v26, v5, s[4:7], s47 offen sc1
    s_mov_b64 exec, 15
    v_lshlrev_b32 v5, 7, v1
    s_lshr_b32 s47, s83, 6
    s_add_u32 s47, s47, 73728
    buffer_load_dword v26, v5, s[4:7], s47 offen sc1
    s_mov_b64 exec, -1
L_j2_0:
    s_waitcnt lgkmcnt(0)
    s_barrier
    ds_read_b32 v23, v4 offset:44
    s_cmp_eq_u32 s36, 0
    s_cbranch_scc1 Lnohalo_44
    ds_read_b128 v[80:83], v21
    v_add_u32 v21, s54, v21
    ds_read_b128 v[76:79], v21
    v_add_u32 v21, s54, v21
    ds_read_b128 v[88:91], v22 offset:2048
    s_waitcnt lgkmcnt(2)
    s_cmp_eq_u32 s36, 1
    s_cbranch_scc1 Lr1_45
    v_mfma_f32_32x32x16_bf16 v[112:127], v[80:83], v[72:75], v[112:127]
    s_branch Lr2_46
Lr1_45:
    v_mfma_f32_32x32x16_bf16 v[112:127], v[80:83], v[72:75], 0
Lr2_46:
    s_waitcnt lgkmcnt(1)
    s_nop 6
Latt_47:
    s_waitcnt lgkmcnt(2)
    v_mfma_f32_32x32x16_bf16 v[32:47], v[76:79], v[72:75], 0
    ds_read_b128 v[76:79], v21
    v_add_u32 v21, s54, v21
    v_exp_f32 v112, v112
    v_exp_f32 v113, v113
    v_exp_f32 v114, v114
    v_exp_f32 v115, v115
    s_waitcnt lgkmcnt(2)
    v_mfma_f32_32x32x16_bf16 v[48:63], v[92:95], v[84:87], v[48:63]
    ds_read_b128 v[92:95], v22 offset:3072
    v_add_u32 v22, v64, v22
    v_exp_f32 v116, v116
    v_exp_f32 v117, v117
    v_exp_f32 v118, v118
    v_exp_f32 v119, v119
    v_exp_f32 v120, v120
    v_exp_f32 v121, v121
    v_perm_b32 v80, v113, v112, s63
    v_perm_b32 v81, v115, v114, s63
    v_perm_b32 v82, v117, v116, s63
    v_perm_b32 v83, v119, v118, s63
    v_exp_f32 v122, v122
    v_exp_f32 v123, v123
    s_waitcnt lgkmcnt(2)
    v_mfma_f32_32x32x16_bf16 v[48:63], v[88:91], v[80:83], v[48:63]
    ds_read_b128 v[88:91], v22 offset:2048
    s_cmp_le_u32 s59, 1
    s_cbranch_scc1 Lsk_49
    s_mul_i32 s46, s87, 3
    s_add_u32 m0, s88, 0
    s_add_u32 s47, s46, 1024
    buffer_load_dwordx4 v8, s[20:23], s47 offen lds
    s_add_u32 m0, s88, 32768
    s_add_u32 s47, s46, 2048
    buffer_load_dwordx4 v8, s[20:23], s47 offen lds
    s_add_u32 m0, s88, 1024
    s_add_u32 s47, s46, 50176
    buffer_load_dwordx4 v8, s[20:23], s47 offen lds
    s_add_u32 m0, s88, 33792
    s_add_u32 s47, s46, 51200
    buffer_load_dwordx4 v8, s[20:23], s47 offen lds
    s_add_u32 s88, s88, 8192
    s_and_b32 s88, s88, 0x7fff
    s_add_u32 s87, s87, 0x20000
    s_and_b32 s87, s87, 0x7ffff
    s_sub_u32 s59, s59, 1
Lsk_49:
    v_exp_f32 v124, v124
    v_exp_f32 v125, v125
    v_exp_f32 v126, v126
    v_exp_f32 v127, v127
    s_sub_u32 s53, s53, 1
    v_perm_b32 v84, v121, v120, s63
    v_perm_b32 v85, v123, v122, s63
    v_perm_b32 v86, v125, v124, s63
    v_perm_b32 v87, v127, v126, s63
    s_cbranch_scc1 Lattd_48
    s_waitcnt lgkmcnt(2)
    v_mfma_f32_32x32x16_bf16 v[112:127], v[76:79], v[72:75], 0
    ds_read_b128 v[76:79], v21
    v_add_u32 v21, s54, v21
    v_exp_f32 v32, v32
    v_exp_f32 v33, v33
    v_exp_f32 v34, v34
    v_exp_f32 v35, v35
    s_waitcnt lgkmcnt(2)
    v_mfma_f32_32x32x16_bf16 v[48:63], v[92:95], v[84:87], v[48:63]
    ds_read_b128 v[92:95], v22 offset:3072
    v_add_u32 v22, v64, v22
    v_exp_f32 v36, v36
    v_exp_f32 v37, v37
    v_exp_f32 v38, v38
    v_exp_f32 v39, v39
    v_exp_f32 v40, v40
    v_exp_f32 v41, v41
    v_perm_b32 v80, v33, v32, s63
    v_perm_b32 v81, v35, v34, s63
    v_perm_b32 v82, v37, v36, s63
    v_perm_b32 v83, v39, v38, s63
    v_exp_f32 v42, v42
    v_exp_f32 v43, v43
    s_waitcnt lgkmcnt(2)
    v_mfma_f32_32x32x16_bf16 v[48:63], v[88:91], v[80:83], v[48:63]
    ds_read_b128 v[88:91], v22 offset:2048
    s_cmp_le_u32 s59, 1
    s_cbranch_scc1 Lsk_50
    s_mul_i32 s46, s87, 3
    s_add_u32 m0, s88, 0
    s_add_u32 s47, s46, 1024
    buffer_load_dwordx4 v8, s[20:23], s47 offen lds
    s_add_u32 m0, s88, 32768
    s_add_u32 s47, s46, 2048
    buffer_load_dwordx4 v8, s[20:23], s47 offen lds
    s_add_u32 m0, s88, 1024
    s_add_u32 s47, s46, 50176
    buffer_load_dwordx4 v8, s[20:23], s47 offen lds
    s_add_u32 m0, s88, 33792
    s_add_u32 s47, s46, 51200
    buffer_load_dwordx4 v8, s[20:23], s47 offen lds
    s_add_u32 s88, s88, 8192
    s_and_b32 s88, s88, 0x7fff
    s_add_u32 s87, s87, 0x20000
    s_and_b32 s87, s87, 0x7ffff
    s_sub_u32 s59, s59, 1
Lsk_50:
    v_exp_f32 v44, v44
    v_exp_f32 v45, v45
    v_exp_f32 v46, v46
    v_exp_f32 v47, v47
    s_sub_u32 s53, s53, 1
    v_perm_b32 v84, v41, v40, s63
    v_perm_b32 v85, v43, v42, s63
    v_perm_b32 v86, v45, v44, s63
    v_perm_b32 v87, v47, v46, s63
    s_cbranch_scc0 Latt_47
Lattd_48:
Lnohalo_44:
    s_waitcnt lgkmcnt(1)
    v_mfma_f32_32x32x16_bf16 v[48:63], v[92:95], v[84:87], v[48:63]
    s_waitcnt lgkmcnt(0)
    v_readfirstlane_b32 s44, v23
    s_nop 9
    v_subrev_u32 v0, 0x30800000, v56
    v_cmp_le_u32 vcc, 0x1e000000, v0
    s_cbranch_vccnz L_fb_0
L_fbr_0:
    v_rcp_f32 v56, v56
    s_nop 0
    v_mul_f32 v48, v56, v48
    v_mul_f32 v49, v56, v49
    v_mul_f32 v50, v56, v50
    v_mul_f32 v51, v56, v51
    v_mul_f32 v52, v56, v52
    v_mul_f32 v53, v56, v53
    v_mul_f32 v54, v56, v54
    v_mul_f32 v55, v56, v55
    v_and_b32 v48, 0xfffe0000, v48
    v_or_b32 v48, 0x10000, v48
    v_cvt_pk_bf16_f32 v81, v50, v51
    v_cvt_pk_bf16_f32 v82, v52, v53
    v_cvt_pk_bf16_f32 v83, v54, v55
    v_cvt_pk_bf16_f32 v80, v48, v49
    v_or_b32 v80, 1, v80
    s_cmp_eq_u32 s44, 0
    s_cbranch_scc1 Lsafe_51
    buffer_store_dwordx4 v[80:83], v2, s[4:7], s91 offen
    v_mov_b32 v23, s43
    s_mov_b64 exec, 1
    s_waitcnt vmcnt(0)
    buffer_store_dword v23, off, s[4:7], s92
    s_mov_b64 exec, -1
Lpub_52:
    s_setprio 0
    v_mov_b32 v23, 1
    s_mov_b64 exec, 1
    s_waitcnt lgkmcnt(0)
    ds_add_u32 v4, v23 offset:32
    s_mov_b64 exec, -1
    s_cmp_lg_u32 s40, 0
    s_cbranch_scc1 L_ax3_0
    s_lshl_b32 s46, s37, 1
    s_add_u32 s46, s46, s40
    s_lshl_b32 s46, s46, 9
    v_bfe_u32 v178, v1, 3, 2
    v_and_b32 v179, 3, v1
    v_lshl_add_u32 v178, v178, 2, v179
    v_lshlrev_b32 v178, 1, v178
    v_lshrrev_b32 v179, 5, v1
    v_lshl_add_u32 v178, v179, 7, v178
    s_and_b32 s46, s46, 512
    s_add_u32 s46, s46, 162512
    v_add_u32 v178, s46, v178
    ds_read_u16 v170, v178 offset:0
    ds_read_u16 v171, v178 offset:32
    ds_read_u16 v172, v178 offset:64
    ds_read_u16 v173, v178 offset:96
    ds_read_u16 v174, v178 offset:256
    ds_read_u16 v175, v178 offset:288
    ds_read_u16 v176, v178 offset:320
    ds_read_u16 v177, v178 offset:352
    s_waitcnt lgkmcnt(0)
    s_waitcnt vmcnt(1)
    v_permlane32_swap_b32 v8, v10
    v_permlane32_swap_b32 v9, v11
    v_permlane32_swap_b32 v12, v14
    v_permlane32_swap_b32 v13, v15
    v_lshl_or_b32 v16, v171, 16, v170
    v_lshl_or_b32 v17, v173, 16, v172
    v_lshl_or_b32 v18, v175, 16, v174
    v_lshl_or_b32 v19, v177, 16, v176
    v_bfe_i32 v170, v1, 2, 1
    v_and_b32 v170, 0x80008000, v170
    v_xor_b32 v16, v170, v16
    v_xor_b32 v17, v170, v17
    v_xor_b32 v18, v170, v18
    v_xor_b32 v19, v170, v19
    v_mov_b32 v128, v80
    v_mov_b32 v129, v81
    v_mov_b32 v130, v82
    v_mov_b32 v131, v83
    s_add_u32 s92, s81, 1048576
    s_lshl_b32 s93, s37, 2
    s_add_u32 s93, s93, s82
    s_add_u32 s93, s93, 12288
    s_lshl_b32 s46, s39, 2
    v_add_u32 v100, s78, v2
    v_add_u32 v101, s46, v4
Lopredo_53:
    ds_read_b64_tr_b16 v[64:65], v6 offset:0
    ds_read_b64_tr_b16 v[66:67], v6 offset:512
    ds_read_b64_tr_b16 v[68:69], v6 offset:1024
    ds_read_b64_tr_b16 v[70:71], v6 offset:1536
    ds_read_b64_tr_b16 v[72:73], v6 offset:2048
    ds_read_b64_tr_b16 v[74:75], v6 offset:2560
    ds_read_b64_tr_b16 v[76:77], v6 offset:3072
    ds_read_b64_tr_b16 v[78:79], v6 offset:3584
    ds_read_b64_tr_b16 v[80:81], v6 offset:4096
    ds_read_b64_tr_b16 v[82:83], v6 offset:4608
    ds_read_b64_tr_b16 v[84:85], v6 offset:5120
    ds_read_b64_tr_b16 v[86:87], v6 offset:5632
    v_lshlrev_b32 v32, 16, v8
    v_and_b32 v33, 0xffff0000, v8
    v_lshlrev_b32 v34, 16, v9
    v_and_b32 v35, 0xffff0000, v9
    v_lshlrev_b32 v36, 16, v10
    v_and_b32 v37, 0xffff0000, v10
    v_lshlrev_b32 v38, 16, v11
    v_and_b32 v39, 0xffff0000, v11
    v_lshlrev_b32 v40, 16, v12
    v_and_b32 v41, 0xffff0000, v12
    v_lshlrev_b32 v42, 16, v13
    v_and_b32 v43, 0xffff0000, v13
    v_lshlrev_b32 v44, 16, v14
    v_and_b32 v45, 0xffff0000, v14
    v_lshlrev_b32 v46, 16, v15
    v_and_b32 v47, 0xffff0000, v15
    v_and_b32 v110, 124, v3
    s_add_u32 s48, s82, 36864
    s_and_b32 s49, s37, 1
    s_lshl_b32 s49, s49, 11
    s_add_u32 s89, s83, 10485760
    v_add3_u32 v108, s49, v2, 0
    s_lshr_b32 s90, s37, 1
    v_add_u32 v108, s89, v108
    s_lshl_b32 s90, s90, 12
    v_xor_b32 v109, 2048, v108
    buffer_load_dword v104, v110, s[4:7], s48 offen sc1
    s_sleep 2
Lpoll_54:
    buffer_load_dword v105, v110, s[4:7], s48 offen sc1
    s_waitcnt vmcnt(1)
    v_cmp_ne_u32 vcc, s43, v104
    s_cbranch_vccz Lpolld_55
    buffer_load_dword v104, v110, s[4:7], s48 offen sc1
    s_waitcnt vmcnt(1)
    v_cmp_ne_u32 vcc, s43, v105
    s_cbranch_vccz Lpolld_55
    s_sub_u32 s45, s45, 1
    s_cbranch_scc0 Lpoll_54
    s_mov_b32 s45, 0
Lpolld_55:
    buffer_load_dwordx4 v[136:139], v109, s[4:7], s90 offen offset:0 sc1
    buffer_load_dwordx4 v[140:143], v109, s[4:7], s90 offen offset:1024 sc1
    s_add_u32 s90, s90, 4096
    s_and_b32 s90, s90, 0x7fff
    buffer_load_dwordx4 v[144:147], v108, s[4:7], s90 offen offset:0 sc1
    buffer_load_dwordx4 v[148:151], v108, s[4:7], s90 offen offset:1024 sc1
    buffer_load_dwordx4 v[152:155], v109, s[4:7], s90 offen offset:0 sc1
    buffer_load_dwordx4 v[156:159], v109, s[4:7], s90 offen offset:1024 sc1
    s_add_u32 s90, s90, 4096
    s_and_b32 s90, s90, 0x7fff
    buffer_load_dwordx4 v[160:163], v108, s[4:7], s90 offen offset:0 sc1
    buffer_load_dwordx4 v[164:167], v108, s[4:7], s90 offen offset:1024 sc1
    buffer_load_dwordx4 v[168:171], v109, s[4:7], s90 offen offset:0 sc1
    buffer_load_dwordx4 v[172:175], v109, s[4:7], s90 offen offset:1024 sc1
    s_add_u32 s90, s90, 4096
    s_and_b32 s90, s90, 0x7fff
Lhb_56:
    ds_read_b32 v102, v101 offset:0
    ds_read_b128 v[132:135], v100 offset:5120
    s_waitcnt lgkmcnt(0)
    v_cmp_gt_u32 vcc, 5, v102
    s_cbranch_vccnz Lhb_56
    v_mfma_f32_32x32x16_bf16 v[32:47], v[64:67], v[128:131], v[32:47]
    ds_read_b64_tr_b16 v[64:65], v6 offset:6144
    ds_read_b64_tr_b16 v[66:67], v6 offset:6656
    v_mfma_f32_32x32x16_bf16 v[32:47], v[68:71], v[132:135], v[32:47]
    ds_read_b64_tr_b16 v[68:69], v6 offset:7168
    ds_read_b64_tr_b16 v[70:71], v6 offset:7680
    s_waitcnt vmcnt(9)
    v_mfma_f32_32x32x16_bf16 v[32:47], v[72:75], v[136:139], v[32:47]
    buffer_load_dwordx4 v[176:179], v108, s[4:7], s90 offen offset:0 sc1
    ds_read_b64_tr_b16 v[72:73], v6 offset:8192
    ds_read_b64_tr_b16 v[74:75], v6 offset:8704
    s_waitcnt vmcnt(9)
    v_mfma_f32_32x32x16_bf16 v[32:47], v[76:79], v[140:143], v[32:47]
    buffer_load_dwordx4 v[180:183], v108, s[4:7], s90 offen offset:1024 sc1
    ds_read_b64_tr_b16 v[76:77], v6 offset:9216
    ds_read_b64_tr_b16 v[78:79], v6 offset:9728
    s_waitcnt vmcnt(9)
    v_mfma_f32_32x32x16_bf16 v[32:47], v[80:83], v[144:147], v[32:47]
    buffer_load_dwordx4 v[184:187], v109, s[4:7], s90 offen offset:0 sc1
    ds_read_b64_tr_b16 v[80:81], v6 offset:10240
    ds_read_b64_tr_b16 v[82:83], v6 offset:10752
    s_waitcnt vmcnt(9)
    v_mfma_f32_32x32x16_bf16 v[32:47], v[84:87], v[148:151], v[32:47]
    buffer_load_dwordx4 v[188:191], v109, s[4:7], s90 offen offset:1024 sc1
    s_add_u32 s90, s90, 4096
    s_and_b32 s90, s90, 0x7fff
    ds_read_b64_tr_b16 v[84:85], v6 offset:11264
    ds_read_b64_tr_b16 v[86:87], v6 offset:11776
    s_waitcnt vmcnt(9) lgkmcnt(10)
    v_mfma_f32_32x32x16_bf16 v[32:47], v[64:67], v[152:155], v[32:47]
    buffer_load_dwordx4 v[192:195], v108, s[4:7], s90 offen offset:0 sc1
    ds_read_b64_tr_b16 v[64:65], v6 offset:12288
    ds_read_b64_tr_b16 v[66:67], v6 offset:12800
    s_waitcnt vmcnt(9) lgkmcnt(10)
    v_mfma_f32_32x32x16_bf16 v[32:47], v[68:71], v[156:159], v[32:47]
    buffer_load_dwordx4 v[196:199], v108, s[4:7], s90 offen offset:1024 sc1
    ds_read_b64_tr_b16 v[68:69], v6 offset:13312
    ds_read_b64_tr_b16 v[70:71], v6 offset:13824
    s_waitcnt vmcnt(9) lgkmcnt(10)
    v_mfma_f32_32x32x16_bf16 v[32:47], v[72:75], v[160:163], v[32:47]
    buffer_load_dwordx4 v[200:203], v109, s[4:7], s90 offen offset:0 sc1
    ds_read_b64_tr_b16 v[72:73], v6 offset:14336
    ds_read_b64_tr_b16 v[74:75], v6 offset:14848
    s_waitcnt vmcnt(9) lgkmcnt(10)
    v_mfma_f32_32x32x16_bf16 v[32:47], v[76:79], v[164:167], v[32:47]
    buffer_load_dwordx4 v[204:207], v109, s[4:7], s90 offen offset:1024 sc1
    s_add_u32 s90, s90, 4096
    s_and_b32 s90, s90, 0x7fff
    ds_read_b64_tr_b16 v[76:77], v6 offset:15360
    ds_read_b64_tr_b16 v[78:79], v6 offset:15872
    s_waitcnt vmcnt(9) lgkmcnt(10)
    v_mfma_f32_32x32x16_bf16 v[32:47], v[80:83], v[168:171], v[32:47]
    buffer_load_dwordx4 v[208:211], v108, s[4:7], s90 offen offset:0 sc1
    ds_read_b64_tr_b16 v[80:81], v6 offset:16384
    ds_read_b64_tr_b16 v[82:83], v6 offset:16896
    s_waitcnt vmcnt(9) lgkmcnt(10)
    v_mfma_f32_32x32x16_bf16 v[32:47], v[84:87], v[172:175], v[32:47]
    buffer_load_dwordx4 v[212:215], v108, s[4:7], s90 offen offset:1024 sc1
    ds_read_b64_tr_b16 v[84:85], v6 offset:17408
    ds_read_b64_tr_b16 v[86:87], v6 offset:17920
    s_waitcnt vmcnt(9) lgkmcnt(10)
    v_mfma_f32_32x32x16_bf16 v[32:47], v[64:67], v[176:179], v[32:47]
    buffer_load_dwordx4 v[216:219], v109, s[4:7], s90 offen offset:0 sc1
    ds_read_b64_tr_b16 v[64:65], v6 offset:18432
    ds_read_b64_tr_b16 v[66:67], v6 offset:18944
    s_waitcnt vmcnt(9) lgkmcnt(10)
    v_mfma_f32_32x32x16_bf16 v[32:47], v[68:71], v[180:183], v[32:47]
    buffer_load_dwordx4 v[220:223], v109, s[4:7], s90 offen offset:1024 sc1
    s_add_u32 s90, s90, 4096
    s_and_b32 s90, s90, 0x7fff
    ds_read_b64_tr_b16 v[68:69], v6 offset:19456
    ds_read_b64_tr_b16 v[70:71], v6 offset:19968
    s_waitcnt vmcnt(9) lgkmcnt(10)
    v_mfma_f32_32x32x16_bf16 v[32:47], v[72:75], v[184:187], v[32:47]
    buffer_load_dwordx4 v[224:227], v108, s[4:7], s90 offen offset:0 sc1
    ds_read_b64_tr_b16 v[72:73], v6 offset:20480
    ds_read_b64_tr_b16 v[74:75], v6 offset:20992
    s_waitcnt vmcnt(9) lgkmcnt(10)
    v_mfma_f32_32x32x16_bf16 v[32:47], v[76:79], v[188:191], v[32:47]
    buffer_load_dwordx4 v[228:231], v108, s[4:7], s90 offen offset:1024 sc1
    ds_read_b64_tr_b16 v[76:77], v6 offset:21504
    ds_read_b64_tr_b16 v[78:79], v6 offset:22016
    s_waitcnt vmcnt(9) lgkmcnt(10)
    v_mfma_f32_32x32x16_bf16 v[32:47], v[80:83], v[192:195], v[32:47]
    buffer_load_dwordx4 v[232:235], v109, s[4:7], s90 offen offset:0 sc1
    ds_read_b64_tr_b16 v[80:81], v6 offset:22528
    ds_read_b64_tr_b16 v[82:83], v6 offset:23040
    s_waitcnt vmcnt(9) lgkmcnt(10)
    v_mfma_f32_32x32x16_bf16 v[32:47], v[84:87], v[196:199], v[32:47]
    buffer_load_dwordx4 v[236:239], v109, s[4:7], s90 offen offset:1024 sc1
    s_add_u32 s90, s90, 4096
    s_and_b32 s90, s90, 0x7fff
    ds_read_b64_tr_b16 v[84:85], v6 offset:23552
    ds_read_b64_tr_b16 v[86:87], v6 offset:24064
    s_waitcnt vmcnt(9) lgkmcnt(10)
    v_mfma_f32_32x32x16_bf16 v[32:47], v[64:67], v[200:203], v[32:47]
    buffer_load_dwordx4 v[240:243], v108, s[4:7], s90 offen offset:0 sc1
    ds_read_b64_tr_b16 v[64:65], v6 offset:24576
    ds_read_b64_tr_b16 v[66:67], v6 offset:25088
    s_waitcnt vmcnt(9) lgkmcnt(10)
    v_mfma_f32_32x32x16_bf16 v[32:47], v[68:71], v[204:207], v[32:47]
    buffer_load_dwordx4 v[244:247], v108, s[4:7], s90 offen offset:1024 sc1
    ds_read_b64_tr_b16 v[68:69], v6 offset:25600
    ds_read_b64_tr_b16 v[70:71], v6 offset:26112
    s_waitcnt vmcnt(9) lgkmcnt(10)
    v_mfma_f32_32x32x16_bf16 v[32:47], v[72:75], v[208:211], v[32:47]
    buffer_load_dwordx4 v[248:251], v109, s[4:7], s90 offen offset:0 sc1
    ds_read_b64_tr_b16 v[72:73], v6 offset:26624
    ds_read_b64_tr_b16 v[74:75], v6 offset:27136
    s_waitcnt vmcnt(9) lgkmcnt(10)
    v_mfma_f32_32x32x16_bf16 v[32:47], v[76:79], v[212:215], v[32:47]
    buffer_load_dwordx4 v[252:255], v109, s[4:7], s90 offen offset:1024 sc1
    ds_read_b64_tr_b16 v[76:77], v6 offset:27648
    ds_read_b64_tr_b16 v[78:79], v6 offset:28160
    s_waitcnt vmcnt(9) lgkmcnt(10)
    v_mfma_f32_32x32x16_bf16 v[32:47], v[80:83], v[216:219], v[32:47]
    ds_read_b64_tr_b16 v[80:81], v6 offset:28672
    ds_read_b64_tr_b16 v[82:83], v6 offset:29184
    s_waitcnt vmcnt(8) lgkmcnt(10)
    v_mfma_f32_32x32x16_bf16 v[32:47], v[84:87], v[220:223], v[32:47]
    ds_read_b64_tr_b16 v[84:85], v6 offset:29696
    ds_read_b64_tr_b16 v[86:87], v6 offset:30208
    s_waitcnt vmcnt(7) lgkmcnt(10)
    v_mfma_f32_32x32x16_bf16 v[32:47], v[64:67], v[224:227], v[32:47]
    ds_read_b64_tr_b16 v[64:65], v6 offset:30720
    ds_read_b64_tr_b16 v[66:67], v6 offset:31232
    s_waitcnt vmcnt(6) lgkmcnt(10)
    v_mfma_f32_32x32x16_bf16 v[32:47], v[68:71], v[228:231], v[32:47]
    ds_read_b64_tr_b16 v[68:69], v6 offset:31744
    ds_read_b64_tr_b16 v[70:71], v6 offset:32256
    s_waitcnt vmcnt(5) lgkmcnt(10)
    v_mfma_f32_32x32x16_bf16 v[32:47], v[72:75], v[232:235], v[32:47]
    s_waitcnt vmcnt(4) lgkmcnt(8)
    v_mfma_f32_32x32x16_bf16 v[32:47], v[76:79], v[236:239], v[32:47]
    s_waitcnt vmcnt(3) lgkmcnt(6)
    v_mfma_f32_32x32x16_bf16 v[32:47], v[80:83], v[240:243], v[32:47]
    s_waitcnt vmcnt(2) lgkmcnt(4)
    v_mfma_f32_32x32x16_bf16 v[32:47], v[84:87], v[244:247], v[32:47]
    s_waitcnt vmcnt(1) lgkmcnt(2)
    v_mfma_f32_32x32x16_bf16 v[32:47], v[64:67], v[248:251], v[32:47]
    s_waitcnt vmcnt(0) lgkmcnt(0)
    v_mfma_f32_32x32x16_bf16 v[32:47], v[68:71], v[252:255], v[32:47]
    ds_read_b32 v0, v4 offset:40
    s_nop 10
    v_and_b32 v128, 0xfffe0000, v32
    v_or_b32 v128, 0x10000, v128
    v_cvt_pk_bf16_f32 v128, v128, v33
    v_cvt_pk_bf16_f32 v129, v34, v35
    v_cvt_pk_bf16_f32 v130, v36, v37
    v_cvt_pk_bf16_f32 v131, v38, v39
    v_and_b32 v132, 0xfffe0000, v40
    v_or_b32 v132, 0x10000, v132
    v_cvt_pk_bf16_f32 v132, v132, v41
    v_cvt_pk_bf16_f32 v133, v42, v43
    v_cvt_pk_bf16_f32 v134, v44, v45
    v_cvt_pk_bf16_f32 v135, v46, v47
    v_or_b32 v128, 1, v128
    v_or_b32 v132, 1, v132
    s_cmp_eq_u32 s44, 0
    s_cbranch_scc1 Lsafe_57
    buffer_store_dwordx4 v[128:131], v2, s[32:35], s80 offen
    buffer_store_dwordx4 v[132:135], v2, s[32:35], s80 offen offset:1024
    v_pk_add_f32 v[64:65], v[32:33], v[34:35]
    v_pk_add_f32 v[66:67], v[36:37], v[38:39]
    v_pk_add_f32 v[68:69], v[40:41], v[42:43]
    v_pk_add_f32 v[70:71], v[44:45], v[46:47]
    v_pk_mul_f32 v[72:73], v[32:33], v[32:33]
    v_pk_mul_f32 v[74:75], v[34:35], v[34:35]
    v_pk_add_f32 v[64:65], v[64:65], v[66:67]
    v_pk_add_f32 v[68:69], v[68:69], v[70:71]
    v_pk_fma_f32 v[72:73], v[36:37], v[36:37], v[72:73]
    v_pk_fma_f32 v[74:75], v[38:39], v[38:39], v[74:75]
    v_pk_fma_f32 v[72:73], v[40:41], v[40:41], v[72:73]
    v_pk_fma_f32 v[74:75], v[42:43], v[42:43], v[74:75]
    v_pk_fma_f32 v[72:73], v[44:45], v[44:45], v[72:73]
    v_pk_fma_f32 v[74:75], v[46:47], v[46:47], v[74:75]
    v_pk_add_f32 v[64:65], v[64:65], v[68:69]
    v_pk_add_f32 v[72:73], v[72:73], v[74:75]
    v_add_f32 v64, v64, v65
    v_add_f32 v66, v72, v73
    s_nop 1
    v_permlane32_swap_b32 v64, v66
    v_add_f32 v64, v64, v66
    v_or_b32 v64, 1, v64
    buffer_store_dword v64, v3, s[4:7], s92 offen
    v_mov_b32 v23, s43
    s_mov_b64 exec, 1
    s_waitcnt vmcnt(0)
    buffer_store_dword v23, off, s[4:7], s93
    s_mov_b64 exec, -1
Lpub_58:
    v_cvt_pk_bf16_f32 v8, v32, v33
    v_cvt_pk_bf16_f32 v9, v34, v35
    v_cvt_pk_bf16_f32 v10, v36, v37
    v_cvt_pk_bf16_f32 v11, v38, v39
    v_cvt_pk_bf16_f32 v12, v40, v41
    v_cvt_pk_bf16_f32 v13, v42, v43
    v_cvt_pk_bf16_f32 v14, v44, v45
    v_cvt_pk_bf16_f32 v15, v46, v47
    v_mov_b32 v23, 1
    s_mov_b64 exec, 1
    s_waitcnt lgkmcnt(0)
    ds_add_u32 v4, v23 offset:16
    s_mov_b64 exec, -1
    s_branch L_main_1
L_ax3_0:
    v_add_u32 v64, s78, v2
    s_lshl_b32 s46, s42, 2
    ds_write_b128 v64, v[80:83] offset:5120
    v_add_u32 v65, s46, v4
    v_mov_b32 v66, 5
    ds_write_b32 v65, v66 offset:0
Lx_59:
    s_cmp_le_u32 s59, 0
    s_cbranch_scc1 Lsk_60
    s_mul_i32 s46, s87, 3
    s_add_u32 m0, s88, 0
    s_add_u32 s47, s46, 1024
    buffer_load_dwordx4 v8, s[20:23], s47 offen lds
    s_add_u32 m0, s88, 32768
    s_add_u32 s47, s46, 2048
    buffer_load_dwordx4 v8, s[20:23], s47 offen lds
    s_add_u32 m0, s88, 1024
    s_add_u32 s47, s46, 50176
    buffer_load_dwordx4 v8, s[20:23], s47 offen lds
    s_add_u32 m0, s88, 33792
    s_add_u32 s47, s46, 51200
    buffer_load_dwordx4 v8, s[20:23], s47 offen lds
    s_add_u32 s88, s88, 8192
    s_and_b32 s88, s88, 0x7fff
    s_add_u32 s87, s87, 0x20000
    s_and_b32 s87, s87, 0x7ffff
    s_sub_u32 s59, s59, 1
Lsk_60:
    s_cmp_lg_u32 s59, 0
    s_cbranch_scc1 Lx_59
    s_lshl_b32 s46, s37, 1
    s_add_u32 s46, s46, s40
    s_lshl_b32 s46, s46, 9
    v_bfe_u32 v104, v1, 3, 2
    v_and_b32 v105, 3, v1
    v_lshl_add_u32 v104, v104, 2, v105
    v_lshlrev_b32 v104, 1, v104
    v_lshrrev_b32 v105, 5, v1
    v_lshl_add_u32 v104, v105, 7, v104
    s_and_b32 s46, s46, 512
    s_add_u32 s46, s46, 162512
    v_add_u32 v104, s46, v104
    ds_read_u16 v96, v104 offset:0
    ds_read_u16 v97, v104 offset:32
    ds_read_u16 v98, v104 offset:64
    ds_read_u16 v99, v104 offset:96
    ds_read_u16 v100, v104 offset:256
    ds_read_u16 v101, v104 offset:288
    ds_read_u16 v102, v104 offset:320
    ds_read_u16 v103, v104 offset:352
Llw_61:
    s_sleep 2
    ds_read_b32 v23, v4 offset:32
    s_waitcnt lgkmcnt(0)
    v_cmp_gt_u32 vcc, 8, v23
    s_cbranch_vccnz Llw_61
    s_add_u32 s46, s62, 0
    s_and_b32 s46, s46, 0x7ffff
    s_mul_i32 s46, s46, 3
    s_add_u32 s49, s3, 0
    s_and_b32 s49, s49, 0x7fff
    s_add_u32 s49, s49, s86
    s_add_u32 m0, s49, 65536
    s_add_u32 s47, s46, 0
    buffer_load_dwordx4 v8, s[20:23], s47 offen lds
    s_add_u32 m0, s49, 66560
    s_add_u32 s47, s46, 49152
    buffer_load_dwordx4 v8, s[20:23], s47 offen lds
    s_add_u32 s46, s62, 131072
    s_and_b32 s46, s46, 0x7ffff
    s_mul_i32 s46, s46, 3
    s_add_u32 s49, s3, 8192
    s_and_b32 s49, s49, 0x7fff
    s_add_u32 s49, s49, s86
    s_add_u32 m0, s49, 65536
    s_add_u32 s47, s46, 0
    buffer_load_dwordx4 v8, s[20:23], s47 offen lds
    s_add_u32 m0, s49, 66560
    s_add_u32 s47, s46, 49152
    buffer_load_dwordx4 v8, s[20:23], s47 offen lds
    s_add_u32 s46, s62, 262144
    s_and_b32 s46, s46, 0x7ffff
    s_mul_i32 s46, s46, 3
    s_add_u32 s49, s3, 16384
    s_and_b32 s49, s49, 0x7fff
    s_add_u32 s49, s49, s86
    s_add_u32 m0, s49, 65536
    s_add_u32 s47, s46, 0
    buffer_load_dwordx4 v8, s[20:23], s47 offen lds
    s_add_u32 m0, s49, 66560
    s_add_u32 s47, s46, 49152
    buffer_load_dwordx4 v8, s[20:23], s47 offen lds
    s_add_u32 s46, s62, 393216
    s_and_b32 s46, s46, 0x7ffff
    s_mul_i32 s46, s46, 3
    s_add_u32 s49, s3, 24576
    s_and_b32 s49, s49, 0x7fff
    s_add_u32 s49, s49, s86
    s_add_u32 m0, s49, 65536
    s_add_u32 s47, s46, 0
    buffer_load_dwordx4 v8, s[20:23], s47 offen lds
    s_add_u32 m0, s49, 66560
    s_add_u32 s47, s46, 49152
    buffer_load_dwordx4 v8, s[20:23], s47 offen lds
    s_waitcnt vmcnt(8) lgkmcnt(0)
    v_lshl_or_b32 v16, v97, 16, v96
    v_lshl_or_b32 v17, v99, 16, v98
    v_lshl_or_b32 v18, v101, 16, v100
    v_lshl_or_b32 v19, v103, 16, v102
    v_bfe_i32 v96, v1, 2, 1
    v_and_b32 v96, 0x80008000, v96
    v_xor_b32 v16, v96, v16
    v_xor_b32 v17, v96, v17
    v_xor_b32 v18, v96, v18
    v_xor_b32 v19, v96, v19
    s_lshl_b32 s46, s39, 2
    s_add_u32 s46, s46, 157184
    v_and_b32 v28, 31, v1
    v_lshl_add_u32 v28, v28, 4, s46
    v_add_u32 v29, 0, v11
    ds_read_b64_tr_b16 v[64:65], v29 offset:0
    ds_read_b64_tr_b16 v[66:67], v29 offset:512
    ds_read_b64_tr_b16 v[68:69], v29 offset:1024
    ds_read_b64_tr_b16 v[70:71], v29 offset:1536
    ds_read_b64_tr_b16 v[72:73], v29 offset:8192
    ds_read_b64_tr_b16 v[74:75], v29 offset:8704
    ds_read_b64_tr_b16 v[76:77], v29 offset:9216
    ds_read_b64_tr_b16 v[78:79], v29 offset:9728
    s_waitcnt lgkmcnt(6)
    v_mfma_f32_32x32x16_bf16 v[32:47], v[12:15], v[64:67], 0
    s_waitcnt lgkmcnt(4)
    v_mfma_f32_32x32x16_bf16 v[32:47], v[12:15], v[68:71], v[32:47]
    s_waitcnt lgkmcnt(2)
    v_mfma_f32_32x32x16_bf16 v[32:47], v[12:15], v[72:75], v[32:47]
    s_waitcnt lgkmcnt(0)
    v_mfma_f32_32x32x16_bf16 v[32:47], v[12:15], v[76:79], v[32:47]
    ds_read_b64_tr_b16 v[80:81], v29 offset:16384
    ds_read_b64_tr_b16 v[82:83], v29 offset:16896
    ds_read_b64_tr_b16 v[84:85], v29 offset:17408
    ds_read_b64_tr_b16 v[86:87], v29 offset:17920
    ds_read_b64_tr_b16 v[88:89], v29 offset:24576
    ds_read_b64_tr_b16 v[90:91], v29 offset:25088
    ds_read_b64_tr_b16 v[92:93], v29 offset:25600
    ds_read_b64_tr_b16 v[94:95], v29 offset:26112
    s_waitcnt lgkmcnt(6)
    v_mfma_f32_32x32x16_bf16 v[32:47], v[12:15], v[80:83], v[32:47]
    s_waitcnt lgkmcnt(4)
    v_mfma_f32_32x32x16_bf16 v[32:47], v[12:15], v[84:87], v[32:47]
    s_waitcnt lgkmcnt(2)
    v_mfma_f32_32x32x16_bf16 v[32:47], v[12:15], v[88:91], v[32:47]
    s_waitcnt lgkmcnt(0)
    v_mfma_f32_32x32x16_bf16 v[32:47], v[12:15], v[92:95], v[32:47]
    v_add_u32 v29, 32768, v11
    ds_read_b64_tr_b16 v[64:65], v29 offset:0
    ds_read_b64_tr_b16 v[66:67], v29 offset:512
    ds_read_b64_tr_b16 v[68:69], v29 offset:1024
    ds_read_b64_tr_b16 v[70:71], v29 offset:1536
    ds_read_b64_tr_b16 v[72:73], v29 offset:8192
    ds_read_b64_tr_b16 v[74:75], v29 offset:8704
    ds_read_b64_tr_b16 v[76:77], v29 offset:9216
    ds_read_b64_tr_b16 v[78:79], v29 offset:9728
    s_waitcnt lgkmcnt(6)
    v_mfma_f32_32x32x16_bf16 v[48:63], v[12:15], v[64:67], 0
    s_waitcnt lgkmcnt(4)
    v_mfma_f32_32x32x16_bf16 v[48:63], v[12:15], v[68:71], v[48:63]
    s_waitcnt lgkmcnt(2)
    v_mfma_f32_32x32x16_bf16 v[48:63], v[12:15], v[72:75], v[48:63]
    s_waitcnt lgkmcnt(0)
    v_mfma_f32_32x32x16_bf16 v[48:63], v[12:15], v[76:79], v[48:63]
    ds_read_b64_tr_b16 v[80:81], v29 offset:16384
    ds_read_b64_tr_b16 v[82:83], v29 offset:16896
    ds_read_b64_tr_b16 v[84:85], v29 offset:17408
    ds_read_b64_tr_b16 v[86:87], v29 offset:17920
    ds_read_b64_tr_b16 v[88:89], v29 offset:24576
    ds_read_b64_tr_b16 v[90:91], v29 offset:25088
    ds_read_b64_tr_b16 v[92:93], v29 offset:25600
    ds_read_b64_tr_b16 v[94:95], v29 offset:26112
    s_waitcnt lgkmcnt(6)
    v_mfma_f32_32x32x16_bf16 v[48:63], v[12:15], v[80:83], v[48:63]
    s_waitcnt lgkmcnt(4)
    v_mfma_f32_32x32x16_bf16 v[48:63], v[12:15], v[84:87], v[48:63]
    s_waitcnt lgkmcnt(2)
    v_mfma_f32_32x32x16_bf16 v[48:63], v[12:15], v[88:91], v[48:63]
    s_waitcnt lgkmcnt(0)
    v_mfma_f32_32x32x16_bf16 v[48:63], v[12:15], v[92:95], v[48:63]
    ds_write_b32 v28, v32 offset:512
    s_nop 10
    ds_write_b32 v28, v48 offset:1024
    s_waitcnt lgkmcnt(0)
    s_branch L_aux_1
L_main_1:
    v_subrev_u32 v5, 32768, v6
    v_subrev_u32 v127, 65536, v5
    v_cmp_gt_u32 vcc, 4, v0
    s_cbranch_vccz Lwr_62
Llw_63:
    ds_read_b32 v23, v4 offset:40
    s_waitcnt lgkmcnt(0)
    v_cmp_gt_u32 vcc, 4, v23
    s_cbranch_vccnz Llw_63
Lwr_62:
    v_and_b32 v0, 0x1f0, v2
    v_add_u32 v0, 157184, v0
    s_lshr_b32 s47, s83, 6
    s_add_u32 s47, s47, 73728
    v_add_u32 v21, s78, v2
    v_sub_u32 v22, v21, v2
    v_and_b32 v23, 31, v1
    v_lshl_add_u32 v22, v23, 5, v22
    v_lshrrev_b32 v23, 5, v1
    v_lshl_add_u32 v22, v23, 4, v22
    s_lshl_b32 s46, s39, 2
    v_add_u32 v120, s46, v4
    v_mov_b32 v121, 6
Lkvredo_64:
    ds_read_b128 v[88:91], v0 offset:512
    ds_read_b128 v[92:95], v0 offset:1024
    ds_read_b64_tr_b16 v[64:65], v127 offset:0
    ds_read_b64_tr_b16 v[66:67], v127 offset:512
    ds_read_b64_tr_b16 v[68:69], v127 offset:32768
    ds_read_b64_tr_b16 v[70:71], v127 offset:33280
    ds_read_b64_tr_b16 v[72:73], v127 offset:1024
    ds_read_b64_tr_b16 v[74:75], v127 offset:1536
    ds_read_b64_tr_b16 v[76:77], v127 offset:33792
    ds_read_b64_tr_b16 v[78:79], v127 offset:34304
    ds_read_b64_tr_b16 v[80:81], v127 offset:2048
    ds_read_b64_tr_b16 v[82:83], v127 offset:2560
    ds_read_b64_tr_b16 v[84:85], v127 offset:34816
    ds_read_b64_tr_b16 v[86:87], v127 offset:35328
    v_and_b32 v110, 60, v3
    s_add_u32 s48, s82, 12288
    s_and_b32 s49, s37, 1
    s_lshl_b32 s49, s49, 11
    s_add_u32 s89, s83, 0
    v_add3_u32 v108, s49, v2, 0
    s_lshr_b32 s90, s37, 1
    v_add_u32 v108, s89, v108
    s_lshl_b32 s90, s90, 12
    v_xor_b32 v109, 2048, v108
    buffer_load_dword v104, v110, s[4:7], s48 offen sc1
    s_sleep 2
Lpoll_65:
    buffer_load_dword v105, v110, s[4:7], s48 offen sc1
    s_waitcnt vmcnt(1)
    v_cmp_ne_u32 vcc, s43, v104
    s_cbranch_vccz Lpolld_66
    buffer_load_dword v104, v110, s[4:7], s48 offen sc1
    s_waitcnt vmcnt(1)
    v_cmp_ne_u32 vcc, s43, v105
    s_cbranch_vccz Lpolld_66
    s_sub_u32 s45, s45, 1
    s_cbranch_scc0 Lpoll_65
    s_mov_b32 s45, 0
Lpolld_66:
    buffer_load_dwordx4 v[136:139], v109, s[32:35], s90 offen offset:0 sc1
    buffer_load_dwordx4 v[140:143], v109, s[32:35], s90 offen offset:1024 sc1
    s_add_u32 s90, s90, 4096
    s_and_b32 s90, s90, 0x7fff
    buffer_load_dwordx4 v[144:147], v108, s[32:35], s90 offen offset:0 sc1
    buffer_load_dwordx4 v[148:151], v108, s[32:35], s90 offen offset:1024 sc1
    buffer_load_dwordx4 v[152:155], v109, s[32:35], s90 offen offset:0 sc1
    buffer_load_dwordx4 v[156:159], v109, s[32:35], s90 offen offset:1024 sc1
    s_add_u32 s90, s90, 4096
    s_and_b32 s90, s90, 0x7fff
    buffer_load_dwordx4 v[160:163], v108, s[32:35], s90 offen offset:0 sc1
    buffer_load_dwordx4 v[164:167], v108, s[32:35], s90 offen offset:1024 sc1
    s_waitcnt lgkmcnt(10)
    v_mfma_f32_32x32x16_bf16 v[32:47], v[64:67], v[128:131], 0
    ds_read_b64_tr_b16 v[64:65], v127 offset:3072
    ds_read_b64_tr_b16 v[66:67], v127 offset:3584
    v_add_f32 v88, v88, v89
    v_add_f32 v90, v90, v91
    s_waitcnt lgkmcnt(10)
    v_mfma_f32_32x32x16_bf16 v[48:63], v[128:131], v[68:71], 0
    ds_read_b64_tr_b16 v[68:69], v127 offset:35840
    ds_read_b64_tr_b16 v[70:71], v127 offset:36352
    v_add_f32 v88, v88, v90
    v_and_b32 v90, 0xffff0000, v88
    v_sub_f32 v91, v88, v90
    s_waitcnt lgkmcnt(10)
    v_mfma_f32_32x32x16_bf16 v[32:47], v[72:75], v[132:135], v[32:47]
    ds_read_b64_tr_b16 v[72:73], v127 offset:4096
    ds_read_b64_tr_b16 v[74:75], v127 offset:4608
    v_cvt_pk_bf16_f32 v88, v90, v91
    v_cvt_pk_bf16_f32 v89, v90, 0
    v_mov_b32 v90, 0
    s_waitcnt lgkmcnt(10)
    v_mfma_f32_32x32x16_bf16 v[48:63], v[132:135], v[76:79], v[48:63]
    ds_read_b64_tr_b16 v[76:77], v127 offset:36864
    ds_read_b64_tr_b16 v[78:79], v127 offset:37376
    v_mov_b32 v91, 0
    v_add_f32 v92, v92, v93
    s_waitcnt vmcnt(7) lgkmcnt(10)
    v_mfma_f32_32x32x16_bf16 v[32:47], v[80:83], v[136:139], v[32:47]
    ds_read_b64_tr_b16 v[80:81], v127 offset:5120
    ds_read_b64_tr_b16 v[82:83], v127 offset:5632
    buffer_load_dwordx4 v[168:171], v109, s[32:35], s90 offen offset:0 sc1
    v_add_f32 v94, v94, v95
    s_waitcnt lgkmcnt(10)
    v_mfma_f32_32x32x16_bf16 v[48:63], v[136:139], v[84:87], v[48:63]
    ds_read_b64_tr_b16 v[84:85], v127 offset:37888
    ds_read_b64_tr_b16 v[86:87], v127 offset:38400
    v_add_f32 v92, v92, v94
    v_and_b32 v94, 0xffff0000, v92
    v_sub_f32 v95, v92, v94
    s_waitcnt vmcnt(7) lgkmcnt(10)
    v_mfma_f32_32x32x16_bf16 v[32:47], v[64:67], v[140:143], v[32:47]
    ds_read_b64_tr_b16 v[64:65], v127 offset:6144
    ds_read_b64_tr_b16 v[66:67], v127 offset:6656
    buffer_load_dwordx4 v[172:175], v109, s[32:35], s90 offen offset:1024 sc1
    s_add_u32 s90, s90, 4096
    s_and_b32 s90, s90, 0x7fff
    v_cvt_pk_bf16_f32 v92, v94, v95
    s_waitcnt lgkmcnt(10)
    v_mfma_f32_32x32x16_bf16 v[48:63], v[140:143], v[68:71], v[48:63]
    ds_read_b64_tr_b16 v[68:69], v127 offset:38912
    ds_read_b64_tr_b16 v[70:71], v127 offset:39424
    v_cvt_pk_bf16_f32 v93, v94, 0
    v_mov_b32 v94, 0
    v_mov_b32 v95, 0
    s_waitcnt vmcnt(7) lgkmcnt(10)
    v_mfma_f32_32x32x16_bf16 v[32:47], v[72:75], v[144:147], v[32:47]
    ds_read_b64_tr_b16 v[72:73], v127 offset:7168
    ds_read_b64_tr_b16 v[74:75], v127 offset:7680
    buffer_load_dwordx4 v[176:179], v108, s[32:35], s90 offen offset:0 sc1
    v_lshlrev_b32 v98, 3, v1
    s_waitcnt lgkmcnt(10)
    v_mfma_f32_32x32x16_bf16 v[48:63], v[144:147], v[76:79], v[48:63]
    ds_read_b64_tr_b16 v[76:77], v127 offset:39936
    ds_read_b64_tr_b16 v[78:79], v127 offset:40448
    s_add_u32 s64, s43, 1
    s_waitcnt vmcnt(7) lgkmcnt(10)
    v_mfma_f32_32x32x16_bf16 v[32:47], v[80:83], v[148:151], v[32:47]
    ds_read_b64_tr_b16 v[80:81], v127 offset:8192
    ds_read_b64_tr_b16 v[82:83], v127 offset:8704
    buffer_load_dwordx4 v[180:183], v108, s[32:35], s90 offen offset:1024 sc1
    s_waitcnt lgkmcnt(10)
    v_mfma_f32_32x32x16_bf16 v[48:63], v[148:151], v[84:87], v[48:63]
    ds_read_b64_tr_b16 v[84:85], v127 offset:40960
    ds_read_b64_tr_b16 v[86:87], v127 offset:41472
    s_waitcnt vmcnt(7) lgkmcnt(10)
    v_mfma_f32_32x32x16_bf16 v[32:47], v[64:67], v[152:155], v[32:47]
    ds_read_b64_tr_b16 v[64:65], v127 offset:9216
    ds_read_b64_tr_b16 v[66:67], v127 offset:9728
    buffer_load_dwordx4 v[184:187], v109, s[32:35], s90 offen offset:0 sc1
    s_waitcnt lgkmcnt(10)
    v_mfma_f32_32x32x16_bf16 v[48:63], v[152:155], v[68:71], v[48:63]
    ds_read_b64_tr_b16 v[68:69], v127 offset:41984
    ds_read_b64_tr_b16 v[70:71], v127 offset:42496
    s_waitcnt vmcnt(7) lgkmcnt(10)
    v_mfma_f32_32x32x16_bf16 v[32:47], v[72:75], v[156:159], v[32:47]
    ds_read_b64_tr_b16 v[72:73], v127 offset:10240
    ds_read_b64_tr_b16 v[74:75], v127 offset:10752
    buffer_load_dwordx4 v[188:191], v109, s[32:35], s90 offen offset:1024 sc1
    s_add_u32 s90, s90, 4096
    s_and_b32 s90, s90, 0x7fff
    s_waitcnt lgkmcnt(10)
    v_mfma_f32_32x32x16_bf16 v[48:63], v[156:159], v[76:79], v[48:63]
    ds_read_b64_tr_b16 v[76:77], v127 offset:43008
    ds_read_b64_tr_b16 v[78:79], v127 offset:43520
    s_waitcnt vmcnt(7) lgkmcnt(10)
    v_mfma_f32_32x32x16_bf16 v[32:47], v[80:83], v[160:163], v[32:47]
    ds_read_b64_tr_b16 v[80:81], v127 offset:11264
    ds_read_b64_tr_b16 v[82:83], v127 offset:11776
    buffer_load_dwordx4 v[192:195], v108, s[32:35], s90 offen offset:0 sc1
    s_waitcnt lgkmcnt(10)
    v_mfma_f32_32x32x16_bf16 v[48:63], v[160:163], v[84:87], v[48:63]
    ds_read_b64_tr_b16 v[84:85], v127 offset:44032
    ds_read_b64_tr_b16 v[86:87], v127 offset:44544
    s_waitcnt vmcnt(7) lgkmcnt(10)
    v_mfma_f32_32x32x16_bf16 v[32:47], v[64:67], v[164:167], v[32:47]
    ds_read_b64_tr_b16 v[64:65], v127 offset:12288
    ds_read_b64_tr_b16 v[66:67], v127 offset:12800
    buffer_load_dwordx4 v[196:199], v108, s[32:35], s90 offen offset:1024 sc1
    s_waitcnt lgkmcnt(10)
    v_mfma_f32_32x32x16_bf16 v[48:63], v[164:167], v[68:71], v[48:63]
    ds_read_b64_tr_b16 v[68:69], v127 offset:45056
    ds_read_b64_tr_b16 v[70:71], v127 offset:45568
    s_waitcnt vmcnt(7) lgkmcnt(10)
    v_mfma_f32_32x32x16_bf16 v[32:47], v[72:75], v[168:171], v[32:47]
    ds_read_b64_tr_b16 v[72:73], v127 offset:13312
    ds_read_b64_tr_b16 v[74:75], v127 offset:13824
    buffer_load_dwordx4 v[200:203], v109, s[32:35], s90 offen offset:0 sc1
    s_waitcnt lgkmcnt(10)
    v_mfma_f32_32x32x16_bf16 v[48:63], v[168:171], v[76:79], v[48:63]
    ds_read_b64_tr_b16 v[76:77], v127 offset:46080
    ds_read_b64_tr_b16 v[78:79], v127 offset:46592
    s_waitcnt vmcnt(7) lgkmcnt(10)
    v_mfma_f32_32x32x16_bf16 v[32:47], v[80:83], v[172:175], v[32:47]
    ds_read_b64_tr_b16 v[80:81], v127 offset:14336
    ds_read_b64_tr_b16 v[82:83], v127 offset:14848
    buffer_load_dwordx4 v[204:207], v109, s[32:35], s90 offen offset:1024 sc1
    s_add_u32 s90, s90, 4096
    s_and_b32 s90, s90, 0x7fff
    s_waitcnt lgkmcnt(10)
    v_mfma_f32_32x32x16_bf16 v[48:63], v[172:175], v[84:87], v[48:63]
    ds_read_b64_tr_b16 v[84:85], v127 offset:47104
    ds_read_b64_tr_b16 v[86:87], v127 offset:47616
    s_waitcnt vmcnt(7) lgkmcnt(10)
    v_mfma_f32_32x32x16_bf16 v[32:47], v[64:67], v[176:179], v[32:47]
    ds_read_b64_tr_b16 v[64:65], v127 offset:15360
    ds_read_b64_tr_b16 v[66:67], v127 offset:15872
    buffer_load_dwordx4 v[208:211], v108, s[32:35], s90 offen offset:0 sc1
    s_waitcnt lgkmcnt(10)
    v_mfma_f32_32x32x16_bf16 v[48:63], v[176:179], v[68:71], v[48:63]
    ds_read_b64_tr_b16 v[68:69], v127 offset:48128
    ds_read_b64_tr_b16 v[70:71], v127 offset:48640
    s_waitcnt vmcnt(7) lgkmcnt(10)
    v_mfma_f32_32x32x16_bf16 v[32:47], v[72:75], v[180:183], v[32:47]
    ds_read_b64_tr_b16 v[72:73], v127 offset:16384
    ds_read_b64_tr_b16 v[74:75], v127 offset:16896
    buffer_load_dwordx4 v[212:215], v108, s[32:35], s90 offen offset:1024 sc1
    s_waitcnt lgkmcnt(10)
    v_mfma_f32_32x32x16_bf16 v[48:63], v[180:183], v[76:79], v[48:63]
    ds_read_b64_tr_b16 v[76:77], v127 offset:49152
    ds_read_b64_tr_b16 v[78:79], v127 offset:49664
    s_waitcnt vmcnt(7) lgkmcnt(10)
    v_mfma_f32_32x32x16_bf16 v[32:47], v[80:83], v[184:187], v[32:47]
    ds_read_b64_tr_b16 v[80:81], v127 offset:17408
    ds_read_b64_tr_b16 v[82:83], v127 offset:17920
    buffer_load_dwordx4 v[216:219], v109, s[32:35], s90 offen offset:0 sc1
    s_waitcnt lgkmcnt(10)
    v_mfma_f32_32x32x16_bf16 v[48:63], v[184:187], v[84:87], v[48:63]
    ds_read_b64_tr_b16 v[84:85], v127 offset:50176
    ds_read_b64_tr_b16 v[86:87], v127 offset:50688
    s_waitcnt vmcnt(7) lgkmcnt(10)
    v_mfma_f32_32x32x16_bf16 v[32:47], v[64:67], v[188:191], v[32:47]
    ds_read_b64_tr_b16 v[64:65], v127 offset:18432
    ds_read_b64_tr_b16 v[66:67], v127 offset:18944
    buffer_load_dwordx4 v[220:223], v109, s[32:35], s90 offen offset:1024 sc1
    s_add_u32 s90, s90, 4096
    s_and_b32 s90, s90, 0x7fff
    s_waitcnt lgkmcnt(10)
    v_mfma_f32_32x32x16_bf16 v[48:63], v[188:191], v[68:71], v[48:63]
    ds_read_b64_tr_b16 v[68:69], v127 offset:51200
    ds_read_b64_tr_b16 v[70:71], v127 offset:51712
    s_waitcnt vmcnt(7) lgkmcnt(10)
    v_mfma_f32_32x32x16_bf16 v[32:47], v[72:75], v[192:195], v[32:47]
    ds_read_b64_tr_b16 v[72:73], v127 offset:19456
    ds_read_b64_tr_b16 v[74:75], v127 offset:19968
    buffer_load_dwordx4 v[224:227], v108, s[32:35], s90 offen offset:0 sc1
    s_waitcnt lgkmcnt(10)
    v_mfma_f32_32x32x16_bf16 v[48:63], v[192:195], v[76:79], v[48:63]
    ds_read_b64_tr_b16 v[76:77], v127 offset:52224
    ds_read_b64_tr_b16 v[78:79], v127 offset:52736
    s_waitcnt vmcnt(7) lgkmcnt(10)
    v_mfma_f32_32x32x16_bf16 v[32:47], v[80:83], v[196:199], v[32:47]
    ds_read_b64_tr_b16 v[80:81], v127 offset:20480
    ds_read_b64_tr_b16 v[82:83], v127 offset:20992
    buffer_load_dwordx4 v[228:231], v108, s[32:35], s90 offen offset:1024 sc1
    s_waitcnt lgkmcnt(10)
    v_mfma_f32_32x32x16_bf16 v[48:63], v[196:199], v[84:87], v[48:63]
    ds_read_b64_tr_b16 v[84:85], v127 offset:53248
    ds_read_b64_tr_b16 v[86:87], v127 offset:53760
    s_waitcnt vmcnt(7) lgkmcnt(10)
    v_mfma_f32_32x32x16_bf16 v[32:47], v[64:67], v[200:203], v[32:47]
    ds_read_b64_tr_b16 v[64:65], v127 offset:21504
    ds_read_b64_tr_b16 v[66:67], v127 offset:22016
    buffer_load_dwordx4 v[232:235], v109, s[32:35], s90 offen offset:0 sc1
    s_waitcnt lgkmcnt(10)
    v_mfma_f32_32x32x16_bf16 v[48:63], v[200:203], v[68:71], v[48:63]
    ds_read_b64_tr_b16 v[68:69], v127 offset:54272
    ds_read_b64_tr_b16 v[70:71], v127 offset:54784
    s_waitcnt vmcnt(7) lgkmcnt(10)
    v_mfma_f32_32x32x16_bf16 v[32:47], v[72:75], v[204:207], v[32:47]
    ds_read_b64_tr_b16 v[72:73], v127 offset:22528
    ds_read_b64_tr_b16 v[74:75], v127 offset:23040
    buffer_load_dwordx4 v[236:239], v109, s[32:35], s90 offen offset:1024 sc1
    s_add_u32 s90, s90, 4096
    s_and_b32 s90, s90, 0x7fff
    s_waitcnt lgkmcnt(10)
    v_mfma_f32_32x32x16_bf16 v[48:63], v[204:207], v[76:79], v[48:63]
    ds_read_b64_tr_b16 v[76:77], v127 offset:55296
    ds_read_b64_tr_b16 v[78:79], v127 offset:55808
    s_waitcnt vmcnt(7) lgkmcnt(10)
    v_mfma_f32_32x32x16_bf16 v[32:47], v[80:83], v[208:211], v[32:47]
    ds_read_b64_tr_b16 v[80:81], v127 offset:23552
    ds_read_b64_tr_b16 v[82:83], v127 offset:24064
    buffer_load_dwordx4 v[240:243], v108, s[32:35], s90 offen offset:0 sc1
    s_waitcnt lgkmcnt(10)
    v_mfma_f32_32x32x16_bf16 v[48:63], v[208:211], v[84:87], v[48:63]
    ds_read_b64_tr_b16 v[84:85], v127 offset:56320
    ds_read_b64_tr_b16 v[86:87], v127 offset:56832
    s_waitcnt vmcnt(7) lgkmcnt(10)
    v_mfma_f32_32x32x16_bf16 v[32:47], v[64:67], v[212:215], v[32:47]
    ds_read_b64_tr_b16 v[64:65], v127 offset:24576
    ds_read_b64_tr_b16 v[66:67], v127 offset:25088
    buffer_load_dwordx4 v[244:247], v108, s[32:35], s90 offen offset:1024 sc1
    s_waitcnt lgkmcnt(10)
    v_mfma_f32_32x32x16_bf16 v[48:63], v[212:215], v[68:71], v[48:63]
    ds_read_b64_tr_b16 v[68:69], v127 offset:57344
    ds_read_b64_tr_b16 v[70:71], v127 offset:57856
    s_waitcnt vmcnt(7) lgkmcnt(10)
    v_mfma_f32_32x32x16_bf16 v[32:47], v[72:75], v[216:219], v[32:47]
    ds_read_b64_tr_b16 v[72:73], v127 offset:25600
    ds_read_b64_tr_b16 v[74:75], v127 offset:26112
    buffer_load_dwordx4 v[248:251], v109, s[32:35], s90 offen offset:0 sc1
    s_waitcnt lgkmcnt(10)
    v_mfma_f32_32x32x16_bf16 v[48:63], v[216:219], v[76:79], v[48:63]
    ds_read_b64_tr_b16 v[76:77], v127 offset:58368
    ds_read_b64_tr_b16 v[78:79], v127 offset:58880
    buffer_load_dwordx2 v[96:97], v98, s[4:7], s47 offen sc1
    s_waitcnt vmcnt(8) lgkmcnt(10)
    v_mfma_f32_32x32x16_bf16 v[32:47], v[80:83], v[220:223], v[32:47]
    ds_read_b64_tr_b16 v[80:81], v127 offset:26624
    ds_read_b64_tr_b16 v[82:83], v127 offset:27136
    buffer_load_dwordx4 v[252:255], v109, s[32:35], s90 offen offset:1024 sc1
    s_waitcnt lgkmcnt(10)
    v_mfma_f32_32x32x16_bf16 v[48:63], v[220:223], v[84:87], v[48:63]
    ds_read_b64_tr_b16 v[84:85], v127 offset:59392
    ds_read_b64_tr_b16 v[86:87], v127 offset:59904
    s_waitcnt vmcnt(8) lgkmcnt(10)
    v_mfma_f32_32x32x16_bf16 v[32:47], v[64:67], v[224:227], v[32:47]
    ds_read_b64_tr_b16 v[64:65], v127 offset:27648
    ds_read_b64_tr_b16 v[66:67], v127 offset:28160
    s_waitcnt lgkmcnt(10)
    v_mfma_f32_32x32x16_bf16 v[48:63], v[224:227], v[68:71], v[48:63]
    ds_read_b64_tr_b16 v[68:69], v127 offset:60416
    ds_read_b64_tr_b16 v[70:71], v127 offset:60928
    s_waitcnt vmcnt(7) lgkmcnt(10)
    v_mfma_f32_32x32x16_bf16 v[32:47], v[72:75], v[228:231], v[32:47]
    ds_read_b64_tr_b16 v[72:73], v127 offset:28672
    ds_read_b64_tr_b16 v[74:75], v127 offset:29184
    s_waitcnt lgkmcnt(10)
    v_mfma_f32_32x32x16_bf16 v[48:63], v[228:231], v[76:79], v[48:63]
    ds_read_b64_tr_b16 v[76:77], v127 offset:61440
    ds_read_b64_tr_b16 v[78:79], v127 offset:61952
    s_waitcnt vmcnt(6) lgkmcnt(10)
    v_mfma_f32_32x32x16_bf16 v[32:47], v[80:83], v[232:235], v[32:47]
    ds_read_b64_tr_b16 v[80:81], v127 offset:29696
    ds_read_b64_tr_b16 v[82:83], v127 offset:30208
    s_waitcnt lgkmcnt(10)
    v_mfma_f32_32x32x16_bf16 v[48:63], v[232:235], v[84:87], v[48:63]
    ds_read_b64_tr_b16 v[84:85], v127 offset:62464
    ds_read_b64_tr_b16 v[86:87], v127 offset:62976
    s_waitcnt vmcnt(5) lgkmcnt(10)
    v_mfma_f32_32x32x16_bf16 v[32:47], v[64:67], v[236:239], v[32:47]
    ds_read_b64_tr_b16 v[64:65], v127 offset:30720
    ds_read_b64_tr_b16 v[66:67], v127 offset:31232
    s_waitcnt lgkmcnt(10)
    v_mfma_f32_32x32x16_bf16 v[48:63], v[236:239], v[68:71], v[48:63]
    ds_read_b64_tr_b16 v[68:69], v127 offset:63488
    ds_read_b64_tr_b16 v[70:71], v127 offset:64000
    s_waitcnt vmcnt(4) lgkmcnt(10)
    v_mfma_f32_32x32x16_bf16 v[32:47], v[72:75], v[240:243], v[32:47]
    ds_read_b64_tr_b16 v[72:73], v127 offset:31744
    ds_read_b64_tr_b16 v[74:75], v127 offset:32256
    s_waitcnt vmcnt(1)
    v_cmp_ne_u32 vcc, s64, v97
    s_cbranch_vccnz Lfin_67
Lfinc_68:
    v_mov_b32 v97, v96
    v_mov_b32 v30, 0
    s_waitcnt lgkmcnt(10)
    v_mfma_f32_32x32x16_bf16 v[48:63], v[240:243], v[76:79], v[48:63]
    ds_read_b64_tr_b16 v[76:77], v127 offset:64512
    ds_read_b64_tr_b16 v[78:79], v127 offset:65024
    v_mov_b32 v31, 0
    v_permlane32_swap_b32 v96, v97
    v_mul_f32 v96, 0x3b000000, v96
    s_waitcnt lgkmcnt(10)
    v_mfma_f32_32x32x16_bf16 v[32:47], v[80:83], v[244:247], v[32:47]
    v_mul_f32 v97, 0x3b000000, v97
    v_fma_f32 v97, -v96, v96, v97
    v_max_f32 v97, 0, v97
    s_waitcnt lgkmcnt(8)
    v_mfma_f32_32x32x16_bf16 v[48:63], v[244:247], v[84:87], v[48:63]
    v_add_f32 v97, 0x3727c5ac, v97
    v_rsq_f32 v20, v97
    v_cndmask_b32 v96, 0, v96, s[60:61]
    s_waitcnt lgkmcnt(6)
    v_mfma_f32_32x32x16_bf16 v[32:47], v[64:67], v[248:251], v[32:47]
    v_and_b32 v98, 0xffff0000, v96
    v_sub_f32 v99, v96, v98
    v_cvt_pk_bf16_f32 v28, -v98, -v98
    s_waitcnt lgkmcnt(4)
    v_mfma_f32_32x32x16_bf16 v[48:63], v[248:251], v[68:71], v[48:63]
    v_cvt_pk_bf16_f32 v29, -v99, 0
    ds_write_b32 v25, v20
    ds_read_b128 v[96:99], v26 offset:0
    s_waitcnt vmcnt(0) lgkmcnt(4)
    v_mfma_f32_32x32x16_bf16 v[32:47], v[72:75], v[252:255], v[32:47]
    ds_read_b128 v[100:103], v26 offset:32
    ds_read_b128 v[104:107], v26 offset:64
    ds_read_b128 v[108:111], v26 offset:96
    s_waitcnt lgkmcnt(5)
    v_mfma_f32_32x32x16_bf16 v[48:63], v[252:255], v[76:79], v[48:63]
    v_mul_f32 v20, s55, v20
    v_mfma_f32_32x32x16_bf16 v[32:47], v[88:91], v[28:31], v[32:47]
    v_mfma_f32_32x32x16_bf16 v[48:63], v[28:31], v[92:95], v[48:63]
    s_waitcnt lgkmcnt(0)
    s_nop 9
    v_cvt_pk_bf16_f32 v116, v40, v41
    v_cvt_pk_bf16_f32 v117, v42, v43
    v_cvt_pk_bf16_f32 v118, v44, v45
    v_cvt_pk_bf16_f32 v119, v46, v47
    ds_write_b128 v21, v[116:119] offset:1024
    ds_write_b32 v120, v121 offset:0
    v_cvt_pk_bf16_f32 v112, v32, v33
    v_cvt_pk_bf16_f32 v113, v34, v35
    v_cvt_pk_bf16_f32 v114, v36, v37
    v_cvt_pk_bf16_f32 v115, v38, v39
    v_pk_mul_f32 v[48:49], v[48:49], v[96:97]
    v_pk_mul_f32 v[50:51], v[50:51], v[98:99]
    v_mfma_f32_32x32x16_bf16 v[32:47], v[16:19], v[112:115], 0
    v_pk_mul_f32 v[52:53], v[52:53], v[100:101]
    v_pk_mul_f32 v[54:55], v[54:55], v[102:103]
    v_pk_mul_f32 v[56:57], v[56:57], v[104:105]
    v_pk_mul_f32 v[58:59], v[58:59], v[106:107]
    v_pk_mul_f32 v[60:61], v[60:61], v[108:109]
    v_pk_mul_f32 v[62:63], v[62:63], v[110:111]
    v_cvt_pk_bf16_f32 v120, v48, v49
    v_cvt_pk_bf16_f32 v121, v50, v51
    v_cvt_pk_bf16_f32 v122, v52, v53
    v_cvt_pk_bf16_f32 v123, v54, v55
    ds_write_b128 v21, v[120:123] offset:2048
    v_cvt_pk_bf16_f32 v124, v56, v57
    v_cvt_pk_bf16_f32 v125, v58, v59
    v_cvt_pk_bf16_f32 v126, v60, v61
    v_cvt_pk_bf16_f32 v127, v62, v63
    ds_write_b128 v21, v[124:127] offset:3072
    s_branch L_j0_1
L_aux_1:
    v_mov_b32 v23, 1
    s_mov_b64 exec, 1
    s_waitcnt lgkmcnt(0)
    ds_add_u32 v4, v23 offset:40
    s_mov_b64 exec, -1
    s_cmp_lg_u32 s39, 3
    s_cbranch_scc1 Lx_69
    s_lshl_b32 s46, s37, 10
    s_add_u32 s46, s46, (L_main_2 - interleave_layers__sliding_block__linear_kernel_hedgehog__prompt_kernel)
    s_cmp_ge_u32 s46, (L_end - interleave_layers__sliding_block__linear_kernel_hedgehog__prompt_kernel - 1088)
    s_cbranch_scc1 Lx_69
    v_add_u32 v28, s46, v2
    v_mov_b32 v29, s85
    v_add_co_u32 v28, vcc, s84, v28
    s_nop 1
    v_addc_co_u32 v29, vcc, 0, v29, vcc
    global_load_dword v26, v[28:29], off
Lx_69:
    v_add_u32 v29, 98304, v11
    ds_read_b64_tr_b16 v[224:225], v29 offset:0
    ds_read_b64_tr_b16 v[226:227], v29 offset:512
    ds_read_b64_tr_b16 v[228:229], v29 offset:1024
    ds_read_b64_tr_b16 v[230:231], v29 offset:1536
    ds_read_b64_tr_b16 v[232:233], v29 offset:8192
    ds_read_b64_tr_b16 v[234:235], v29 offset:8704
    ds_read_b64_tr_b16 v[236:237], v29 offset:9216
    ds_read_b64_tr_b16 v[238:239], v29 offset:9728
    ds_read_b64_tr_b16 v[240:241], v29 offset:16384
    ds_read_b64_tr_b16 v[242:243], v29 offset:16896
    ds_read_b64_tr_b16 v[244:245], v29 offset:17408
    ds_read_b64_tr_b16 v[246:247], v29 offset:17920
    ds_read_b64_tr_b16 v[248:249], v29 offset:24576
    ds_read_b64_tr_b16 v[250:251], v29 offset:25088
    ds_read_b64_tr_b16 v[252:253], v29 offset:25600
    ds_read_b64_tr_b16 v[254:255], v29 offset:26112
    s_waitcnt vmcnt(0) lgkmcnt(0)
    s_lshl_b32 s46, s39, 2
    s_add_u32 s46, s46, 157184
    v_and_b32 v28, 31, v1
    v_lshl_add_u32 v28, v28, 4, s46
    v_add_u32 v29, 65536, v11
    ds_read_b64_tr_b16 v[64:65], v29 offset:0
    ds_read_b64_tr_b16 v[66:67], v29 offset:512
    ds_read_b64_tr_b16 v[68:69], v29 offset:1024
    ds_read_b64_tr_b16 v[70:71], v29 offset:1536
    ds_read_b64_tr_b16 v[72:73], v29 offset:8192
    ds_read_b64_tr_b16 v[74:75], v29 offset:8704
    ds_read_b64_tr_b16 v[76:77], v29 offset:9216
    ds_read_b64_tr_b16 v[78:79], v29 offset:9728
    s_waitcnt lgkmcnt(6)
    v_mfma_f32_32x32x16_bf16 v[32:47], v[12:15], v[64:67], 0
    s_waitcnt lgkmcnt(4)
    v_mfma_f32_32x32x16_bf16 v[32:47], v[12:15], v[68:71], v[32:47]
    s_waitcnt lgkmcnt(2)
    v_mfma_f32_32x32x16_bf16 v[32:47], v[12:15], v[72:75], v[32:47]
    s_waitcnt lgkmcnt(0)
    v_mfma_f32_32x32x16_bf16 v[32:47], v[12:15], v[76:79], v[32:47]
    ds_read_b64_tr_b16 v[80:81], v29 offset:16384
    ds_read_b64_tr_b16 v[82:83], v29 offset:16896
    ds_read_b64_tr_b16 v[84:85], v29 offset:17408
    ds_read_b64_tr_b16 v[86:87], v29 offset:17920
    ds_read_b64_tr_b16 v[88:89], v29 offset:24576
    ds_read_b64_tr_b16 v[90:91], v29 offset:25088
    ds_read_b64_tr_b16 v[92:93], v29 offset:25600
    ds_read_b64_tr_b16 v[94:95], v29 offset:26112
    s_waitcnt lgkmcnt(6)
    v_mfma_f32_32x32x16_bf16 v[32:47], v[12:15], v[80:83], v[32:47]
    s_waitcnt lgkmcnt(4)
    v_mfma_f32_32x32x16_bf16 v[32:47], v[12:15], v[84:87], v[32:47]
    s_waitcnt lgkmcnt(2)
    v_mfma_f32_32x32x16_bf16 v[32:47], v[12:15], v[88:91], v[32:47]
    s_waitcnt lgkmcnt(0)
    v_mfma_f32_32x32x16_bf16 v[32:47], v[12:15], v[92:95], v[32:47]
    s_nop 11
    ds_write_b32 v28, v32 offset:0
    s_waitcnt lgkmcnt(0)
    v_mov_b32 v96, v12
    v_mov_b32 v97, v12
    v_mov_b32 v98, v12
    v_mov_b32 v99, v12
    v_mov_b32 v100, v12
    v_mov_b32 v101, v12
    v_mov_b32 v102, v12
    v_mov_b32 v103, v12
    v_mov_b32 v104, v12
    v_mov_b32 v105, v12
    v_mov_b32 v106, v12
    v_mov_b32 v107, v12
    v_mov_b32 v108, v12
    v_mov_b32 v109, v12
    v_mov_b32 v110, v12
    v_mov_b32 v111, v12
    v_mov_b32 v112, v12
    v_mov_b32 v113, v12
    v_mov_b32 v114, v12
    v_mov_b32 v115, v12
    v_mov_b32 v116, v12
    v_mov_b32 v117, v12
    v_mov_b32 v118, v12
    v_mov_b32 v119, v12
    v_mov_b32 v120, v12
    v_mov_b32 v121, v12
    v_mov_b32 v122, v12
    v_mov_b32 v123, v12
    v_mov_b32 v124, v12
    v_mov_b32 v125, v12
    v_mov_b32 v126, v12
    v_mov_b32 v127, v12
    v_lshrrev_b32 v91, 5, v1
    v_bfe_u32 v88, v1, 2, 2
    v_lshl_add_u32 v88, v91, 2, v88
    v_lshlrev_b32 v88, 5, v88
    v_and_b32 v89, 1, v1
    v_lshl_add_u32 v88, v89, 4, v88
    v_bfe_u32 v89, v1, 4, 1
    v_lshl_add_u32 v88, v89, 12, v88
    v_bfe_u32 v89, v1, 1, 1
    v_lshl_add_u32 v88, v89, 3, v88
    s_lshl_b32 s46, s39, 10
    s_add_u32 s46, s46, 131072
    v_add_u32 v88, s46, v88
    s_lshl_b32 s47, s39, 8
    v_xor_b32 v90, s47, v2
    v_add_u32 v89, 131072, v90
    s_lshl_b32 s46, s39, 1
    v_add_u32 v91, s46, v91
    v_and_b32 v92, 31, v1
    v_mov_b32 v93, 0x4000000
    v_cmp_eq_u32 vcc, 16, v92
    s_nop 1
    v_cndmask_b32 v91, v93, v91, vcc
    v_lshrrev_b32 v92, 8, v90
    v_mul_u32_u24 v92, 640, v92
    v_and_b32 v93, 15, v1
    v_lshl_add_u32 v90, v93, 4, v92
    v_lshl_add_u32 v92, v93, 2, v92
    v_lshlrev_b32 v93, 4, v91
    v_add_u32 v93, 2560, v93
    v_lshlrev_b32 v91, 4, v91
    v_add_u32 v91, 64, v91
    v_cndmask_b32 v91, v91, v92, s[50:51]
    v_cndmask_b32 v90, v93, v90, s[50:51]
    v_add_u32 v93, 64, v93
    v_add_u32 v92, 256, v90
    v_cndmask_b32 v93, v93, v92, s[50:51]
    s_lshl_b32 s93, s37, 4
    s_add_u32 s93, s93, s36
    s_mul_i32 s93, s93, 2688
    s_add_u32 s93, s93, 28311552
    s_lshl_b32 s47, s40, 10
    s_add_u32 s47, s47, s78
    v_add_u32 v21, s47, v2
    s_lshl_b32 s47, s40, 8
    v_xor_b32 v22, s47, v2
    v_add_u32 v22, s78, v22
    v_sub_u32 v22, v21, v2
    v_and_b32 v23, 31, v1
    v_lshl_add_u32 v22, v23, 5, v22
    v_lshrrev_b32 v23, 5, v1
    v_lshl_add_u32 v22, v23, 4, v22
    s_lshl_b32 s46, s42, 7
    s_add_u32 s46, s46, 158720
    v_and_b32 v25, 124, v3
    v_add_u32 v25, s46, v25
    s_lshl_b32 s46, s39, 2
    s_cmp_lg_u32 s46, s37
    s_cbranch_scc1 Lx_70
    s_setprio 3
    v_and_b32 v24, 60, v3
    s_add_u32 s48, s82, 12288
    s_add_u32 s46, s43, 0
    s_lshr_b32 s47, s83, 3
    s_add_u32 s47, s47, 1048576
    s_lshr_b32 s49, s83, 6
    s_add_u32 s49, s49, 73728
    v_and_b32 v82, 15, v1
    v_lshrrev_b32 v81, 4, v1
    v_lshl_add_u32 v82, v82, 2, v81
    v_lshlrev_b32 v82, 3, v82
    v_add_u32 v81, s43, 1
Lpoll_73:
    buffer_load_dword v23, v24, s[4:7], s48 offen sc1
    s_waitcnt vmcnt(0)
    v_cmp_ne_u32 vcc, s46, v23
    s_cbranch_vccz Lpolld_74
    s_sleep 1
    s_sub_u32 s45, s45, 1
    s_cbranch_scc0 Lpoll_73
    s_mov_b32 s45, 0
Lpolld_74:
Lred_71:
    buffer_load_dwordx4 v[64:67], v2, s[4:7], s47 offen offset:0 sc1
    buffer_load_dwordx4 v[68:71], v2, s[4:7], s47 offen offset:1024 sc1
    buffer_load_dwordx4 v[72:75], v2, s[4:7], s47 offen offset:2048 sc1
    buffer_load_dwordx4 v[76:79], v2, s[4:7], s47 offen offset:3072 sc1
    v_mov_b32 v23, 1
    s_waitcnt vmcnt(3)
    v_bitop3_b32 v23, v23, v64, v65 bitop3:0x80
    v_bitop3_b32 v23, v23, v66, v67 bitop3:0x80
    s_waitcnt vmcnt(2)
    v_bitop3_b32 v23, v23, v68, v69 bitop3:0x80
    v_bitop3_b32 v23, v23, v70, v71 bitop3:0x80
    v_add_f32 v64, v64, v68
    v_add_f32 v65, v65, v69
    v_add_f32 v66, v66, v70
    v_add_f32 v67, v67, v71
    s_waitcnt vmcnt(1)
    v_bitop3_b32 v23, v23, v72, v73 bitop3:0x80
    v_bitop3_b32 v23, v23, v74, v75 bitop3:0x80
    v_add_f32 v64, v64, v72
    v_add_f32 v65, v65, v73
    v_add_f32 v66, v66, v74
    v_add_f32 v67, v67, v75
    s_waitcnt vmcnt(0)
    v_bitop3_b32 v23, v23, v76, v77 bitop3:0x80
    v_bitop3_b32 v23, v23, v78, v79 bitop3:0x80
    v_add_f32 v64, v64, v76
    v_add_f32 v65, v65, v77
    v_add_f32 v66, v66, v78
    v_add_f32 v67, v67, v79
    v_and_b32 v23, 1, v23
    v_cmp_ne_u32 vcc, 1, v23
    v_permlane32_swap_b32 v64, v66
    v_permlane32_swap_b32 v65, v67
    v_add_f32 v64, v64, v66
    v_add_f32 v65, v65, v67
    s_nop 1
    v_permlane16_swap_b32 v64, v65
    v_add_f32 v80, v64, v65
    s_cbranch_vccz Lredd_72
    s_sub_u32 s45, s45, 1
    s_cbranch_scc0 Lred_71
    s_mov_b32 s45, 0
Lredd_72:
    s_cmp_eq_u32 s44, 0
    s_cbranch_scc1 Lsafe_75
    buffer_store_dwordx2 v[80:81], v82, s[4:7], s49 offen
Lpub_76:
    s_setprio 0
Lx_70:
    s_lshl_b32 s46, s42, 2
    v_add_u32 v26, s46, v4
Lpw_77:
    s_sleep 2
    ds_read_b32 v23, v26 offset:0
    ds_read_b128 v[72:75], v21
    ds_read_b32 v20, v25
    s_waitcnt lgkmcnt(1)
    v_cmp_gt_u32 vcc, 6, v23
    s_cbranch_vccnz Lpw_77
    v_mfma_f32_32x32x16_bf16 v[32:47], v[16:19], v[72:75], 0
    s_waitcnt lgkmcnt(0)
    v_mul_f32 v20, s55, v20
    s_nop 7
L_j0_1:
    s_nop 1
    v_max3_f32 v76, v32, v33, v34
    v_max3_f32 v77, v35, v36, v37
    v_max3_f32 v78, v38, v39, v40
    v_max3_f32 v79, v41, v42, v43
    v_max3_f32 v76, v76, v44, v45
    v_max3_f32 v77, v77, v46, v47
    v_max3_f32 v76, v76, v78, v79
    v_max_f32 v76, v76, v77
    v_mul_f32 v76, v20, v76
    v_pk_fma_f32 v[32:33], v[32:33], v[20:21], v[76:77] op_sel_hi:[1,0,0] neg_lo:[0,0,1] neg_hi:[0,0,1]
    v_pk_fma_f32 v[34:35], v[34:35], v[20:21], v[76:77] op_sel_hi:[1,0,0] neg_lo:[0,0,1] neg_hi:[0,0,1]
    v_exp_f32 v32, v32
    v_pk_fma_f32 v[36:37], v[36:37], v[20:21], v[76:77] op_sel_hi:[1,0,0] neg_lo:[0,0,1] neg_hi:[0,0,1]
    v_exp_f32 v33, v33
    v_exp_f32 v34, v34
    v_pk_fma_f32 v[38:39], v[38:39], v[20:21], v[76:77] op_sel_hi:[1,0,0] neg_lo:[0,0,1] neg_hi:[0,0,1]
    v_exp_f32 v35, v35
    v_exp_f32 v36, v36
    v_pk_fma_f32 v[40:41], v[40:41], v[20:21], v[76:77] op_sel_hi:[1,0,0] neg_lo:[0,0,1] neg_hi:[0,0,1]
    v_exp_f32 v37, v37
    v_pk_add_f32 v[78:79], v[32:33], v[34:35]
    v_exp_f32 v38, v38
    v_pk_fma_f32 v[42:43], v[42:43], v[20:21], v[76:77] op_sel_hi:[1,0,0] neg_lo:[0,0,1] neg_hi:[0,0,1]
    v_exp_f32 v39, v39
    v_pk_add_f32 v[78:79], v[78:79], v[36:37]
    v_exp_f32 v40, v40
    v_pk_fma_f32 v[44:45], v[44:45], v[20:21], v[76:77] op_sel_hi:[1,0,0] neg_lo:[0,0,1] neg_hi:[0,0,1]
    v_exp_f32 v41, v41
    v_pk_add_f32 v[78:79], v[78:79], v[38:39]
    v_exp_f32 v42, v42
    v_pk_fma_f32 v[46:47], v[46:47], v[20:21], v[76:77] op_sel_hi:[1,0,0] neg_lo:[0,0,1] neg_hi:[0,0,1]
    v_exp_f32 v43, v43
    v_pk_add_f32 v[78:79], v[78:79], v[40:41]
    v_exp_f32 v44, v44
    v_exp_f32 v45, v45
    v_pk_add_f32 v[78:79], v[78:79], v[42:43]
    v_exp_f32 v46, v46
    v_exp_f32 v47, v47
    v_pk_add_f32 v[78:79], v[78:79], v[44:45]
    v_pk_add_f32 v[78:79], v[78:79], v[46:47]
    v_add_f32 v78, v78, v79
    v_rcp_f32 v76, v78
    s_nop 0
    v_pk_mul_f32 v[32:33], v[32:33], v[76:77] op_sel_hi:[1,0]
    v_pk_mul_f32 v[34:35], v[34:35], v[76:77] op_sel_hi:[1,0]
    v_pk_mul_f32 v[36:37], v[36:37], v[76:77] op_sel_hi:[1,0]
    v_pk_mul_f32 v[38:39], v[38:39], v[76:77] op_sel_hi:[1,0]
    v_pk_mul_f32 v[40:41], v[40:41], v[76:77] op_sel_hi:[1,0]
    v_pk_mul_f32 v[42:43], v[42:43], v[76:77] op_sel_hi:[1,0]
    v_pk_mul_f32 v[44:45], v[44:45], v[76:77] op_sel_hi:[1,0]
    v_pk_mul_f32 v[46:47], v[46:47], v[76:77] op_sel_hi:[1,0]
    v_cvt_pk_bf16_f32 v64, v32, v33
    v_cvt_pk_bf16_f32 v65, v34, v35
    v_cvt_pk_bf16_f32 v66, v36, v37
    v_cvt_pk_bf16_f32 v67, v38, v39
    v_cvt_pk_bf16_f32 v68, v40, v41
    v_cvt_pk_bf16_f32 v69, v42, v43
    v_cvt_pk_bf16_f32 v70, v44, v45
    v_cvt_pk_bf16_f32 v71, v46, v47
Lpw_78:
    ds_write_b128 v22, v[64:67]
    ds_write_b128 v22, v[68:71] offset:4096
    s_waitcnt lgkmcnt(0)
    s_barrier
    s_cmp_lg_u32 s40, 0
    s_cbranch_scc1 L_ax1_1
    ds_read_b64_tr_b16 v[64:65], v5 offset:0
    ds_read_b64_tr_b16 v[66:67], v5 offset:512
    ds_read_b64_tr_b16 v[68:69], v5 offset:1024
    ds_read_b64_tr_b16 v[70:71], v5 offset:1536
    ds_read_b64_tr_b16 v[72:73], v5 offset:2048
    ds_read_b64_tr_b16 v[74:75], v5 offset:2560
    ds_read_b64_tr_b16 v[76:77], v5 offset:3072
    ds_read_b64_tr_b16 v[78:79], v5 offset:3584
    ds_read_b64_tr_b16 v[80:81], v5 offset:4096
    ds_read_b64_tr_b16 v[82:83], v5 offset:4608
    s_waitcnt lgkmcnt(8)
    v_mfma_f32_32x32x16_bf16 v[48:63], v[64:67], v[128:131], 0
    ds_read_b64_tr_b16 v[64:65], v5 offset:5120
    ds_read_b64_tr_b16 v[66:67], v5 offset:5632
    ds_read_b128 v[84:87], v0
    s_add_u32 s91, s72, 10485760
    s_waitcnt lgkmcnt(9)
    v_mfma_f32_32x32x16_bf16 v[48:63], v[68:71], v[132:135], v[48:63]
    ds_read_b64_tr_b16 v[68:69], v5 offset:6144
    ds_read_b64_tr_b16 v[70:71], v5 offset:6656
    s_add_u32 s92, s73, 36864
    s_mul_i32 s96, s37, 43008
    s_waitcnt lgkmcnt(9)
    v_mfma_f32_32x32x16_bf16 v[48:63], v[72:75], v[136:139], v[48:63]
    ds_read_b64_tr_b16 v[72:73], v5 offset:7168
    ds_read_b64_tr_b16 v[74:75], v5 offset:7680
    s_add_u32 s96, s96, 28311552
    s_mov_b32 s94, 0x3f80
    s_waitcnt lgkmcnt(9)
    v_mfma_f32_32x32x16_bf16 v[48:63], v[76:79], v[140:143], v[48:63]
    ds_read_b64_tr_b16 v[76:77], v5 offset:8192
    ds_read_b64_tr_b16 v[78:79], v5 offset:8704
    s_mov_b32 s95, 0x3f800000
    s_lshl_b32 s46, s40, 4
    s_waitcnt lgkmcnt(9)
    v_mfma_f32_32x32x16_bf16 v[48:63], v[80:83], v[144:147], v[48:63]
    ds_read_b64_tr_b16 v[80:81], v5 offset:9216
    ds_read_b64_tr_b16 v[82:83], v5 offset:9728
    v_xor_b32 v99, s46, v1
    v_lshlrev_b32 v99, 5, v99
    s_waitcnt lgkmcnt(9)
    v_mfma_f32_32x32x16_bf16 v[48:63], v[64:67], v[148:151], v[48:63]
    ds_read_b64_tr_b16 v[64:65], v5 offset:10240
    ds_read_b64_tr_b16 v[66:67], v5 offset:10752
    v_add_u32 v99, 159232, v99
    v_and_b32 v100, 32, v1
    s_waitcnt lgkmcnt(8)
    v_mfma_f32_32x32x16_bf16 v[48:63], v[68:71], v[152:155], v[48:63]
    ds_read_b64_tr_b16 v[68:69], v5 offset:11264
    ds_read_b64_tr_b16 v[70:71], v5 offset:11776
    s_lshl_b32 s46, s40, 6
    s_add_u32 s46, s46, 161280
    s_waitcnt lgkmcnt(8)
    v_mfma_f32_32x32x16_bf16 v[48:63], v[72:75], v[156:159], v[48:63]
    ds_read_b64_tr_b16 v[72:73], v5 offset:12288
    ds_read_b64_tr_b16 v[74:75], v5 offset:12800
    v_add_u32 v100, s46, v100
    v_cndmask_b32 v99, v100, v99, s[50:51]
    s_waitcnt lgkmcnt(8)
    v_mfma_f32_32x32x16_bf16 v[48:63], v[76:79], v[160:163], v[48:63]
    ds_read_b64_tr_b16 v[76:77], v5 offset:13312
    ds_read_b64_tr_b16 v[78:79], v5 offset:13824
    s_mul_i32 s97, s39, 640
    s_add_u32 s97, s97, s96
    s_waitcnt lgkmcnt(8)
    v_mfma_f32_32x32x16_bf16 v[48:63], v[80:83], v[164:167], v[48:63]
    ds_read_b64_tr_b16 v[80:81], v5 offset:14336
    ds_read_b64_tr_b16 v[82:83], v5 offset:14848
    v_lshrrev_b32 v100, 4, v1
    v_and_b32 v101, 15, v1
    s_waitcnt lgkmcnt(8)
    v_mfma_f32_32x32x16_bf16 v[48:63], v[64:67], v[168:171], v[48:63]
    ds_read_b64_tr_b16 v[64:65], v5 offset:15360
    ds_read_b64_tr_b16 v[66:67], v5 offset:15872
    v_mul_u32_u24 v96, 2688, v100
    v_lshl_add_u32 v97, v101, 2, v96
    s_waitcnt lgkmcnt(8)
    v_mfma_f32_32x32x16_bf16 v[48:63], v[68:71], v[172:175], v[48:63]
    ds_read_b64_tr_b16 v[68:69], v5 offset:16384
    ds_read_b64_tr_b16 v[70:71], v5 offset:16896
    v_lshl_add_u32 v96, v101, 4, v96
    s_lshl_b32 s46, s39, 9
    s_waitcnt lgkmcnt(8)
    v_mfma_f32_32x32x16_bf16 v[48:63], v[72:75], v[176:179], v[48:63]
    ds_read_b64_tr_b16 v[72:73], v5 offset:17408
    ds_read_b64_tr_b16 v[74:75], v5 offset:17920
    s_add_u32 s46, s46, 159232
    v_lshl_add_u32 v98, v101, 5, s46
    s_waitcnt lgkmcnt(8)
    v_mfma_f32_32x32x16_bf16 v[48:63], v[76:79], v[180:183], v[48:63]
    ds_read_b64_tr_b16 v[76:77], v5 offset:18432
    ds_read_b64_tr_b16 v[78:79], v5 offset:18944
    v_lshl_add_u32 v98, v100, 3, v98
    v_lshlrev_b32 v100, 4, v1
    s_waitcnt lgkmcnt(8)
    v_mfma_f32_32x32x16_bf16 v[48:63], v[80:83], v[184:187], v[48:63]
    ds_read_b64_tr_b16 v[80:81], v5 offset:19456
    ds_read_b64_tr_b16 v[82:83], v5 offset:19968
    v_lshlrev_b32 v100, v100, s94
    v_lshrrev_b32 v101, 1, v101
    s_waitcnt lgkmcnt(8)
    v_mfma_f32_32x32x16_bf16 v[48:63], v[64:67], v[188:191], v[48:63]
    ds_read_b64_tr_b16 v[64:65], v5 offset:20480
    ds_read_b64_tr_b16 v[66:67], v5 offset:20992
    v_cmp_eq_u32 vcc, 0, v101
    s_nop 1
    v_cndmask_b32 v104, 0, v100, vcc
    v_cmp_eq_u32 vcc, 1, v101
    s_nop 1
    v_cndmask_b32 v105, 0, v100, vcc
    s_waitcnt lgkmcnt(8)
    v_mfma_f32_32x32x16_bf16 v[48:63], v[68:71], v[192:195], v[48:63]
    ds_read_b64_tr_b16 v[68:69], v5 offset:21504
    ds_read_b64_tr_b16 v[70:71], v5 offset:22016
    v_cmp_eq_u32 vcc, 2, v101
    s_nop 1
    v_cndmask_b32 v106, 0, v100, vcc
    v_cmp_eq_u32 vcc, 3, v101
    s_nop 1
    v_cndmask_b32 v107, 0, v100, vcc
    s_waitcnt lgkmcnt(8)
    v_mfma_f32_32x32x16_bf16 v[48:63], v[72:75], v[196:199], v[48:63]
    ds_read_b64_tr_b16 v[72:73], v5 offset:22528
    ds_read_b64_tr_b16 v[74:75], v5 offset:23040
    v_cmp_eq_u32 vcc, 4, v101
    s_nop 1
    v_cndmask_b32 v108, 0, v100, vcc
    v_cmp_eq_u32 vcc, 5, v101
    s_nop 1
    v_cndmask_b32 v109, 0, v100, vcc
    s_waitcnt lgkmcnt(8)
    v_mfma_f32_32x32x16_bf16 v[48:63], v[76:79], v[200:203], v[48:63]
    ds_read_b64_tr_b16 v[76:77], v5 offset:23552
    ds_read_b64_tr_b16 v[78:79], v5 offset:24064
    v_cmp_eq_u32 vcc, 6, v101
    s_nop 1
    v_cndmask_b32 v110, 0, v100, vcc
    v_cmp_eq_u32 vcc, 7, v101
    s_nop 1
    v_cndmask_b32 v111, 0, v100, vcc
    s_waitcnt lgkmcnt(8)
    v_mfma_f32_32x32x16_bf16 v[48:63], v[80:83], v[204:207], v[48:63]
    ds_read_b64_tr_b16 v[80:81], v5 offset:24576
    ds_read_b64_tr_b16 v[82:83], v5 offset:25088
    v_add_f32 v84, v84, v85
    v_add_f32 v86, v86, v87
    s_waitcnt lgkmcnt(8)
    v_mfma_f32_32x32x16_bf16 v[48:63], v[64:67], v[208:211], v[48:63]
    ds_read_b64_tr_b16 v[64:65], v5 offset:25600
    ds_read_b64_tr_b16 v[66:67], v5 offset:26112
    v_add_f32 v84, v84, v86
    v_and_b32 v86, 0xffff0000, v84
    s_waitcnt lgkmcnt(8)
    v_mfma_f32_32x32x16_bf16 v[48:63], v[68:71], v[212:215], v[48:63]
    ds_read_b64_tr_b16 v[68:69], v5 offset:26624
    ds_read_b64_tr_b16 v[70:71], v5 offset:27136
    v_sub_f32 v87, v84, v86
    v_cvt_pk_bf16_f32 v84, v86, v87
    s_waitcnt lgkmcnt(8)
    v_mfma_f32_32x32x16_bf16 v[48:63], v[72:75], v[216:219], v[48:63]
    ds_read_b64_tr_b16 v[72:73], v5 offset:27648
    ds_read_b64_tr_b16 v[74:75], v5 offset:28160
    v_cvt_pk_bf16_f32 v85, v86, 0
    v_mov_b32 v86, 0
    s_waitcnt lgkmcnt(8)
    v_mfma_f32_32x32x16_bf16 v[48:63], v[76:79], v[220:223], v[48:63]
    ds_read_b64_tr_b16 v[76:77], v5 offset:28672
    ds_read_b64_tr_b16 v[78:79], v5 offset:29184
    v_mov_b32 v87, 0
    s_waitcnt lgkmcnt(8)
    v_mfma_f32_32x32x16_bf16 v[48:63], v[80:83], v[224:227], v[48:63]
    ds_read_b64_tr_b16 v[80:81], v5 offset:29696
    ds_read_b64_tr_b16 v[82:83], v5 offset:30208
    s_waitcnt lgkmcnt(8)
    v_mfma_f32_32x32x16_bf16 v[48:63], v[64:67], v[228:231], v[48:63]
    ds_read_b64_tr_b16 v[64:65], v5 offset:30720
    ds_read_b64_tr_b16 v[66:67], v5 offset:31232
    s_waitcnt lgkmcnt(8)
    v_mfma_f32_32x32x16_bf16 v[48:63], v[68:71], v[232:235], v[48:63]
    ds_read_b64_tr_b16 v[68:69], v5 offset:31744
    ds_read_b64_tr_b16 v[70:71], v5 offset:32256
    s_waitcnt lgkmcnt(8)
    v_mfma_f32_32x32x16_bf16 v[48:63], v[72:75], v[236:239], v[48:63]
    s_waitcnt lgkmcnt(6)
    v_mfma_f32_32x32x16_bf16 v[48:63], v[76:79], v[240:243], v[48:63]
    s_waitcnt lgkmcnt(4)
    v_mfma_f32_32x32x16_bf16 v[48:63], v[80:83], v[244:247], v[48:63]
    s_waitcnt lgkmcnt(2)
    v_mfma_f32_32x32x16_bf16 v[48:63], v[64:67], v[248:251], v[48:63]
    s_waitcnt lgkmcnt(0)
    v_mfma_f32_32x32x16_bf16 v[48:63], v[68:71], v[252:255], v[48:63]
    v_mfma_f32_32x32x16_bf16 v[48:63], v[84:87], v[28:31], v[48:63]
    s_nop 11
    v_cvt_pk_bf16_f32 v76, v56, v57
    v_cvt_pk_bf16_f32 v77, v58, v59
    v_cvt_pk_bf16_f32 v78, v60, v61
    v_cvt_pk_bf16_f32 v79, v62, v63
    s_barrier
    ds_write_b128 v21, v[76:79] offset:5120
    v_cvt_pk_bf16_f32 v72, v48, v49
    v_cvt_pk_bf16_f32 v73, v50, v51
    v_cvt_pk_bf16_f32 v74, v52, v53
    v_cvt_pk_bf16_f32 v75, v54, v55
    s_nop 1
    v_mfma_f32_32x32x16_bf16 v[32:47], v[16:19], v[72:75], 0
    s_waitcnt lgkmcnt(0)
    s_barrier
    s_branch L_j1_1
L_ax1_1:
    s_cmp_ge_u32 s39, 2
    s_cbranch_scc1 L_ax1b_1
    s_setprio 3
    s_mov_b64 exec, s[50:51]
    ds_read_b128 v[96:99], v89 offset:2048
    ds_read_b128 v[100:103], v89 offset:3072
    ds_read_b128 v[104:107], v89 offset:8192
    ds_read_b128 v[108:111], v89 offset:9216
    ds_read_b128 v[112:115], v89 offset:14336
    ds_read_b128 v[116:119], v89 offset:15360
    ds_read_b128 v[120:123], v89 offset:20480
    ds_read_b128 v[124:127], v89 offset:21504
    s_mov_b64 exec, -1
    ds_read_b64_tr_b16 v[48:49], v88 offset:0
    ds_read_b64_tr_b16 v[50:51], v88 offset:256
    ds_read_b64_tr_b16 v[52:53], v88 offset:512
    ds_read_b64_tr_b16 v[54:55], v88 offset:768
    ds_read_b64_tr_b16 v[56:57], v88 offset:6144
    ds_read_b64_tr_b16 v[58:59], v88 offset:6400
    ds_read_b64_tr_b16 v[60:61], v88 offset:6656
    ds_read_b64_tr_b16 v[62:63], v88 offset:6912
    s_waitcnt lgkmcnt(6)
    v_mfma_f32_32x32x16_bf16 v[32:47], v[48:51], v[96:99], 0
    ds_read_b64_tr_b16 v[64:65], v88 offset:12288
    ds_read_b64_tr_b16 v[66:67], v88 offset:12544
    s_waitcnt lgkmcnt(6)
    v_mfma_f32_32x32x16_bf16 v[32:47], v[52:55], v[100:103], v[32:47]
    ds_read_b64_tr_b16 v[68:69], v88 offset:12800
    ds_read_b64_tr_b16 v[70:71], v88 offset:13056
    s_waitcnt lgkmcnt(6)
    v_mfma_f32_32x32x16_bf16 v[32:47], v[56:59], v[104:107], v[32:47]
    ds_read_b64_tr_b16 v[72:73], v88 offset:18432
    ds_read_b64_tr_b16 v[74:75], v88 offset:18688
    s_waitcnt lgkmcnt(6)
    v_mfma_f32_32x32x16_bf16 v[32:47], v[60:63], v[108:111], v[32:47]
    ds_read_b64_tr_b16 v[76:77], v88 offset:18944
    ds_read_b64_tr_b16 v[78:79], v88 offset:19200
    s_waitcnt lgkmcnt(6)
    v_mfma_f32_32x32x16_bf16 v[32:47], v[64:67], v[112:115], v[32:47]
    s_waitcnt lgkmcnt(4)
    v_mfma_f32_32x32x16_bf16 v[32:47], v[68:71], v[116:119], v[32:47]
    s_waitcnt lgkmcnt(2)
    v_mfma_f32_32x32x16_bf16 v[32:47], v[72:75], v[120:123], v[32:47]
    s_waitcnt lgkmcnt(0)
    v_mfma_f32_32x32x16_bf16 v[32:47], v[76:79], v[124:127], v[32:47]
    s_nop 11
    v_cvt_pk_bf16_f32 v80, v32, v33
    v_cvt_pk_bf16_f32 v81, v34, v35
    v_cvt_pk_bf16_f32 v82, v36, v37
    v_cvt_pk_bf16_f32 v83, v38, v39
    v_cvt_pk_bf16_f32 v84, v40, v41
    v_cvt_pk_bf16_f32 v85, v42, v43
    v_cvt_pk_bf16_f32 v86, v44, v45
    v_cvt_pk_bf16_f32 v87, v46, v47
    buffer_store_dwordx4 v[80:83], v90, s[4:7], s93 offen sc1
    buffer_store_dwordx4 v[84:87], v93, s[4:7], s93 offen sc1
    v_add3_u32 v92, s43, v80, v81
    v_add3_u32 v92, v92, v82, v83
    v_add3_u32 v92, v92, v84, v85
    v_add3_u32 v92, v92, v86, v87
    buffer_store_dword v92, v91, s[4:7], s93 offen offset:512 sc1
    s_setprio 0
L_ax1b_1:
    s_add_u32 s46, s62, 0
    s_and_b32 s46, s46, 0x7ffff
    s_add_u32 s49, s3, 0
    s_and_b32 s49, s49, 0x7fff
    s_add_u32 s49, s49, s86
    s_add_u32 m0, s49, 98304
    s_add_u32 s47, s46, 0
    buffer_load_dwordx4 v9, s[24:27], s47 offen lds
    s_add_u32 m0, s49, 99328
    s_add_u32 s47, s46, 16384
    buffer_load_dwordx4 v9, s[24:27], s47 offen lds
    s_add_u32 s46, s62, 131072
    s_and_b32 s46, s46, 0x7ffff
    s_add_u32 s49, s3, 8192
    s_and_b32 s49, s49, 0x7fff
    s_add_u32 s49, s49, s86
    s_add_u32 m0, s49, 98304
    s_add_u32 s47, s46, 0
    buffer_load_dwordx4 v9, s[24:27], s47 offen lds
    s_add_u32 m0, s49, 99328
    s_add_u32 s47, s46, 16384
    buffer_load_dwordx4 v9, s[24:27], s47 offen lds
    s_add_u32 s46, s62, 262144
    s_and_b32 s46, s46, 0x7ffff
    s_add_u32 s49, s3, 16384
    s_and_b32 s49, s49, 0x7fff
    s_add_u32 s49, s49, s86
    s_add_u32 m0, s49, 98304
    s_add_u32 s47, s46, 0
    buffer_load_dwordx4 v9, s[24:27], s47 offen lds
    s_add_u32 m0, s49, 99328
    s_add_u32 s47, s46, 16384
    buffer_load_dwordx4 v9, s[24:27], s47 offen lds
    s_add_u32 s46, s62, 393216
    s_and_b32 s46, s46, 0x7ffff
    s_add_u32 s49, s3, 24576
    s_and_b32 s49, s49, 0x7fff
    s_add_u32 s49, s49, s86
    s_add_u32 m0, s49, 98304
    s_add_u32 s47, s46, 0
    buffer_load_dwordx4 v9, s[24:27], s47 offen lds
    s_add_u32 m0, s49, 99328
    s_add_u32 s47, s46, 16384
    buffer_load_dwordx4 v9, s[24:27], s47 offen lds
    s_add_u32 s91, s72, 10485760
    s_add_u32 s92, s73, 36864
    s_mul_i32 s96, s37, 43008
    s_add_u32 s96, s96, 28311552
    s_mov_b32 s94, 0x3f80
    s_mov_b32 s95, 0x3f800000
    s_lshl_b32 s46, s40, 4
    v_xor_b32 v99, s46, v1
    v_lshlrev_b32 v99, 5, v99
    v_add_u32 v99, 159232, v99
    v_and_b32 v100, 32, v1
    s_lshl_b32 s46, s40, 6
    s_add_u32 s46, s46, 161280
    v_add_u32 v100, s46, v100
    v_cndmask_b32 v99, v100, v99, s[50:51]
    v_lshrrev_b32 v102, 4, v1
    v_mul_u32_u24 v96, 2688, v102
    v_bfe_u32 v100, v1, 3, 1
    v_and_b32 v101, 1, v1
    v_lshl_add_u32 v100, v100, 1, v101
    v_bfe_u32 v101, v1, 1, 2
    v_mul_u32_u24 v97, 10752, v100
    v_add_u32 v97, v97, v96
    v_lshl_add_u32 v97, v101, 4, v97
    v_lshlrev_b32 v98, 5, v101
    v_lshl_add_u32 v98, v100, 3, v98
    v_lshl_add_u32 v98, v102, 1, v98
    v_add_u32 v98, 161280, v98
    v_and_b32 v100, 15, v1
    v_lshl_add_u32 v96, v100, 3, v96
    s_barrier
    s_barrier
    ds_read_b128 v[72:75], v21 offset:4096
    s_waitcnt lgkmcnt(0)
    v_mfma_f32_32x32x16_bf16 v[32:47], v[16:19], v[72:75], 0
    s_nop 11
L_j1_1:
    s_nop 8
    v_max3_f32 v76, v32, v33, v34
    v_max3_f32 v77, v35, v36, v37
    v_max3_f32 v78, v38, v39, v40
    v_max3_f32 v79, v41, v42, v43
    v_max3_f32 v76, v76, v44, v45
    v_max3_f32 v77, v77, v46, v47
    v_max3_f32 v76, v76, v78, v79
    v_max_f32 v76, v76, v77
    v_mul_f32 v76, v20, v76
    v_pk_fma_f32 v[32:33], v[32:33], v[20:21], v[76:77] op_sel_hi:[1,0,0] neg_lo:[0,0,1] neg_hi:[0,0,1]
    v_pk_fma_f32 v[34:35], v[34:35], v[20:21], v[76:77] op_sel_hi:[1,0,0] neg_lo:[0,0,1] neg_hi:[0,0,1]
    v_exp_f32 v32, v32
    v_pk_fma_f32 v[36:37], v[36:37], v[20:21], v[76:77] op_sel_hi:[1,0,0] neg_lo:[0,0,1] neg_hi:[0,0,1]
    v_exp_f32 v33, v33
    v_exp_f32 v34, v34
    v_pk_fma_f32 v[38:39], v[38:39], v[20:21], v[76:77] op_sel_hi:[1,0,0] neg_lo:[0,0,1] neg_hi:[0,0,1]
    v_exp_f32 v35, v35
    v_exp_f32 v36, v36
    v_pk_fma_f32 v[40:41], v[40:41], v[20:21], v[76:77] op_sel_hi:[1,0,0] neg_lo:[0,0,1] neg_hi:[0,0,1]
    v_exp_f32 v37, v37
    v_pk_add_f32 v[78:79], v[32:33], v[34:35]
    v_exp_f32 v38, v38
    v_pk_fma_f32 v[42:43], v[42:43], v[20:21], v[76:77] op_sel_hi:[1,0,0] neg_lo:[0,0,1] neg_hi:[0,0,1]
    v_exp_f32 v39, v39
    v_pk_add_f32 v[78:79], v[78:79], v[36:37]
    v_exp_f32 v40, v40
    v_pk_fma_f32 v[44:45], v[44:45], v[20:21], v[76:77] op_sel_hi:[1,0,0] neg_lo:[0,0,1] neg_hi:[0,0,1]
    v_exp_f32 v41, v41
    v_pk_add_f32 v[78:79], v[78:79], v[38:39]
    v_exp_f32 v42, v42
    v_pk_fma_f32 v[46:47], v[46:47], v[20:21], v[76:77] op_sel_hi:[1,0,0] neg_lo:[0,0,1] neg_hi:[0,0,1]
    v_exp_f32 v43, v43
    v_pk_add_f32 v[78:79], v[78:79], v[40:41]
    v_exp_f32 v44, v44
    v_exp_f32 v45, v45
    v_pk_add_f32 v[78:79], v[78:79], v[42:43]
    v_exp_f32 v46, v46
    v_exp_f32 v47, v47
    v_pk_add_f32 v[78:79], v[78:79], v[44:45]
    v_pk_add_f32 v[78:79], v[78:79], v[46:47]
    v_add_f32 v78, v78, v79
    v_rcp_f32 v76, v78
    s_nop 0
    v_pk_mul_f32 v[32:33], v[32:33], v[76:77] op_sel_hi:[1,0]
    v_pk_mul_f32 v[34:35], v[34:35], v[76:77] op_sel_hi:[1,0]
    v_pk_mul_f32 v[36:37], v[36:37], v[76:77] op_sel_hi:[1,0]
    v_pk_mul_f32 v[38:39], v[38:39], v[76:77] op_sel_hi:[1,0]
    v_pk_mul_f32 v[40:41], v[40:41], v[76:77] op_sel_hi:[1,0]
    v_pk_mul_f32 v[42:43], v[42:43], v[76:77] op_sel_hi:[1,0]
    v_pk_mul_f32 v[44:45], v[44:45], v[76:77] op_sel_hi:[1,0]
    v_pk_mul_f32 v[46:47], v[46:47], v[76:77] op_sel_hi:[1,0]
    v_cvt_pk_bf16_f32 v112, v32, v33
    v_cvt_pk_bf16_f32 v113, v34, v35
    v_cvt_pk_bf16_f32 v114, v36, v37
    v_cvt_pk_bf16_f32 v115, v38, v39
    v_cvt_pk_bf16_f32 v116, v40, v41
    v_cvt_pk_bf16_f32 v117, v42, v43
    v_cvt_pk_bf16_f32 v118, v44, v45
    v_cvt_pk_bf16_f32 v119, v46, v47
    s_cmp_lg_u32 s40, 0
    s_cbranch_scc1 L_axz_1
Lkp_79:
    s_mov_b32 s46, s97
    buffer_load_dwordx4 v[128:131], v96, s[4:7], s46 offen sc1
    buffer_load_dwordx4 v[132:135], v96, s[4:7], s46 offen offset:256 sc1
    buffer_load_dword v136, v97, s[4:7], s46 offen offset:512 sc1
    s_add_u32 s46, s46, 10752
    buffer_load_dwordx4 v[140:143], v96, s[4:7], s46 offen sc1
    buffer_load_dwordx4 v[144:147], v96, s[4:7], s46 offen offset:256 sc1
    buffer_load_dword v148, v97, s[4:7], s46 offen offset:512 sc1
    s_add_u32 s46, s46, 10752
    buffer_load_dwordx4 v[152:155], v96, s[4:7], s46 offen sc1
    buffer_load_dwordx4 v[156:159], v96, s[4:7], s46 offen offset:256 sc1
    buffer_load_dword v160, v97, s[4:7], s46 offen offset:512 sc1
    s_add_u32 s46, s46, 10752
    buffer_load_dwordx4 v[164:167], v96, s[4:7], s46 offen sc1
    buffer_load_dwordx4 v[168:171], v96, s[4:7], s46 offen offset:256 sc1
    buffer_load_dword v172, v97, s[4:7], s46 offen offset:512 sc1
L_kpc_1:
    s_waitcnt vmcnt(10)
    v_mfma_f32_16x16x32_bf16 v[48:51], v[104:107], v[128:131], 0
    v_mfma_f32_16x16x32_bf16 v[48:51], v[108:111], v[132:135], v[48:51]
    v_add3_u32 v137, s43, v128, v129
    v_add3_u32 v137, v137, v130, v131
    v_add3_u32 v137, v137, v132, v133
    v_add3_u32 v137, v137, v134, v135
    s_waitcnt vmcnt(9)
    v_cmp_ne_u32 s[64:65], v136, v137
    s_waitcnt vmcnt(7)
    v_mfma_f32_16x16x32_bf16 v[48:51], v[104:107], v[140:143], v[48:51]
    v_mfma_f32_16x16x32_bf16 v[48:51], v[108:111], v[144:147], v[48:51]
    v_add3_u32 v149, s43, v140, v141
    v_add3_u32 v149, v149, v142, v143
    v_add3_u32 v149, v149, v144, v145
    v_add3_u32 v149, v149, v146, v147
    s_waitcnt vmcnt(6)
    v_cmp_ne_u32 s[66:67], v148, v149
    s_waitcnt vmcnt(4)
    v_mfma_f32_16x16x32_bf16 v[48:51], v[104:107], v[152:155], v[48:51]
    v_mfma_f32_16x16x32_bf16 v[48:51], v[108:111], v[156:159], v[48:51]
    v_add3_u32 v161, s43, v152, v153
    v_add3_u32 v161, v161, v154, v155
    v_add3_u32 v161, v161, v156, v157
    v_add3_u32 v161, v161, v158, v159
    s_waitcnt vmcnt(3)
    v_cmp_ne_u32 s[68:69], v160, v161
    s_or_b64 s[64:65], s[64:65], s[66:67]
    s_waitcnt vmcnt(1)
    v_mfma_f32_16x16x32_bf16 v[48:51], v[104:107], v[164:167], v[48:51]
    v_mfma_f32_16x16x32_bf16 v[48:51], v[108:111], v[168:171], v[48:51]
    v_add3_u32 v173, s43, v164, v165
    v_add3_u32 v173, v173, v166, v167
    v_add3_u32 v173, v173, v168, v169
    v_add3_u32 v173, v173, v170, v171
    s_waitcnt vmcnt(0)
    v_cmp_ne_u32 s[70:71], v172, v173
    s_or_b64 s[64:65], s[64:65], s[68:69]
    s_nop 0
    v_cvt_pk_bf16_f32 v68, v48, v49
    v_cvt_pk_bf16_f32 v69, v50, v51
    ds_write_b64 v98, v[68:69]
    s_or_b64 s[64:65], s[64:65], s[70:71]
    s_cbranch_scc0 Lkpd_80
    s_sub_u32 s45, s45, 1
    s_cbranch_scc0 Lkp_79
    s_mov_b32 s45, 0
Lkpd_80:
    s_branch L_j2_1
L_axz_1:
    s_waitcnt vmcnt(0)
    s_cmp_lg_u32 s39, 2
    s_cbranch_scc1 L_j2_1
Lkz_81:
    s_mov_b32 s46, s96
    buffer_load_dword v40, v97, s[4:7], s46 offen offset:576 sc1
    buffer_load_dwordx2 v[32:33], v96, s[4:7], s46 offen offset:2560 sc1
    s_add_u32 s46, s46, 10752
    buffer_load_dwordx2 v[34:35], v96, s[4:7], s46 offen offset:2560 sc1
    s_add_u32 s46, s46, 10752
    buffer_load_dwordx2 v[36:37], v96, s[4:7], s46 offen offset:2560 sc1
    s_add_u32 s46, s46, 10752
    buffer_load_dwordx2 v[38:39], v96, s[4:7], s46 offen offset:2560 sc1
    s_waitcnt vmcnt(3)
    v_add3_u32 v52, s43, v32, v33
    v_lshlrev_b32 v48, 16, v32
    v_and_b32 v49, 0xffff0000, v32
    v_lshlrev_b32 v50, 16, v33
    v_and_b32 v51, 0xffff0000, v33
    v_sub_u32 v52, v52, v40
    s_waitcnt vmcnt(2)
    v_add3_u32 v52, v52, v34, v35
    v_dot2_f32_bf16 v48, v34, s94, v48
    v_dot2_f32_bf16 v49, v34, s95, v49
    v_dot2_f32_bf16 v50, v35, s94, v50
    v_dot2_f32_bf16 v51, v35, s95, v51
    s_waitcnt vmcnt(1)
    v_add3_u32 v52, v52, v36, v37
    v_dot2_f32_bf16 v48, v36, s94, v48
    v_dot2_f32_bf16 v49, v36, s95, v49
    v_dot2_f32_bf16 v50, v37, s94, v50
    v_dot2_f32_bf16 v51, v37, s95, v51
    s_waitcnt vmcnt(0)
    v_add3_u32 v52, v52, v38, v39
    v_dot2_f32_bf16 v48, v38, s94, v48
    v_dot2_f32_bf16 v49, v38, s95, v49
    v_dot2_f32_bf16 v50, v39, s94, v50
    v_dot2_f32_bf16 v51, v39, s95, v51
    v_add_u32_dpp v52, v52, v52 quad_perm:[1,0,3,2] row_mask:0xf bank_mask:0xf
    s_nop 0
    v_permlane32_swap_b32 v48, v50
    v_permlane32_swap_b32 v49, v51
    v_add_u32_dpp v52, v52, v52 row_ror:8 row_mask:0xf bank_mask:0xf
    v_add_f32 v48, v48, v50
    v_add_f32 v49, v49, v51
    v_cmp_ne_u32 vcc, 0, v52
    s_nop 0
    v_permlane16_swap_b32 v48, v49
    v_add_f32 v48, v48, v49
    v_cvt_pk_bf16_f32 v68, v48, v48
    ds_write_b16 v98, v68
    s_cbranch_vccz Lkzd_82
    s_sub_u32 s45, s45, 1
    s_cbranch_scc0 Lkz_81
    s_mov_b32 s45, 0
Lkzd_82:
L_j2_1:
    s_waitcnt lgkmcnt(0)
    s_barrier
    ds_read_b128 v[68:71], v99
    ds_read_b128 v[72:75], v99 offset:16
    v_cmp_gt_u32 vcc, s44, v1
    v_add_u32 v78, s43, 1
    s_nop 0
    v_cndmask_b32 v79, 0x40000000, v1, vcc
    s_waitcnt lgkmcnt(1)
    v_mfma_f32_32x32x16_bf16 v[32:47], v[68:71], v[112:115], 0
    s_waitcnt lgkmcnt(0)
    v_mfma_f32_32x32x16_bf16 v[32:47], v[72:75], v[116:119], v[32:47]
    buffer_store_dword v78, v79, s[4:7], s92 offen
    s_nop 10
    v_add_f32 v40, 0x358637bd, v40
    v_rcp_f32 v40, v40
    s_nop 0
    v_pk_mul_f32 v[32:33], v[32:33], v[40:41] op_sel_hi:[1,0]
    v_pk_mul_f32 v[34:35], v[34:35], v[40:41] op_sel_hi:[1,0]
    v_pk_mul_f32 v[36:37], v[36:37], v[40:41] op_sel_hi:[1,0]
    v_pk_mul_f32 v[38:39], v[38:39], v[40:41] op_sel_hi:[1,0]
    v_add_u32 v32, 0x10000, v32
    v_and_b32 v32, 0xfffe0000, v32
    v_cvt_pk_bf16_f32 v81, v34, v35
    v_cvt_pk_bf16_f32 v82, v36, v37
    v_cvt_pk_bf16_f32 v83, v38, v39
    v_cvt_pk_bf16_f32 v80, v32, v33
    v_and_b32 v80, -2, v80
    s_cmp_eq_u32 s44, 0
    s_cbranch_scc1 Lsafe_83
    buffer_store_dwordx4 v[80:83], v2, s[4:7], s91 offen
Lpub_84:
    s_cmp_lg_u32 s40, 0
    s_cbranch_scc1 L_ax3_1
    v_and_b32 v111, 124, v3
    v_add_u32 v111, 36864, v111
    buffer_load_dword v103, v111, s[4:7], s82 offen sc1
    v_mov_b32 v128, v80
    v_mov_b32 v129, v81
    v_mov_b32 v130, v82
    v_mov_b32 v131, v83
    s_add_u32 s92, s81, 1048576
    s_lshl_b32 s93, s37, 2
    s_add_u32 s93, s93, s82
    s_add_u32 s93, s93, 12288
    s_lshl_b32 s46, s39, 2
    v_add_u32 v100, s78, v2
    v_add_u32 v101, s46, v4
Lopredo_85:
    ds_read_b64_tr_b16 v[64:65], v6 offset:0
    ds_read_b64_tr_b16 v[66:67], v6 offset:512
    ds_read_b64_tr_b16 v[68:69], v6 offset:1024
    ds_read_b64_tr_b16 v[70:71], v6 offset:1536
    ds_read_b64_tr_b16 v[72:73], v6 offset:2048
    ds_read_b64_tr_b16 v[74:75], v6 offset:2560
    ds_read_b64_tr_b16 v[76:77], v6 offset:3072
    ds_read_b64_tr_b16 v[78:79], v6 offset:3584
    ds_read_b64_tr_b16 v[80:81], v6 offset:4096
    ds_read_b64_tr_b16 v[82:83], v6 offset:4608
    ds_read_b64_tr_b16 v[84:85], v6 offset:5120
    ds_read_b64_tr_b16 v[86:87], v6 offset:5632
    v_lshlrev_b32 v32, 16, v8
    v_and_b32 v33, 0xffff0000, v8
    v_lshlrev_b32 v34, 16, v9
    v_and_b32 v35, 0xffff0000, v9
    v_lshlrev_b32 v36, 16, v10
    v_and_b32 v37, 0xffff0000, v10
    v_lshlrev_b32 v38, 16, v11
    v_and_b32 v39, 0xffff0000, v11
    v_lshlrev_b32 v40, 16, v12
    v_and_b32 v41, 0xffff0000, v12
    v_lshlrev_b32 v42, 16, v13
    v_and_b32 v43, 0xffff0000, v13
    v_lshlrev_b32 v44, 16, v14
    v_and_b32 v45, 0xffff0000, v14
    v_lshlrev_b32 v46, 16, v15
    v_and_b32 v47, 0xffff0000, v15
    v_and_b32 v110, 124, v3
    s_add_u32 s48, s82, 36864
    s_and_b32 s49, s37, 1
    s_lshl_b32 s49, s49, 11
    s_add_u32 s89, s83, 10485760
    v_add3_u32 v108, s49, v2, 0
    s_lshr_b32 s90, s37, 1
    v_add_u32 v108, s89, v108
    s_lshl_b32 s90, s90, 12
    v_xor_b32 v109, 2048, v108
    s_add_u32 s46, s43, 1
    s_waitcnt vmcnt(0)
    v_cmp_ne_u32 vcc, s46, v103
    s_cbranch_vccz Lpolld_87
    buffer_load_dword v104, v110, s[4:7], s48 offen sc1
    s_sleep 2
Lpoll_86:
    buffer_load_dword v105, v110, s[4:7], s48 offen sc1
    s_waitcnt vmcnt(1)
    v_cmp_ne_u32 vcc, s46, v104
    s_cbranch_vccz Lpolld_87
    buffer_load_dword v104, v110, s[4:7], s48 offen sc1
    s_waitcnt vmcnt(1)
    v_cmp_ne_u32 vcc, s46, v105
    s_cbranch_vccz Lpolld_87
    s_sub_u32 s45, s45, 1
    s_cbranch_scc0 Lpoll_86
    s_mov_b32 s45, 0
Lpolld_87:
    v_mov_b32 v23, 0
    buffer_load_dwordx4 v[136:139], v109, s[4:7], s90 offen offset:0 sc1
    buffer_load_dwordx4 v[140:143], v109, s[4:7], s90 offen offset:1024 sc1
    s_add_u32 s90, s90, 4096
    s_and_b32 s90, s90, 0x7fff
    buffer_load_dwordx4 v[144:147], v108, s[4:7], s90 offen offset:0 sc1
    buffer_load_dwordx4 v[148:151], v108, s[4:7], s90 offen offset:1024 sc1
    buffer_load_dwordx4 v[152:155], v109, s[4:7], s90 offen offset:0 sc1
    buffer_load_dwordx4 v[156:159], v109, s[4:7], s90 offen offset:1024 sc1
    s_add_u32 s90, s90, 4096
    s_and_b32 s90, s90, 0x7fff
    buffer_load_dwordx4 v[160:163], v108, s[4:7], s90 offen offset:0 sc1
    buffer_load_dwordx4 v[164:167], v108, s[4:7], s90 offen offset:1024 sc1
    buffer_load_dwordx4 v[168:171], v109, s[4:7], s90 offen offset:0 sc1
    buffer_load_dwordx4 v[172:175], v109, s[4:7], s90 offen offset:1024 sc1
    s_add_u32 s90, s90, 4096
    s_and_b32 s90, s90, 0x7fff
Lhb_88:
    ds_read_b32 v102, v101 offset:0
    ds_read_b128 v[132:135], v100 offset:5120
    s_waitcnt lgkmcnt(0)
    v_cmp_gt_u32 vcc, 7, v102
    s_cbranch_vccnz Lhb_88
    v_mfma_f32_32x32x16_bf16 v[32:47], v[64:67], v[128:131], v[32:47]
    ds_read_b64_tr_b16 v[64:65], v6 offset:6144
    ds_read_b64_tr_b16 v[66:67], v6 offset:6656
    v_mfma_f32_32x32x16_bf16 v[32:47], v[68:71], v[132:135], v[32:47]
    ds_read_b64_tr_b16 v[68:69], v6 offset:7168
    ds_read_b64_tr_b16 v[70:71], v6 offset:7680
    v_or3_b32 v23, v23, v128, v132
    s_waitcnt vmcnt(9)
    v_mfma_f32_32x32x16_bf16 v[32:47], v[72:75], v[136:139], v[32:47]
    buffer_load_dwordx4 v[176:179], v108, s[4:7], s90 offen offset:0 sc1
    ds_read_b64_tr_b16 v[72:73], v6 offset:8192
    ds_read_b64_tr_b16 v[74:75], v6 offset:8704
    s_waitcnt vmcnt(9)
    v_mfma_f32_32x32x16_bf16 v[32:47], v[76:79], v[140:143], v[32:47]
    buffer_load_dwordx4 v[180:183], v108, s[4:7], s90 offen offset:1024 sc1
    ds_read_b64_tr_b16 v[76:77], v6 offset:9216
    ds_read_b64_tr_b16 v[78:79], v6 offset:9728
    v_or3_b32 v23, v23, v136, v140
    s_waitcnt vmcnt(9)
    v_mfma_f32_32x32x16_bf16 v[32:47], v[80:83], v[144:147], v[32:47]
    buffer_load_dwordx4 v[184:187], v109, s[4:7], s90 offen offset:0 sc1
    ds_read_b64_tr_b16 v[80:81], v6 offset:10240
    ds_read_b64_tr_b16 v[82:83], v6 offset:10752
    s_waitcnt vmcnt(9)
    v_mfma_f32_32x32x16_bf16 v[32:47], v[84:87], v[148:151], v[32:47]
    buffer_load_dwordx4 v[188:191], v109, s[4:7], s90 offen offset:1024 sc1
    s_add_u32 s90, s90, 4096
    s_and_b32 s90, s90, 0x7fff
    ds_read_b64_tr_b16 v[84:85], v6 offset:11264
    ds_read_b64_tr_b16 v[86:87], v6 offset:11776
    v_or3_b32 v23, v23, v144, v148
    v_and_b32 v23, 1, v23
    v_cmp_ne_u32 vcc, 0, v23
    s_cbranch_vccnz Lver_89
Lverc_90:
    s_waitcnt vmcnt(9) lgkmcnt(10)
    v_mfma_f32_32x32x16_bf16 v[32:47], v[64:67], v[152:155], v[32:47]
    buffer_load_dwordx4 v[192:195], v108, s[4:7], s90 offen offset:0 sc1
    ds_read_b64_tr_b16 v[64:65], v6 offset:12288
    ds_read_b64_tr_b16 v[66:67], v6 offset:12800
    s_waitcnt vmcnt(9) lgkmcnt(10)
    v_mfma_f32_32x32x16_bf16 v[32:47], v[68:71], v[156:159], v[32:47]
    buffer_load_dwordx4 v[196:199], v108, s[4:7], s90 offen offset:1024 sc1
    ds_read_b64_tr_b16 v[68:69], v6 offset:13312
    ds_read_b64_tr_b16 v[70:71], v6 offset:13824
    v_or3_b32 v23, v23, v152, v156
    s_waitcnt vmcnt(9) lgkmcnt(10)
    v_mfma_f32_32x32x16_bf16 v[32:47], v[72:75], v[160:163], v[32:47]
    buffer_load_dwordx4 v[200:203], v109, s[4:7], s90 offen offset:0 sc1
    ds_read_b64_tr_b16 v[72:73], v6 offset:14336
    ds_read_b64_tr_b16 v[74:75], v6 offset:14848
    s_waitcnt vmcnt(9) lgkmcnt(10)
    v_mfma_f32_32x32x16_bf16 v[32:47], v[76:79], v[164:167], v[32:47]
    buffer_load_dwordx4 v[204:207], v109, s[4:7], s90 offen offset:1024 sc1
    s_add_u32 s90, s90, 4096
    s_and_b32 s90, s90, 0x7fff
    ds_read_b64_tr_b16 v[76:77], v6 offset:15360
    ds_read_b64_tr_b16 v[78:79], v6 offset:15872
    v_or3_b32 v23, v23, v160, v164
    s_waitcnt vmcnt(9) lgkmcnt(10)
    v_mfma_f32_32x32x16_bf16 v[32:47], v[80:83], v[168:171], v[32:47]
    buffer_load_dwordx4 v[208:211], v108, s[4:7], s90 offen offset:0 sc1
    ds_read_b64_tr_b16 v[80:81], v6 offset:16384
    ds_read_b64_tr_b16 v[82:83], v6 offset:16896
    s_waitcnt vmcnt(9) lgkmcnt(10)
    v_mfma_f32_32x32x16_bf16 v[32:47], v[84:87], v[172:175], v[32:47]
    buffer_load_dwordx4 v[212:215], v108, s[4:7], s90 offen offset:1024 sc1
    ds_read_b64_tr_b16 v[84:85], v6 offset:17408
    ds_read_b64_tr_b16 v[86:87], v6 offset:17920
    v_or3_b32 v23, v23, v168, v172
    v_and_b32 v23, 1, v23
    v_cmp_ne_u32 vcc, 0, v23
    s_cbranch_vccnz Lver_91
Lverc_92:
    s_waitcnt vmcnt(9) lgkmcnt(10)
    v_mfma_f32_32x32x16_bf16 v[32:47], v[64:67], v[176:179], v[32:47]
    buffer_load_dwordx4 v[216:219], v109, s[4:7], s90 offen offset:0 sc1
    ds_read_b64_tr_b16 v[64:65], v6 offset:18432
    ds_read_b64_tr_b16 v[66:67], v6 offset:18944
    s_waitcnt vmcnt(9) lgkmcnt(10)
    v_mfma_f32_32x32x16_bf16 v[32:47], v[68:71], v[180:183], v[32:47]
    buffer_load_dwordx4 v[220:223], v109, s[4:7], s90 offen offset:1024 sc1
    s_add_u32 s90, s90, 4096
    s_and_b32 s90, s90, 0x7fff
    ds_read_b64_tr_b16 v[68:69], v6 offset:19456
    ds_read_b64_tr_b16 v[70:71], v6 offset:19968
    v_or3_b32 v23, v23, v176, v180
    s_waitcnt vmcnt(9) lgkmcnt(10)
    v_mfma_f32_32x32x16_bf16 v[32:47], v[72:75], v[184:187], v[32:47]
    buffer_load_dwordx4 v[224:227], v108, s[4:7], s90 offen offset:0 sc1
    ds_read_b64_tr_b16 v[72:73], v6 offset:20480
    ds_read_b64_tr_b16 v[74:75], v6 offset:20992
    s_waitcnt vmcnt(9) lgkmcnt(10)
    v_mfma_f32_32x32x16_bf16 v[32:47], v[76:79], v[188:191], v[32:47]
    buffer_load_dwordx4 v[228:231], v108, s[4:7], s90 offen offset:1024 sc1
    ds_read_b64_tr_b16 v[76:77], v6 offset:21504
    ds_read_b64_tr_b16 v[78:79], v6 offset:22016
    v_or3_b32 v23, v23, v184, v188
    s_waitcnt vmcnt(9) lgkmcnt(10)
    v_mfma_f32_32x32x16_bf16 v[32:47], v[80:83], v[192:195], v[32:47]
    buffer_load_dwordx4 v[232:235], v109, s[4:7], s90 offen offset:0 sc1
    ds_read_b64_tr_b16 v[80:81], v6 offset:22528
    ds_read_b64_tr_b16 v[82:83], v6 offset:23040
    s_waitcnt vmcnt(9) lgkmcnt(10)
    v_mfma_f32_32x32x16_bf16 v[32:47], v[84:87], v[196:199], v[32:47]
    buffer_load_dwordx4 v[236:239], v109, s[4:7], s90 offen offset:1024 sc1
    s_add_u32 s90, s90, 4096
    s_and_b32 s90, s90, 0x7fff
    ds_read_b64_tr_b16 v[84:85], v6 offset:23552
    ds_read_b64_tr_b16 v[86:87], v6 offset:24064
    v_or3_b32 v23, v23, v192, v196
    s_waitcnt vmcnt(9) lgkmcnt(10)
    v_mfma_f32_32x32x16_bf16 v[32:47], v[64:67], v[200:203], v[32:47]
    buffer_load_dwordx4 v[240:243], v108, s[4:7], s90 offen offset:0 sc1
    ds_read_b64_tr_b16 v[64:65], v6 offset:24576
    ds_read_b64_tr_b16 v[66:67], v6 offset:25088
    s_waitcnt vmcnt(9) lgkmcnt(10)
    v_mfma_f32_32x32x16_bf16 v[32:47], v[68:71], v[204:207], v[32:47]
    buffer_load_dwordx4 v[244:247], v108, s[4:7], s90 offen offset:1024 sc1
    ds_read_b64_tr_b16 v[68:69], v6 offset:25600
    ds_read_b64_tr_b16 v[70:71], v6 offset:26112
    v_or3_b32 v23, v23, v200, v204
    s_waitcnt vmcnt(9) lgkmcnt(10)
    v_mfma_f32_32x32x16_bf16 v[32:47], v[72:75], v[208:211], v[32:47]
    buffer_load_dwordx4 v[248:251], v109, s[4:7], s90 offen offset:0 sc1
    ds_read_b64_tr_b16 v[72:73], v6 offset:26624
    ds_read_b64_tr_b16 v[74:75], v6 offset:27136
    s_waitcnt vmcnt(9) lgkmcnt(10)
    v_mfma_f32_32x32x16_bf16 v[32:47], v[76:79], v[212:215], v[32:47]
    buffer_load_dwordx4 v[252:255], v109, s[4:7], s90 offen offset:1024 sc1
    ds_read_b64_tr_b16 v[76:77], v6 offset:27648
    ds_read_b64_tr_b16 v[78:79], v6 offset:28160
    v_or3_b32 v23, v23, v208, v212
    s_waitcnt vmcnt(9) lgkmcnt(10)
    v_mfma_f32_32x32x16_bf16 v[32:47], v[80:83], v[216:219], v[32:47]
    ds_read_b64_tr_b16 v[80:81], v6 offset:28672
    ds_read_b64_tr_b16 v[82:83], v6 offset:29184
    s_waitcnt vmcnt(8) lgkmcnt(10)
    v_mfma_f32_32x32x16_bf16 v[32:47], v[84:87], v[220:223], v[32:47]
    ds_read_b64_tr_b16 v[84:85], v6 offset:29696
    ds_read_b64_tr_b16 v[86:87], v6 offset:30208
    v_or3_b32 v23, v23, v216, v220
    s_waitcnt vmcnt(7) lgkmcnt(10)
    v_mfma_f32_32x32x16_bf16 v[32:47], v[64:67], v[224:227], v[32:47]
    ds_read_b64_tr_b16 v[64:65], v6 offset:30720
    ds_read_b64_tr_b16 v[66:67], v6 offset:31232
    v_cmp_gt_u32 vcc, s44, v1
    v_add_u32 v106, s43, 1
    s_nop 0
    v_cndmask_b32 v107, 0x40000000, v1, vcc
    s_waitcnt vmcnt(6) lgkmcnt(10)
    v_mfma_f32_32x32x16_bf16 v[32:47], v[68:71], v[228:231], v[32:47]
    ds_read_b64_tr_b16 v[68:69], v6 offset:31744
    ds_read_b64_tr_b16 v[70:71], v6 offset:32256
    v_or3_b32 v23, v23, v224, v228
    v_and_b32 v111, 60, v3
    v_add_u32 v111, 12288, v111
    s_waitcnt vmcnt(5) lgkmcnt(10)
    v_mfma_f32_32x32x16_bf16 v[32:47], v[72:75], v[232:235], v[32:47]
    v_mov_b32 v98, 0x10000
    v_mov_b32 v99, 0xfffe0000
    v_cndmask_b32 v98, 0, v98, s[60:61]
    v_cndmask_b32 v99, -1, v99, s[60:61]
    s_waitcnt vmcnt(4) lgkmcnt(8)
    v_mfma_f32_32x32x16_bf16 v[32:47], v[76:79], v[236:239], v[32:47]
    v_or3_b32 v23, v23, v232, v236
    s_waitcnt vmcnt(3) lgkmcnt(6)
    v_mfma_f32_32x32x16_bf16 v[32:47], v[80:83], v[240:243], v[32:47]
    s_waitcnt vmcnt(2) lgkmcnt(4)
    v_mfma_f32_32x32x16_bf16 v[32:47], v[84:87], v[244:247], v[32:47]
    v_or3_b32 v23, v23, v240, v244
    s_waitcnt vmcnt(1) lgkmcnt(2)
    v_mfma_f32_32x32x16_bf16 v[32:47], v[64:67], v[248:251], v[32:47]
    s_waitcnt vmcnt(0) lgkmcnt(0)
    v_mfma_f32_32x32x16_bf16 v[32:47], v[68:71], v[252:255], v[32:47]
    v_or3_b32 v23, v23, v248, v252
    v_and_b32 v23, 1, v23
    v_cmp_ne_u32 vcc, 0, v23
    s_cbranch_vccnz Lver_93
Lverc_94:
    buffer_store_dword v106, v107, s[4:7], s93 offen
    ds_read_b32 v0, v4 offset:40
    s_nop 5
    v_add_u32 v128, v98, v32
    v_and_b32 v128, v99, v128
    v_cvt_pk_bf16_f32 v128, v128, v33
    v_cvt_pk_bf16_f32 v129, v34, v35
    v_add_u32 v130, v98, v36
    v_and_b32 v130, v99, v130
    v_cvt_pk_bf16_f32 v130, v130, v37
    v_cvt_pk_bf16_f32 v131, v38, v39
    v_add_u32 v132, v98, v40
    v_and_b32 v132, v99, v132
    v_cvt_pk_bf16_f32 v132, v132, v41
    v_cvt_pk_bf16_f32 v133, v42, v43
    v_add_u32 v134, v98, v44
    v_and_b32 v134, v99, v134
    v_cvt_pk_bf16_f32 v134, v134, v45
    v_cvt_pk_bf16_f32 v135, v46, v47
    v_permlane32_swap_b32 v128, v130
    v_permlane32_swap_b32 v129, v131
    v_permlane32_swap_b32 v132, v134
    v_permlane32_swap_b32 v133, v135
    v_and_b32 v128, -2, v128
    v_and_b32 v132, -2, v132
    s_cmp_eq_u32 s44, 0
    s_cbranch_scc1 Lsafe_95
    buffer_store_dwordx4 v[128:131], v2, s[32:35], s80 offen
    buffer_store_dwordx4 v[132:135], v2, s[32:35], s80 offen offset:1024
    buffer_load_dword v103, v111, s[4:7], s82 offen sc1
    v_pk_add_f32 v[64:65], v[32:33], v[34:35]
    v_pk_add_f32 v[66:67], v[36:37], v[38:39]
    v_pk_add_f32 v[68:69], v[40:41], v[42:43]
    v_pk_add_f32 v[70:71], v[44:45], v[46:47]
    v_pk_mul_f32 v[72:73], v[32:33], v[32:33]
    v_pk_mul_f32 v[74:75], v[34:35], v[34:35]
    v_pk_add_f32 v[64:65], v[64:65], v[66:67]
    v_pk_add_f32 v[68:69], v[68:69], v[70:71]
    v_pk_fma_f32 v[72:73], v[36:37], v[36:37], v[72:73]
    v_pk_fma_f32 v[74:75], v[38:39], v[38:39], v[74:75]
    v_pk_fma_f32 v[72:73], v[40:41], v[40:41], v[72:73]
    v_pk_fma_f32 v[74:75], v[42:43], v[42:43], v[74:75]
    v_pk_fma_f32 v[72:73], v[44:45], v[44:45], v[72:73]
    v_pk_fma_f32 v[74:75], v[46:47], v[46:47], v[74:75]
    v_pk_add_f32 v[64:65], v[64:65], v[68:69]
    v_pk_add_f32 v[72:73], v[72:73], v[74:75]
    v_add_f32 v64, v64, v65
    v_add_f32 v66, v72, v73
    s_nop 1
    v_permlane32_swap_b32 v64, v66
    v_add_f32 v64, v64, v66
    v_and_b32 v64, -2, v64
    buffer_store_dword v64, v3, s[4:7], s92 offen
Lpub_96:
    v_cvt_pk_bf16_f32 v8, v32, v33
    v_cvt_pk_bf16_f32 v9, v34, v35
    v_cvt_pk_bf16_f32 v10, v36, v37
    v_cvt_pk_bf16_f32 v11, v38, v39
    v_cvt_pk_bf16_f32 v12, v40, v41
    v_cvt_pk_bf16_f32 v13, v42, v43
    v_cvt_pk_bf16_f32 v14, v44, v45
    v_cvt_pk_bf16_f32 v15, v46, v47
    v_mov_b32 v23, 1
    s_mov_b64 exec, 1
    s_waitcnt lgkmcnt(0)
    ds_add_u32 v4, v23 offset:16
    s_mov_b64 exec, -1
    s_branch L_main_2
L_ax3_1:
    v_add_u32 v64, s78, v2
    s_lshl_b32 s46, s42, 2
    ds_write_b128 v64, v[80:83] offset:5120
    v_add_u32 v65, s46, v4
    v_mov_b32 v66, 7
    ds_write_b32 v65, v66 offset:0
    s_add_u32 s46, s3, 0
    s_and_b32 s46, s46, 0x7fff
    v_add_u32 v64, s46, v10
    s_add_u32 s46, s3, 8192
    s_and_b32 s46, s46, 0x7fff
    v_add_u32 v65, s46, v10
    s_add_u32 s46, s3, 16384
    s_and_b32 s46, s46, 0x7fff
    v_add_u32 v66, s46, v10
    s_add_u32 s46, s3, 24576
    s_and_b32 s46, s46, 0x7fff
    v_add_u32 v67, s46, v10
    v_add_u32 v29, 0, v11
    ds_read_b64_tr_b16 v[32:33], v29 offset:0
    ds_read_b64_tr_b16 v[34:35], v29 offset:512
    ds_read_b64_tr_b16 v[36:37], v29 offset:1024
    ds_read_b64_tr_b16 v[38:39], v29 offset:1536
    ds_read_b64_tr_b16 v[40:41], v29 offset:8192
    ds_read_b64_tr_b16 v[42:43], v29 offset:8704
    ds_read_b64_tr_b16 v[44:45], v29 offset:9216
    ds_read_b64_tr_b16 v[46:47], v29 offset:9728
    ds_read_b64_tr_b16 v[48:49], v29 offset:16384
    ds_read_b64_tr_b16 v[50:51], v29 offset:16896
    ds_read_b64_tr_b16 v[52:53], v29 offset:17408
    ds_read_b64_tr_b16 v[54:55], v29 offset:17920
    ds_read_b64_tr_b16 v[56:57], v29 offset:24576
    ds_read_b64_tr_b16 v[58:59], v29 offset:25088
    ds_read_b64_tr_b16 v[60:61], v29 offset:25600
    ds_read_b64_tr_b16 v[62:63], v29 offset:26112
    ds_write_b128 v64, v[128:131] offset:0
    ds_write_b128 v64, v[132:135] offset:1024
    ds_write_b128 v65, v[136:139] offset:0
    ds_write_b128 v65, v[140:143] offset:1024
    ds_write_b128 v66, v[144:147] offset:0
    ds_write_b128 v66, v[148:151] offset:1024
    ds_write_b128 v67, v[152:155] offset:0
    ds_write_b128 v67, v[156:159] offset:1024
    v_add_u32 v29, 32768, v11
    ds_read_b64_tr_b16 v[128:129], v29 offset:0
    ds_read_b64_tr_b16 v[130:131], v29 offset:512
    ds_read_b64_tr_b16 v[132:133], v29 offset:1024
    ds_read_b64_tr_b16 v[134:135], v29 offset:1536
    ds_read_b64_tr_b16 v[136:137], v29 offset:8192
    ds_read_b64_tr_b16 v[138:139], v29 offset:8704
    ds_read_b64_tr_b16 v[140:141], v29 offset:9216
    ds_read_b64_tr_b16 v[142:143], v29 offset:9728
    ds_read_b64_tr_b16 v[144:145], v29 offset:16384
    ds_read_b64_tr_b16 v[146:147], v29 offset:16896
    ds_read_b64_tr_b16 v[148:149], v29 offset:17408
    ds_read_b64_tr_b16 v[150:151], v29 offset:17920
    ds_read_b64_tr_b16 v[152:153], v29 offset:24576
    ds_read_b64_tr_b16 v[154:155], v29 offset:25088
    ds_read_b64_tr_b16 v[156:157], v29 offset:25600
    ds_read_b64_tr_b16 v[158:159], v29 offset:26112
    ds_write_b128 v64, v[160:163] offset:32768
    ds_write_b128 v64, v[164:167] offset:33792
    ds_write_b128 v65, v[168:171] offset:32768
    ds_write_b128 v65, v[172:175] offset:33792
    ds_write_b128 v66, v[176:179] offset:32768
    ds_write_b128 v66, v[180:183] offset:33792
    ds_write_b128 v67, v[184:187] offset:32768
    ds_write_b128 v67, v[188:191] offset:33792
    v_add_u32 v29, 65536, v11
    ds_read_b64_tr_b16 v[160:161], v29 offset:0
    ds_read_b64_tr_b16 v[162:163], v29 offset:512
    ds_read_b64_tr_b16 v[164:165], v29 offset:1024
    ds_read_b64_tr_b16 v[166:167], v29 offset:1536
    ds_read_b64_tr_b16 v[168:169], v29 offset:8192
    ds_read_b64_tr_b16 v[170:171], v29 offset:8704
    ds_read_b64_tr_b16 v[172:173], v29 offset:9216
    ds_read_b64_tr_b16 v[174:175], v29 offset:9728
    ds_read_b64_tr_b16 v[176:177], v29 offset:16384
    ds_read_b64_tr_b16 v[178:179], v29 offset:16896
    ds_read_b64_tr_b16 v[180:181], v29 offset:17408
    ds_read_b64_tr_b16 v[182:183], v29 offset:17920
    ds_read_b64_tr_b16 v[184:185], v29 offset:24576
    ds_read_b64_tr_b16 v[186:187], v29 offset:25088
    ds_read_b64_tr_b16 v[188:189], v29 offset:25600
    ds_read_b64_tr_b16 v[190:191], v29 offset:26112
    v_add_u32 v64, 65536, v64
    v_add_u32 v65, 65536, v65
    v_add_u32 v66, 65536, v66
    v_add_u32 v67, 65536, v67
    ds_write_b128 v64, v[192:195] offset:0
    ds_write_b128 v64, v[196:199] offset:1024
    ds_write_b128 v65, v[200:203] offset:0
    ds_write_b128 v65, v[204:207] offset:1024
    ds_write_b128 v66, v[208:211] offset:0
    ds_write_b128 v66, v[212:215] offset:1024
    ds_write_b128 v67, v[216:219] offset:0
    ds_write_b128 v67, v[220:223] offset:1024
    s_branch L_aux_2
L_main_2:
    v_add_u32 v5, 65536, v2
    v_add_u32 v6, 98304, v2
    v_cmp_gt_u32 vcc, 8, v0
    s_cbranch_vccz Lwr_97
Llw_98:
    ds_read_b32 v23, v4 offset:40
    s_waitcnt lgkmcnt(0)
    v_cmp_gt_u32 vcc, 8, v23
    s_cbranch_vccnz Llw_98
Lwr_97:
    v_and_b32 v0, 0x1f0, v2
    v_add_u32 v0, 155648, v0
    s_lshr_b32 s47, s83, 6
    s_add_u32 s47, s47, 73728
    v_add_u32 v21, s78, v2
    s_add_u32 s91, s79, 23461888
    s_add_u32 s93, s91, 4096
Lkvredo_99:
    ds_read_b128 v[88:91], v0 offset:512
    ds_read_b128 v[92:95], v0 offset:1024
    ds_read_b128 v[64:67], v2 offset:0
    ds_read_b128 v[68:71], v2 offset:32768
    ds_read_b128 v[72:75], v2 offset:1024
    ds_read_b128 v[76:79], v2 offset:33792
    ds_read_b128 v[80:83], v2 offset:2048
    ds_read_b128 v[84:87], v2 offset:34816
    v_and_b32 v110, 60, v3
    s_add_u32 s48, s82, 12288
    s_and_b32 s49, s37, 1
    s_lshl_b32 s49, s49, 11
    s_add_u32 s89, s83, 0
    v_add3_u32 v108, s49, v2, 0
    s_lshr_b32 s90, s37, 1
    v_add_u32 v108, s89, v108
    s_lshl_b32 s90, s90, 12
    v_xor_b32 v109, 2048, v108
    s_add_u32 s46, s43, 1
    s_waitcnt vmcnt(1)
    v_cmp_ne_u32 vcc, s46, v103
    s_cbranch_vccz Lpolld_101
    buffer_load_dword v104, v110, s[4:7], s48 offen sc1
    s_sleep 2
Lpoll_100:
    buffer_load_dword v105, v110, s[4:7], s48 offen sc1
    s_waitcnt vmcnt(1)
    v_cmp_ne_u32 vcc, s46, v104
    s_cbranch_vccz Lpolld_101
    buffer_load_dword v104, v110, s[4:7], s48 offen sc1
    s_waitcnt vmcnt(1)
    v_cmp_ne_u32 vcc, s46, v105
    s_cbranch_vccz Lpolld_101
    s_sub_u32 s45, s45, 1
    s_cbranch_scc0 Lpoll_100
    s_mov_b32 s45, 0
Lpolld_101:
    v_mov_b32 v23, 0
    buffer_load_dwordx4 v[136:139], v109, s[32:35], s90 offen offset:0 sc1
    buffer_load_dwordx4 v[140:143], v109, s[32:35], s90 offen offset:1024 sc1
    s_add_u32 s90, s90, 4096
    s_and_b32 s90, s90, 0x7fff
    buffer_load_dwordx4 v[144:147], v108, s[32:35], s90 offen offset:0 sc1
    buffer_load_dwordx4 v[148:151], v108, s[32:35], s90 offen offset:1024 sc1
    buffer_load_dwordx4 v[152:155], v109, s[32:35], s90 offen offset:0 sc1
    buffer_load_dwordx4 v[156:159], v109, s[32:35], s90 offen offset:1024 sc1
    s_add_u32 s90, s90, 4096
    s_and_b32 s90, s90, 0x7fff
    buffer_load_dwordx4 v[160:163], v108, s[32:35], s90 offen offset:0 sc1
    buffer_load_dwordx4 v[164:167], v108, s[32:35], s90 offen offset:1024 sc1
    s_waitcnt lgkmcnt(5)
    v_mfma_f32_32x32x16_bf16 v[32:47], v[64:67], v[128:131], 0
    ds_read_b128 v[64:67], v2 offset:3072
    v_add_f32 v88, v88, v89
    v_add_f32 v90, v90, v91
    s_waitcnt lgkmcnt(5)
    v_mfma_f32_32x32x16_bf16 v[48:63], v[128:131], v[68:71], 0
    ds_read_b128 v[68:71], v2 offset:35840
    v_add_f32 v88, v88, v90
    v_and_b32 v90, 0xffff0000, v88
    v_sub_f32 v91, v88, v90
    s_waitcnt lgkmcnt(5)
    v_mfma_f32_32x32x16_bf16 v[32:47], v[72:75], v[132:135], v[32:47]
    ds_read_b128 v[72:75], v2 offset:4096
    v_cvt_pk_bf16_f32 v88, v90, v91
    v_cvt_pk_bf16_f32 v89, v90, 0
    v_mov_b32 v90, 0
    s_waitcnt lgkmcnt(5)
    v_mfma_f32_32x32x16_bf16 v[48:63], v[132:135], v[76:79], v[48:63]
    ds_read_b128 v[76:79], v2 offset:36864
    v_mov_b32 v91, 0
    v_add_f32 v92, v92, v93
    s_waitcnt vmcnt(7) lgkmcnt(5)
    v_mfma_f32_32x32x16_bf16 v[32:47], v[80:83], v[136:139], v[32:47]
    ds_read_b128 v[80:83], v2 offset:5120
    buffer_load_dwordx4 v[168:171], v109, s[32:35], s90 offen offset:0 sc1
    v_add_f32 v94, v94, v95
    s_waitcnt lgkmcnt(5)
    v_mfma_f32_32x32x16_bf16 v[48:63], v[136:139], v[84:87], v[48:63]
    ds_read_b128 v[84:87], v2 offset:37888
    v_add_f32 v92, v92, v94
    v_and_b32 v94, 0xffff0000, v92
    v_sub_f32 v95, v92, v94
    s_waitcnt vmcnt(7) lgkmcnt(5)
    v_mfma_f32_32x32x16_bf16 v[32:47], v[64:67], v[140:143], v[32:47]
    ds_read_b128 v[64:67], v2 offset:6144
    v_or3_b32 v23, v23, v136, v140
    buffer_load_dwordx4 v[172:175], v109, s[32:35], s90 offen offset:1024 sc1
    s_add_u32 s90, s90, 4096
    s_and_b32 s90, s90, 0x7fff
    v_cvt_pk_bf16_f32 v92, v94, v95
    s_waitcnt lgkmcnt(5)
    v_mfma_f32_32x32x16_bf16 v[48:63], v[140:143], v[68:71], v[48:63]
    ds_read_b128 v[68:71], v2 offset:38912
    v_cvt_pk_bf16_f32 v93, v94, 0
    v_mov_b32 v94, 0
    v_mov_b32 v95, 0
    s_waitcnt vmcnt(7) lgkmcnt(5)
    v_mfma_f32_32x32x16_bf16 v[32:47], v[72:75], v[144:147], v[32:47]
    ds_read_b128 v[72:75], v2 offset:7168
    buffer_load_dwordx4 v[176:179], v108, s[32:35], s90 offen offset:0 sc1
    v_lshlrev_b32 v98, 3, v1
    s_waitcnt lgkmcnt(5)
    v_mfma_f32_32x32x16_bf16 v[48:63], v[144:147], v[76:79], v[48:63]
    ds_read_b128 v[76:79], v2 offset:39936
    s_add_u32 s64, s43, 2
    s_waitcnt vmcnt(7) lgkmcnt(5)
    v_mfma_f32_32x32x16_bf16 v[32:47], v[80:83], v[148:151], v[32:47]
    ds_read_b128 v[80:83], v2 offset:8192
    v_or3_b32 v23, v23, v144, v148
    buffer_load_dwordx4 v[180:183], v108, s[32:35], s90 offen offset:1024 sc1
    s_waitcnt lgkmcnt(5)
    v_mfma_f32_32x32x16_bf16 v[48:63], v[148:151], v[84:87], v[48:63]
    ds_read_b128 v[84:87], v2 offset:40960
    v_and_b32 v23, 1, v23
    v_cmp_ne_u32 vcc, 0, v23
    s_cbranch_vccnz Lver_102
Lverc_103:
    s_waitcnt vmcnt(7) lgkmcnt(5)
    v_mfma_f32_32x32x16_bf16 v[32:47], v[64:67], v[152:155], v[32:47]
    ds_read_b128 v[64:67], v2 offset:9216
    buffer_load_dwordx4 v[184:187], v109, s[32:35], s90 offen offset:0 sc1
    s_waitcnt lgkmcnt(5)
    v_mfma_f32_32x32x16_bf16 v[48:63], v[152:155], v[68:71], v[48:63]
    ds_read_b128 v[68:71], v2 offset:41984
    s_waitcnt vmcnt(7) lgkmcnt(5)
    v_mfma_f32_32x32x16_bf16 v[32:47], v[72:75], v[156:159], v[32:47]
    ds_read_b128 v[72:75], v2 offset:10240
    v_or3_b32 v23, v23, v152, v156
    buffer_load_dwordx4 v[188:191], v109, s[32:35], s90 offen offset:1024 sc1
    s_add_u32 s90, s90, 4096
    s_and_b32 s90, s90, 0x7fff
    s_waitcnt lgkmcnt(5)
    v_mfma_f32_32x32x16_bf16 v[48:63], v[156:159], v[76:79], v[48:63]
    ds_read_b128 v[76:79], v2 offset:43008
    s_waitcnt vmcnt(7) lgkmcnt(5)
    v_mfma_f32_32x32x16_bf16 v[32:47], v[80:83], v[160:163], v[32:47]
    ds_read_b128 v[80:83], v2 offset:11264
    buffer_load_dwordx4 v[192:195], v108, s[32:35], s90 offen offset:0 sc1
    s_waitcnt lgkmcnt(5)
    v_mfma_f32_32x32x16_bf16 v[48:63], v[160:163], v[84:87], v[48:63]
    ds_read_b128 v[84:87], v2 offset:44032
    s_waitcnt vmcnt(7) lgkmcnt(5)
    v_mfma_f32_32x32x16_bf16 v[32:47], v[64:67], v[164:167], v[32:47]
    ds_read_b128 v[64:67], v2 offset:12288
    v_or3_b32 v23, v23, v160, v164
    buffer_load_dwordx4 v[196:199], v108, s[32:35], s90 offen offset:1024 sc1
    s_waitcnt lgkmcnt(5)
    v_mfma_f32_32x32x16_bf16 v[48:63], v[164:167], v[68:71], v[48:63]
    ds_read_b128 v[68:71], v2 offset:45056
    s_waitcnt vmcnt(7) lgkmcnt(5)
    v_mfma_f32_32x32x16_bf16 v[32:47], v[72:75], v[168:171], v[32:47]
    ds_read_b128 v[72:75], v2 offset:13312
    buffer_load_dwordx4 v[200:203], v109, s[32:35], s90 offen offset:0 sc1
    s_waitcnt lgkmcnt(5)
    v_mfma_f32_32x32x16_bf16 v[48:63], v[168:171], v[76:79], v[48:63]
    ds_read_b128 v[76:79], v2 offset:46080
    s_waitcnt vmcnt(7) lgkmcnt(5)
    v_mfma_f32_32x32x16_bf16 v[32:47], v[80:83], v[172:175], v[32:47]
    ds_read_b128 v[80:83], v2 offset:14336
    v_or3_b32 v23, v23, v168, v172
    buffer_load_dwordx4 v[204:207], v109, s[32:35], s90 offen offset:1024 sc1
    s_add_u32 s90, s90, 4096
    s_and_b32 s90, s90, 0x7fff
    s_waitcnt lgkmcnt(5)
    v_mfma_f32_32x32x16_bf16 v[48:63], v[172:175], v[84:87], v[48:63]
    ds_read_b128 v[84:87], v2 offset:47104
    v_and_b32 v23, 1, v23
    v_cmp_ne_u32 vcc, 0, v23
    s_cbranch_vccnz Lver_104
Lverc_105:
    s_waitcnt vmcnt(7) lgkmcnt(5)
    v_mfma_f32_32x32x16_bf16 v[32:47], v[64:67], v[176:179], v[32:47]
    ds_read_b128 v[64:67], v2 offset:15360
    buffer_load_dwordx4 v[208:211], v108, s[32:35], s90 offen offset:0 sc1
    s_waitcnt lgkmcnt(5)
    v_mfma_f32_32x32x16_bf16 v[48:63], v[176:179], v[68:71], v[48:63]
    ds_read_b128 v[68:71], v2 offset:48128
    s_waitcnt vmcnt(7) lgkmcnt(5)
    v_mfma_f32_32x32x16_bf16 v[32:47], v[72:75], v[180:183], v[32:47]
    ds_read_b128 v[72:75], v2 offset:16384
    v_or3_b32 v23, v23, v176, v180
    buffer_load_dwordx4 v[212:215], v108, s[32:35], s90 offen offset:1024 sc1
    s_waitcnt lgkmcnt(5)
    v_mfma_f32_32x32x16_bf16 v[48:63], v[180:183], v[76:79], v[48:63]
    ds_read_b128 v[76:79], v2 offset:49152
    s_waitcnt vmcnt(7) lgkmcnt(5)
    v_mfma_f32_32x32x16_bf16 v[32:47], v[80:83], v[184:187], v[32:47]
    ds_read_b128 v[80:83], v2 offset:17408
    buffer_load_dwordx4 v[216:219], v109, s[32:35], s90 offen offset:0 sc1
    s_waitcnt lgkmcnt(5)
    v_mfma_f32_32x32x16_bf16 v[48:63], v[184:187], v[84:87], v[48:63]
    ds_read_b128 v[84:87], v2 offset:50176
    s_waitcnt vmcnt(7) lgkmcnt(5)
    v_mfma_f32_32x32x16_bf16 v[32:47], v[64:67], v[188:191], v[32:47]
    ds_read_b128 v[64:67], v2 offset:18432
    v_or3_b32 v23, v23, v184, v188
    buffer_load_dwordx4 v[220:223], v109, s[32:35], s90 offen offset:1024 sc1
    s_add_u32 s90, s90, 4096
    s_and_b32 s90, s90, 0x7fff
    s_waitcnt lgkmcnt(5)
    v_mfma_f32_32x32x16_bf16 v[48:63], v[188:191], v[68:71], v[48:63]
    ds_read_b128 v[68:71], v2 offset:51200
    s_waitcnt vmcnt(7) lgkmcnt(5)
    v_mfma_f32_32x32x16_bf16 v[32:47], v[72:75], v[192:195], v[32:47]
    ds_read_b128 v[72:75], v2 offset:19456
    buffer_load_dwordx4 v[224:227], v108, s[32:35], s90 offen offset:0 sc1
    s_waitcnt lgkmcnt(5)
    v_mfma_f32_32x32x16_bf16 v[48:63], v[192:195], v[76:79], v[48:63]
    ds_read_b128 v[76:79], v2 offset:52224
    s_waitcnt vmcnt(7) lgkmcnt(5)
    v_mfma_f32_32x32x16_bf16 v[32:47], v[80:83], v[196:199], v[32:47]
    ds_read_b128 v[80:83], v2 offset:20480
    v_or3_b32 v23, v23, v192, v196
    buffer_load_dwordx4 v[228:231], v108, s[32:35], s90 offen offset:1024 sc1
    s_waitcnt lgkmcnt(5)
    v_mfma_f32_32x32x16_bf16 v[48:63], v[196:199], v[84:87], v[48:63]
    ds_read_b128 v[84:87], v2 offset:53248
    s_waitcnt vmcnt(7) lgkmcnt(5)
    v_mfma_f32_32x32x16_bf16 v[32:47], v[64:67], v[200:203], v[32:47]
    ds_read_b128 v[64:67], v2 offset:21504
    buffer_load_dwordx4 v[232:235], v109, s[32:35], s90 offen offset:0 sc1
    s_waitcnt lgkmcnt(5)
    v_mfma_f32_32x32x16_bf16 v[48:63], v[200:203], v[68:71], v[48:63]
    ds_read_b128 v[68:71], v2 offset:54272
    s_waitcnt vmcnt(7) lgkmcnt(5)
    v_mfma_f32_32x32x16_bf16 v[32:47], v[72:75], v[204:207], v[32:47]
    ds_read_b128 v[72:75], v2 offset:22528
    v_or3_b32 v23, v23, v200, v204
    buffer_load_dwordx4 v[236:239], v109, s[32:35], s90 offen offset:1024 sc1
    s_add_u32 s90, s90, 4096
    s_and_b32 s90, s90, 0x7fff
    s_waitcnt lgkmcnt(5)
    v_mfma_f32_32x32x16_bf16 v[48:63], v[204:207], v[76:79], v[48:63]
    ds_read_b128 v[76:79], v2 offset:55296
    s_waitcnt vmcnt(7) lgkmcnt(5)
    v_mfma_f32_32x32x16_bf16 v[32:47], v[80:83], v[208:211], v[32:47]
    ds_read_b128 v[80:83], v2 offset:23552
    buffer_load_dwordx4 v[240:243], v108, s[32:35], s90 offen offset:0 sc1
    s_waitcnt lgkmcnt(5)
    v_mfma_f32_32x32x16_bf16 v[48:63], v[208:211], v[84:87], v[48:63]
    ds_read_b128 v[84:87], v2 offset:56320
    s_waitcnt vmcnt(7) lgkmcnt(5)
    v_mfma_f32_32x32x16_bf16 v[32:47], v[64:67], v[212:215], v[32:47]
    ds_read_b128 v[64:67], v2 offset:24576
    v_or3_b32 v23, v23, v208, v212
    buffer_load_dwordx4 v[244:247], v108, s[32:35], s90 offen offset:1024 sc1
    s_waitcnt lgkmcnt(5)
    v_mfma_f32_32x32x16_bf16 v[48:63], v[212:215], v[68:71], v[48:63]
    ds_read_b128 v[68:71], v2 offset:57344
    s_waitcnt vmcnt(7) lgkmcnt(5)
    v_mfma_f32_32x32x16_bf16 v[32:47], v[72:75], v[216:219], v[32:47]
    ds_read_b128 v[72:75], v2 offset:25600
    buffer_load_dwordx4 v[248:251], v109, s[32:35], s90 offen offset:0 sc1
    s_waitcnt lgkmcnt(5)
    v_mfma_f32_32x32x16_bf16 v[48:63], v[216:219], v[76:79], v[48:63]
    ds_read_b128 v[76:79], v2 offset:58368
    buffer_load_dwordx2 v[96:97], v98, s[4:7], s47 offen sc1
    s_waitcnt vmcnt(8) lgkmcnt(5)
    v_mfma_f32_32x32x16_bf16 v[32:47], v[80:83], v[220:223], v[32:47]
    ds_read_b128 v[80:83], v2 offset:26624
    v_or3_b32 v23, v23, v216, v220
    buffer_load_dwordx4 v[252:255], v109, s[32:35], s90 offen offset:1024 sc1
    s_waitcnt lgkmcnt(5)
    v_mfma_f32_32x32x16_bf16 v[48:63], v[220:223], v[84:87], v[48:63]
    ds_read_b128 v[84:87], v2 offset:59392
    s_waitcnt vmcnt(8) lgkmcnt(5)
    v_mfma_f32_32x32x16_bf16 v[32:47], v[64:67], v[224:227], v[32:47]
    ds_read_b128 v[64:67], v2 offset:27648
    s_waitcnt lgkmcnt(5)
    v_mfma_f32_32x32x16_bf16 v[48:63], v[224:227], v[68:71], v[48:63]
    ds_read_b128 v[68:71], v2 offset:60416
    s_waitcnt vmcnt(7) lgkmcnt(5)
    v_mfma_f32_32x32x16_bf16 v[32:47], v[72:75], v[228:231], v[32:47]
    ds_read_b128 v[72:75], v2 offset:28672
    v_or3_b32 v23, v23, v224, v228
    s_waitcnt lgkmcnt(5)
    v_mfma_f32_32x32x16_bf16 v[48:63], v[228:231], v[76:79], v[48:63]
    ds_read_b128 v[76:79], v2 offset:61440
    s_waitcnt vmcnt(6) lgkmcnt(5)
    v_mfma_f32_32x32x16_bf16 v[32:47], v[80:83], v[232:235], v[32:47]
    ds_read_b128 v[80:83], v2 offset:29696
    s_waitcnt lgkmcnt(5)
    v_mfma_f32_32x32x16_bf16 v[48:63], v[232:235], v[84:87], v[48:63]
    ds_read_b128 v[84:87], v2 offset:62464
    s_waitcnt vmcnt(5) lgkmcnt(5)
    v_mfma_f32_32x32x16_bf16 v[32:47], v[64:67], v[236:239], v[32:47]
    ds_read_b128 v[64:67], v2 offset:30720
    v_or3_b32 v23, v23, v232, v236
    s_waitcnt lgkmcnt(5)
    v_mfma_f32_32x32x16_bf16 v[48:63], v[236:239], v[68:71], v[48:63]
    ds_read_b128 v[68:71], v2 offset:63488
    s_waitcnt vmcnt(4) lgkmcnt(5)
    v_mfma_f32_32x32x16_bf16 v[32:47], v[72:75], v[240:243], v[32:47]
    ds_read_b128 v[72:75], v2 offset:31744
    s_waitcnt vmcnt(1)
    v_cmp_ne_u32 vcc, s64, v97
    s_cbranch_vccnz Lfin_106
Lfinc_107:
    v_mov_b32 v97, v96
    v_mov_b32 v30, 0
    s_waitcnt lgkmcnt(5)
    v_mfma_f32_32x32x16_bf16 v[48:63], v[240:243], v[76:79], v[48:63]
    ds_read_b128 v[76:79], v2 offset:64512
    v_mov_b32 v31, 0
    v_permlane32_swap_b32 v96, v97
    v_mul_f32 v96, 0x3b000000, v96
    s_waitcnt lgkmcnt(5)
    v_mfma_f32_32x32x16_bf16 v[32:47], v[80:83], v[244:247], v[32:47]
    v_or3_b32 v23, v23, v240, v244
    v_mul_f32 v97, 0x3b000000, v97
    v_fma_f32 v97, -v96, v96, v97
    v_max_f32 v97, 0, v97
    s_waitcnt lgkmcnt(4)
    v_mfma_f32_32x32x16_bf16 v[48:63], v[244:247], v[84:87], v[48:63]
    v_add_f32 v97, 0x3727c5ac, v97
    v_rsq_f32 v20, v97
    v_cndmask_b32 v96, 0, v96, s[60:61]
    s_waitcnt lgkmcnt(3)
    v_mfma_f32_32x32x16_bf16 v[32:47], v[64:67], v[248:251], v[32:47]
    v_and_b32 v98, 0xffff0000, v96
    v_sub_f32 v99, v96, v98
    v_cvt_pk_bf16_f32 v28, -v98, -v98
    s_waitcnt lgkmcnt(2)
    v_mfma_f32_32x32x16_bf16 v[48:63], v[248:251], v[68:71], v[48:63]
    v_cvt_pk_bf16_f32 v29, -v99, 0
    ds_write_b32 v25, v20
    ds_read_b128 v[96:99], v26 offset:0
    s_waitcnt vmcnt(0) lgkmcnt(3)
    v_mfma_f32_32x32x16_bf16 v[32:47], v[72:75], v[252:255], v[32:47]
    v_or3_b32 v23, v23, v248, v252
    ds_read_b128 v[100:103], v26 offset:32
    ds_read_b128 v[104:107], v26 offset:64
    ds_read_b128 v[108:111], v26 offset:96
    s_waitcnt lgkmcnt(5)
    v_mfma_f32_32x32x16_bf16 v[48:63], v[252:255], v[76:79], v[48:63]
    v_and_b32 v23, 1, v23
    v_cmp_ne_u32 vcc, 0, v23
    s_cbranch_vccnz Lver_108
Lverc_109:
    v_mfma_f32_32x32x16_bf16 v[32:47], v[88:91], v[28:31], v[32:47]
    v_mfma_f32_32x32x16_bf16 v[48:63], v[28:31], v[92:95], v[48:63]
    ds_read_b128 v[64:67], v5 offset:0
    ds_read_b128 v[68:71], v5 offset:1024
    ds_read_b128 v[72:75], v5 offset:2048
    ds_read_b128 v[76:79], v5 offset:3072
    ds_read_b128 v[80:83], v5 offset:4096
    s_waitcnt lgkmcnt(5)
    s_nop 4
    v_pk_mul_f32 v[32:33], v[32:33], v[20:21] op_sel_hi:[1,0]
    v_pk_mul_f32 v[34:35], v[34:35], v[20:21] op_sel_hi:[1,0]
    v_pk_mul_f32 v[36:37], v[36:37], v[20:21] op_sel_hi:[1,0]
    v_pk_mul_f32 v[38:39], v[38:39], v[20:21] op_sel_hi:[1,0]
    v_pk_mul_f32 v[40:41], v[40:41], v[20:21] op_sel_hi:[1,0]
    v_pk_mul_f32 v[42:43], v[42:43], v[20:21] op_sel_hi:[1,0]
    v_pk_mul_f32 v[44:45], v[44:45], v[20:21] op_sel_hi:[1,0]
    v_pk_mul_f32 v[46:47], v[46:47], v[20:21] op_sel_hi:[1,0]
    v_cvt_pk_bf16_f32 v112, v32, v33
    v_cvt_pk_bf16_f32 v113, v34, v35
    v_cvt_pk_bf16_f32 v114, v36, v37
    v_cvt_pk_bf16_f32 v115, v38, v39
    v_cvt_pk_bf16_f32 v116, v40, v41
    v_cvt_pk_bf16_f32 v117, v42, v43
    v_cvt_pk_bf16_f32 v118, v44, v45
    v_cvt_pk_bf16_f32 v119, v46, v47
    s_waitcnt lgkmcnt(4)
    v_mfma_f32_32x32x16_bf16 v[32:47], v[64:67], v[128:131], 0
    ds_read_b128 v[64:67], v5 offset:5120
    buffer_store_dwordx4 v[112:115], v2, s[4:7], s91 offen offset:0 sc1
    buffer_store_dwordx4 v[116:119], v2, s[4:7], s91 offen offset:1024 sc1
    v_mul_f32 v48, v96, v48
    v_mul_f32 v49, v97, v49
    s_waitcnt lgkmcnt(4)
    v_mfma_f32_32x32x16_bf16 v[32:47], v[68:71], v[132:135], v[32:47]
    ds_read_b128 v[68:71], v5 offset:6144
    v_mul_f32 v50, v98, v50
    v_mul_f32 v51, v99, v51
    v_mul_f32 v52, v100, v52
    v_mul_f32 v53, v101, v53
    s_waitcnt lgkmcnt(4)
    v_mfma_f32_32x32x16_bf16 v[32:47], v[72:75], v[136:139], v[32:47]
    ds_read_b128 v[72:75], v5 offset:7168
    v_mul_f32 v54, v102, v54
    v_mul_f32 v55, v103, v55
    v_cvt_pk_bf16_f32 v120, v48, v49
    v_cvt_pk_bf16_f32 v121, v50, v51
    s_waitcnt lgkmcnt(4)
    v_mfma_f32_32x32x16_bf16 v[32:47], v[76:79], v[140:143], v[32:47]
    ds_read_b128 v[76:79], v5 offset:8192
    v_cvt_pk_bf16_f32 v122, v52, v53
    v_cvt_pk_bf16_f32 v123, v54, v55
    buffer_store_dwordx4 v[120:123], v2, s[4:7], s91 offen offset:2048 sc1
    v_mul_f32 v56, v104, v56
    s_waitcnt lgkmcnt(4)
    v_mfma_f32_32x32x16_bf16 v[32:47], v[80:83], v[144:147], v[32:47]
    ds_read_b128 v[80:83], v5 offset:9216
    v_mul_f32 v57, v105, v57
    v_mul_f32 v58, v106, v58
    v_mul_f32 v59, v107, v59
    v_mul_f32 v60, v108, v60
    s_waitcnt lgkmcnt(4)
    v_mfma_f32_32x32x16_bf16 v[32:47], v[64:67], v[148:151], v[32:47]
    ds_read_b128 v[64:67], v5 offset:10240
    v_mul_f32 v61, v109, v61
    v_mul_f32 v62, v110, v62
    v_mul_f32 v63, v111, v63
    v_cvt_pk_bf16_f32 v124, v56, v57
    s_waitcnt lgkmcnt(4)
    v_mfma_f32_32x32x16_bf16 v[32:47], v[68:71], v[152:155], v[32:47]
    ds_read_b128 v[68:71], v5 offset:11264
    v_cvt_pk_bf16_f32 v125, v58, v59
    v_cvt_pk_bf16_f32 v126, v60, v61
    v_cvt_pk_bf16_f32 v127, v62, v63
    buffer_store_dwordx4 v[124:127], v2, s[4:7], s91 offen offset:3072 sc1
    s_waitcnt lgkmcnt(4)
    v_mfma_f32_32x32x16_bf16 v[32:47], v[72:75], v[156:159], v[32:47]
    ds_read_b128 v[72:75], v5 offset:12288
    v_add3_u32 v23, s43, v112, v113
    v_add3_u32 v23, v23, v114, v115
    v_add3_u32 v23, v23, v116, v117
    v_add3_u32 v23, v23, v118, v119
    s_waitcnt lgkmcnt(4)
    v_mfma_f32_32x32x16_bf16 v[32:47], v[76:79], v[160:163], v[32:47]
    ds_read_b128 v[76:79], v5 offset:13312
    v_add3_u32 v23, v23, v120, v121
    v_add3_u32 v23, v23, v122, v123
    v_add3_u32 v23, v23, v124, v125
    v_add3_u32 v23, v23, v126, v127
    s_waitcnt lgkmcnt(4)
    v_mfma_f32_32x32x16_bf16 v[32:47], v[80:83], v[164:167], v[32:47]
    ds_read_b128 v[80:83], v5 offset:14336
    buffer_store_dword v23, v3, s[4:7], s93 offen sc1
    ds_write_b128 v21, v[112:115] offset:0
    ds_write_b128 v21, v[116:119] offset:1024
    ds_write_b128 v21, v[120:123] offset:2048
    s_waitcnt lgkmcnt(7)
    v_mfma_f32_32x32x16_bf16 v[32:47], v[64:67], v[168:171], v[32:47]
    ds_read_b128 v[64:67], v5 offset:15360
    ds_write_b128 v21, v[124:127] offset:3072
    v_subrev_f32 v96, 0x0, v27
    v_subrev_f32 v97, 0x71800000, v27
    v_subrev_f32 v98, 0x72000000, v27
    s_waitcnt lgkmcnt(8)
    v_mfma_f32_32x32x16_bf16 v[32:47], v[68:71], v[172:175], v[32:47]
    ds_read_b128 v[68:71], v5 offset:16384
    v_subrev_f32 v99, 0x72400000, v27
    v_subrev_f32 v100, 0x73000000, v27
    v_subrev_f32 v101, 0x73100000, v27
    v_subrev_f32 v102, 0x73200000, v27
    s_waitcnt lgkmcnt(8)
    v_mfma_f32_32x32x16_bf16 v[32:47], v[72:75], v[176:179], v[32:47]
    ds_read_b128 v[72:75], v5 offset:17408
    v_subrev_f32 v103, 0x73300000, v27
    v_subrev_f32 v104, 0x73800000, v27
    v_subrev_f32 v105, 0x73880000, v27
    v_subrev_f32 v106, 0x73900000, v27
    s_waitcnt lgkmcnt(8)
    v_mfma_f32_32x32x16_bf16 v[32:47], v[76:79], v[180:183], v[32:47]
    ds_read_b128 v[76:79], v5 offset:18432
    v_subrev_f32 v107, 0x73980000, v27
    v_subrev_f32 v108, 0x73c00000, v27
    v_subrev_f32 v109, 0x73c80000, v27
    v_subrev_f32 v110, 0x73d00000, v27
    s_waitcnt lgkmcnt(8)
    v_mfma_f32_32x32x16_bf16 v[32:47], v[80:83], v[184:187], v[32:47]
    ds_read_b128 v[80:83], v5 offset:19456
    v_subrev_f32 v111, 0x73d80000, v27
    ds_read_b128 v[84:87], v0
    v_min_f32 v96, 0, v96
    v_min_f32 v97, 0, v97
    s_waitcnt lgkmcnt(6)
    v_mfma_f32_32x32x16_bf16 v[32:47], v[64:67], v[188:191], v[32:47]
    ds_read_b128 v[64:67], v5 offset:20480
    v_min_f32 v98, 0, v98
    v_min_f32 v99, 0, v99
    v_min_f32 v100, 0, v100
    v_min_f32 v101, 0, v101
    s_waitcnt lgkmcnt(5)
    v_mfma_f32_32x32x16_bf16 v[32:47], v[68:71], v[192:195], v[32:47]
    ds_read_b128 v[68:71], v5 offset:21504
    v_min_f32 v102, 0, v102
    v_min_f32 v103, 0, v103
    v_min_f32 v104, 0, v104
    v_min_f32 v105, 0, v105
    s_waitcnt lgkmcnt(5)
    v_mfma_f32_32x32x16_bf16 v[32:47], v[72:75], v[196:199], v[32:47]
    ds_read_b128 v[72:75], v5 offset:22528
    v_min_f32 v106, 0, v106
    v_min_f32 v107, 0, v107
    v_min_f32 v108, 0, v108
    v_min_f32 v109, 0, v109
    s_waitcnt lgkmcnt(5)
    v_mfma_f32_32x32x16_bf16 v[32:47], v[76:79], v[200:203], v[32:47]
    ds_read_b128 v[76:79], v5 offset:23552
    v_min_f32 v110, 0, v110
    v_min_f32 v111, 0, v111
    v_mul_f32 v20, 0x3eb8aa3b, v20
    s_waitcnt lgkmcnt(4)
    v_add_f32 v84, v84, v85
    v_mfma_f32_32x32x16_bf16 v[32:47], v[80:83], v[204:207], v[32:47]
    ds_read_b128 v[80:83], v5 offset:24576
    v_add_f32 v86, v86, v87
    v_add_f32 v84, v84, v86
    v_and_b32 v86, 0xffff0000, v84
    v_sub_f32 v87, v84, v86
    s_waitcnt lgkmcnt(4)
    v_mfma_f32_32x32x16_bf16 v[32:47], v[64:67], v[208:211], v[32:47]
    ds_read_b128 v[64:67], v5 offset:25600
    v_cvt_pk_bf16_f32 v84, v86, v87
    v_cvt_pk_bf16_f32 v85, v86, 0
    v_mov_b32 v86, 0
    v_mov_b32 v87, 0
    s_waitcnt lgkmcnt(4)
    v_mfma_f32_32x32x16_bf16 v[32:47], v[68:71], v[212:215], v[32:47]
    ds_read_b128 v[68:71], v5 offset:26624
    v_sub_f32 v112, 0xf1800000, v27
    v_sub_f32 v113, 0x0, v27
    v_sub_f32 v114, 0x71800000, v27
    v_sub_f32 v115, 0x72000000, v27
    s_waitcnt lgkmcnt(4)
    v_mfma_f32_32x32x16_bf16 v[32:47], v[72:75], v[216:219], v[32:47]
    ds_read_b128 v[72:75], v5 offset:27648
    v_sub_f32 v116, 0x72e00000, v27
    v_sub_f32 v117, 0x73000000, v27
    v_sub_f32 v118, 0x73100000, v27
    v_sub_f32 v119, 0x73200000, v27
    s_waitcnt lgkmcnt(4)
    v_mfma_f32_32x32x16_bf16 v[32:47], v[76:79], v[220:223], v[32:47]
    ds_read_b128 v[76:79], v5 offset:28672
    v_sub_f32 v120, 0x73700000, v27
    v_sub_f32 v121, 0x73800000, v27
    v_sub_f32 v122, 0x73880000, v27
    v_sub_f32 v123, 0x73900000, v27
    s_waitcnt lgkmcnt(4)
    v_mfma_f32_32x32x16_bf16 v[32:47], v[80:83], v[224:227], v[32:47]
    ds_read_b128 v[80:83], v5 offset:29696
    v_sub_f32 v124, 0x73b80000, v27
    v_sub_f32 v125, 0x73c00000, v27
    v_sub_f32 v126, 0x73c80000, v27
    v_sub_f32 v127, 0x73d00000, v27
    s_waitcnt lgkmcnt(4)
    v_mfma_f32_32x32x16_bf16 v[32:47], v[64:67], v[228:231], v[32:47]
    ds_read_b128 v[64:67], v5 offset:30720
    v_min_f32 v112, 0, v112
    v_min_f32 v113, 0, v113
    v_min_f32 v114, 0, v114
    v_min_f32 v115, 0, v115
    s_waitcnt lgkmcnt(4)
    v_mfma_f32_32x32x16_bf16 v[32:47], v[68:71], v[232:235], v[32:47]
    ds_read_b128 v[68:71], v5 offset:31744
    v_min_f32 v116, 0, v116
    v_min_f32 v117, 0, v117
    v_min_f32 v118, 0, v118
    v_min_f32 v119, 0, v119
    s_waitcnt lgkmcnt(4)
    v_mfma_f32_32x32x16_bf16 v[32:47], v[72:75], v[236:239], v[32:47]
    v_min_f32 v120, 0, v120
    v_min_f32 v121, 0, v121
    v_min_f32 v122, 0, v122
    v_min_f32 v123, 0, v123
    s_waitcnt lgkmcnt(3)
    v_mfma_f32_32x32x16_bf16 v[32:47], v[76:79], v[240:243], v[32:47]
    v_min_f32 v124, 0, v124
    v_min_f32 v125, 0, v125
    v_min_f32 v126, 0, v126
    v_min_f32 v127, 0, v127
    s_waitcnt lgkmcnt(2)
    v_mfma_f32_32x32x16_bf16 v[32:47], v[80:83], v[244:247], v[32:47]
    s_waitcnt lgkmcnt(1)
    v_mfma_f32_32x32x16_bf16 v[32:47], v[64:67], v[248:251], v[32:47]
    s_waitcnt lgkmcnt(0)
    v_mfma_f32_32x32x16_bf16 v[32:47], v[68:71], v[252:255], v[32:47]
    v_mfma_f32_32x32x16_bf16 v[32:47], v[84:87], v[28:31], v[32:47]
    s_add_u32 s91, s72, 10485760
    s_add_u32 s92, s73, 36864
    s_add_u32 s53, s42, 0
    s_mov_b32 s54, -6144
    s_add_u32 s96, s74, 23461888
    s_add_u32 s97, s96, 71680
    s_lshl_b32 s70, s39, 13
    s_add_u32 s70, s70, 65536
    v_add_u32 v67, 4096, v3
    v_mov_b32 v22, v21
    v_mov_b32 v64, 159424
    v_cndmask_b32 v22, v64, v22, s[50:51]
    v_mov_b32 v64, s54
    v_cndmask_b32 v64, 0, v64, s[50:51]
    v_mov_b32 v84, 0
    v_mov_b32 v85, 0
    v_mov_b32 v86, 0
    v_mov_b32 v87, 0
    s_nop 1
    v_mfma_f32_32x32x16_bf16 v[48:63], v[84:87], v[84:87], 0
    v_pk_mul_f32 v[40:41], v[40:41], v[20:21] op_sel_hi:[1,0]
    v_pk_mul_f32 v[42:43], v[42:43], v[20:21] op_sel_hi:[1,0]
    v_pk_mul_f32 v[44:45], v[44:45], v[20:21] op_sel_hi:[1,0]
    v_pk_mul_f32 v[46:47], v[46:47], v[20:21] op_sel_hi:[1,0]
    v_cvt_pk_bf16_f32 v76, v40, v41
    v_cvt_pk_bf16_f32 v77, v42, v43
    v_cvt_pk_bf16_f32 v78, v44, v45
    v_cvt_pk_bf16_f32 v79, v46, v47
    ds_write_b128 v21, v[76:79] offset:5120
    v_pk_mul_f32 v[32:33], v[32:33], v[20:21] op_sel_hi:[1,0]
    v_pk_mul_f32 v[34:35], v[34:35], v[20:21] op_sel_hi:[1,0]
    v_pk_mul_f32 v[36:37], v[36:37], v[20:21] op_sel_hi:[1,0]
    v_pk_mul_f32 v[38:39], v[38:39], v[20:21] op_sel_hi:[1,0]
    v_cvt_pk_bf16_f32 v72, v32, v33
    v_cvt_pk_bf16_f32 v73, v34, v35
    v_cvt_pk_bf16_f32 v74, v36, v37
    v_cvt_pk_bf16_f32 v75, v38, v39
    s_setprio 1
    s_cmp_ge_u32 s42, 2
    s_cbranch_scc0 Lpr_110
    s_setprio 2
Lpr_110:
    s_waitcnt lgkmcnt(0)
    s_barrier
    s_branch L_j1_2
L_aux_2:
    v_mov_b32 v23, 1
    s_mov_b64 exec, 1
    s_waitcnt lgkmcnt(0)
    ds_add_u32 v4, v23 offset:40
    s_mov_b64 exec, -1
    s_cmp_lg_u32 s39, 3
    s_cbranch_scc1 Lx_111
    s_lshl_b32 s46, s37, 10
    s_add_u32 s46, s46, (L_main_3 - interleave_layers__sliding_block__linear_kernel_hedgehog__prompt_kernel)
    s_cmp_ge_u32 s46, (L_end - interleave_layers__sliding_block__linear_kernel_hedgehog__prompt_kernel - 1088)
    s_cbranch_scc1 Lx_111
    v_add_u32 v28, s46, v2
    v_mov_b32 v29, s85
    v_add_co_u32 v28, vcc, s84, v28
    s_nop 1
    v_addc_co_u32 v29, vcc, 0, v29, vcc
    global_load_dword v26, v[28:29], off
Lx_111:
    s_lshl_b32 s46, s39, 2
    s_cmp_lg_u32 s46, s37
    s_cbranch_scc1 Lx_112
    s_setprio 3
    v_and_b32 v24, 60, v3
    s_add_u32 s48, s82, 12288
    s_add_u32 s46, s43, 1
    s_lshr_b32 s47, s83, 3
    s_add_u32 s47, s47, 1048576
    s_lshr_b32 s49, s83, 6
    s_add_u32 s49, s49, 73728
    v_and_b32 v82, 15, v1
    v_lshrrev_b32 v81, 4, v1
    v_lshl_add_u32 v82, v82, 2, v81
    v_lshlrev_b32 v82, 3, v82
    v_add_u32 v81, s43, 2
Lpoll_115:
    buffer_load_dword v23, v24, s[4:7], s48 offen sc1
    s_waitcnt vmcnt(0)
    v_cmp_ne_u32 vcc, s46, v23
    s_cbranch_vccz Lpolld_116
    s_sleep 1
    s_sub_u32 s45, s45, 1
    s_cbranch_scc0 Lpoll_115
    s_mov_b32 s45, 0
Lpolld_116:
Lred_113:
    buffer_load_dwordx4 v[64:67], v2, s[4:7], s47 offen offset:0 sc1
    buffer_load_dwordx4 v[68:71], v2, s[4:7], s47 offen offset:1024 sc1
    buffer_load_dwordx4 v[72:75], v2, s[4:7], s47 offen offset:2048 sc1
    buffer_load_dwordx4 v[76:79], v2, s[4:7], s47 offen offset:3072 sc1
    v_mov_b32 v23, 0
    s_waitcnt vmcnt(3)
    v_or3_b32 v23, v23, v64, v65
    v_or3_b32 v23, v23, v66, v67
    s_waitcnt vmcnt(2)
    v_or3_b32 v23, v23, v68, v69
    v_or3_b32 v23, v23, v70, v71
    v_add_f32 v64, v64, v68
    v_add_f32 v65, v65, v69
    v_add_f32 v66, v66, v70
    v_add_f32 v67, v67, v71
    s_waitcnt vmcnt(1)
    v_or3_b32 v23, v23, v72, v73
    v_or3_b32 v23, v23, v74, v75
    v_add_f32 v64, v64, v72
    v_add_f32 v65, v65, v73
    v_add_f32 v66, v66, v74
    v_add_f32 v67, v67, v75
    s_waitcnt vmcnt(0)
    v_or3_b32 v23, v23, v76, v77
    v_or3_b32 v23, v23, v78, v79
    v_add_f32 v64, v64, v76
    v_add_f32 v65, v65, v77
    v_add_f32 v66, v66, v78
    v_add_f32 v67, v67, v79
    v_and_b32 v23, 1, v23
    v_cmp_ne_u32 vcc, 0, v23
    v_permlane32_swap_b32 v64, v66
    v_permlane32_swap_b32 v65, v67
    v_add_f32 v64, v64, v66
    v_add_f32 v65, v65, v67
    s_nop 1
    v_permlane16_swap_b32 v64, v65
    v_add_f32 v80, v64, v65
    s_cbranch_vccz Lredd_114
    s_sub_u32 s45, s45, 1
    s_cbranch_scc0 Lred_113
    s_mov_b32 s45, 0
Lredd_114:
    s_cmp_eq_u32 s44, 0
    s_cbranch_scc1 Lsafe_117
    buffer_store_dwordx2 v[80:81], v82, s[4:7], s49 offen
Lpub_118:
    s_setprio 0
Lx_112:
    v_mov_b32 v192, v32
    v_mov_b32 v193, v33
    v_mov_b32 v194, v34
    v_mov_b32 v195, v35
    v_mov_b32 v196, v36
    v_mov_b32 v197, v37
    v_mov_b32 v198, v38
    v_mov_b32 v199, v39
    v_mov_b32 v200, v40
    v_mov_b32 v201, v41
    v_mov_b32 v202, v42
    v_mov_b32 v203, v43
    v_mov_b32 v204, v44
    v_mov_b32 v205, v45
    v_mov_b32 v206, v46
    v_mov_b32 v207, v47
    v_mov_b32 v208, v48
    v_mov_b32 v209, v49
    v_mov_b32 v210, v50
    v_mov_b32 v211, v51
    v_mov_b32 v212, v52
    v_mov_b32 v213, v53
    v_mov_b32 v214, v54
    v_mov_b32 v215, v55
    v_mov_b32 v216, v56
    v_mov_b32 v217, v57
    v_mov_b32 v218, v58
    v_mov_b32 v219, v59
    v_mov_b32 v220, v60
    v_mov_b32 v221, v61
    v_mov_b32 v222, v62
    v_mov_b32 v223, v63
Llw_119:
    s_sleep 2
    ds_read_b32 v23, v4 offset:16
    s_waitcnt lgkmcnt(0)
    v_cmp_gt_u32 vcc, 12, v23
    s_cbranch_vccnz Llw_119
    v_add_u32 v29, 98304, v11
    ds_read_b64_tr_b16 v[32:33], v29 offset:0
    ds_read_b64_tr_b16 v[34:35], v29 offset:512
    ds_read_b64_tr_b16 v[36:37], v29 offset:1024
    ds_read_b64_tr_b16 v[38:39], v29 offset:1536
    ds_read_b64_tr_b16 v[40:41], v29 offset:8192
    ds_read_b64_tr_b16 v[42:43], v29 offset:8704
    ds_read_b64_tr_b16 v[44:45], v29 offset:9216
    ds_read_b64_tr_b16 v[46:47], v29 offset:9728
    ds_read_b64_tr_b16 v[48:49], v29 offset:16384
    ds_read_b64_tr_b16 v[50:51], v29 offset:16896
    ds_read_b64_tr_b16 v[52:53], v29 offset:17408
    ds_read_b64_tr_b16 v[54:55], v29 offset:17920
    ds_read_b64_tr_b16 v[56:57], v29 offset:24576
    ds_read_b64_tr_b16 v[58:59], v29 offset:25088
    ds_read_b64_tr_b16 v[60:61], v29 offset:25600
    ds_read_b64_tr_b16 v[62:63], v29 offset:26112
    s_waitcnt lgkmcnt(0)
    v_add_u32 v0, 98304, v10
    ds_write_b128 v0, v[224:227] offset:0
    ds_write_b128 v0, v[228:231] offset:1024
    ds_write_b128 v0, v[232:235] offset:8192
    ds_write_b128 v0, v[236:239] offset:9216
    ds_write_b128 v0, v[240:243] offset:16384
    ds_write_b128 v0, v[244:247] offset:17408
    ds_write_b128 v0, v[248:251] offset:24576
    ds_write_b128 v0, v[252:255] offset:25600
    s_waitcnt lgkmcnt(0)
    v_mov_b32 v224, v32
    v_mov_b32 v225, v33
    v_mov_b32 v226, v34
    v_mov_b32 v227, v35
    v_mov_b32 v228, v36
    v_mov_b32 v229, v37
    v_mov_b32 v230, v38
    v_mov_b32 v231, v39
    v_mov_b32 v232, v40
    v_mov_b32 v233, v41
    v_mov_b32 v234, v42
    v_mov_b32 v235, v43
    v_mov_b32 v236, v44
    v_mov_b32 v237, v45
    v_mov_b32 v238, v46
    v_mov_b32 v239, v47
    v_mov_b32 v240, v48
    v_mov_b32 v241, v49
    v_mov_b32 v242, v50
    v_mov_b32 v243, v51
    v_mov_b32 v244, v52
    v_mov_b32 v245, v53
    v_mov_b32 v246, v54
    v_mov_b32 v247, v55
    v_mov_b32 v248, v56
    v_mov_b32 v249, v57
    v_mov_b32 v250, v58
    v_mov_b32 v251, v59
    v_mov_b32 v252, v60
    v_mov_b32 v253, v61
    v_mov_b32 v254, v62
    v_mov_b32 v255, v63
    v_mov_b32 v88, 0x3f803f80
    v_mov_b32 v89, v88
    v_mov_b32 v90, v88
    v_mov_b32 v91, v88
    v_mov_b32 v92, v88
    v_mov_b32 v93, v88
    v_mov_b32 v94, v88
    v_mov_b32 v95, v88
    v_subrev_f32 v96, 0x0, v27
    v_subrev_f32 v97, 0x71800000, v27
    v_subrev_f32 v98, 0x72000000, v27
    v_subrev_f32 v99, 0x72400000, v27
    v_subrev_f32 v100, 0x73000000, v27
    v_subrev_f32 v101, 0x73100000, v27
    v_subrev_f32 v102, 0x73200000, v27
    v_subrev_f32 v103, 0x73300000, v27
    v_subrev_f32 v104, 0x73800000, v27
    v_subrev_f32 v105, 0x73880000, v27
    v_subrev_f32 v106, 0x73900000, v27
    v_subrev_f32 v107, 0x73980000, v27
    v_subrev_f32 v108, 0x73c00000, v27
    v_subrev_f32 v109, 0x73c80000, v27
    v_subrev_f32 v110, 0x73d00000, v27
    v_subrev_f32 v111, 0x73d80000, v27
    v_min_f32 v96, 0, v96
    v_min_f32 v97, 0, v97
    v_min_f32 v98, 0, v98
    v_min_f32 v99, 0, v99
    v_min_f32 v100, 0, v100
    v_min_f32 v101, 0, v101
    v_min_f32 v102, 0, v102
    v_min_f32 v103, 0, v103
    v_min_f32 v104, 0, v104
    v_min_f32 v105, 0, v105
    v_min_f32 v106, 0, v106
    v_min_f32 v107, 0, v107
    v_min_f32 v108, 0, v108
    v_min_f32 v109, 0, v109
    v_min_f32 v110, 0, v110
    v_min_f32 v111, 0, v111
    v_mov_b32 v48, 0
    v_mov_b32 v49, 0
    v_mov_b32 v50, 0
    v_mov_b32 v51, 0
    v_mov_b32 v52, 0
    v_mov_b32 v53, 0
    v_mov_b32 v54, 0
    v_mov_b32 v55, 0
    v_mov_b32 v56, 0
    v_mov_b32 v57, 0
    v_mov_b32 v58, 0
    v_mov_b32 v59, 0
    v_mov_b32 v60, 0
    v_mov_b32 v61, 0
    v_mov_b32 v62, 0
    v_mov_b32 v63, 0
    v_sub_f32 v112, 0xf1800000, v27
    v_sub_f32 v113, 0x0, v27
    v_sub_f32 v114, 0x71800000, v27
    v_sub_f32 v115, 0x72000000, v27
    v_sub_f32 v116, 0x72e00000, v27
    v_sub_f32 v117, 0x73000000, v27
    v_sub_f32 v118, 0x73100000, v27
    v_sub_f32 v119, 0x73200000, v27
    v_sub_f32 v120, 0x73700000, v27
    v_sub_f32 v121, 0x73800000, v27
    v_sub_f32 v122, 0x73880000, v27
    v_sub_f32 v123, 0x73900000, v27
    v_sub_f32 v124, 0x73b80000, v27
    v_sub_f32 v125, 0x73c00000, v27
    v_sub_f32 v126, 0x73c80000, v27
    v_sub_f32 v127, 0x73d00000, v27
    v_min_f32 v112, 0, v112
    v_min_f32 v113, 0, v113
    v_min_f32 v114, 0, v114
    v_min_f32 v115, 0, v115
    v_min_f32 v116, 0, v116
    v_min_f32 v117, 0, v117
    v_min_f32 v118, 0, v118
    v_min_f32 v119, 0, v119
    v_min_f32 v120, 0, v120
    v_min_f32 v121, 0, v121
    v_min_f32 v122, 0, v122
    v_min_f32 v123, 0, v123
    v_min_f32 v124, 0, v124
    v_min_f32 v125, 0, v125
    v_min_f32 v126, 0, v126
    v_min_f32 v127, 0, v127
    s_lshl_b32 s47, s40, 10
    s_add_u32 s47, s47, s78
    v_add_u32 v21, s47, v2
    s_lshl_b32 s47, s40, 8
    v_xor_b32 v22, s47, v2
    v_add_u32 v22, s78, v22
    s_add_u32 s91, s72, 10485760
    s_add_u32 s92, s73, 36864
    s_add_u32 s53, s42, 0
    s_mov_b32 s54, -6144
    s_add_u32 s96, s74, 23461888
    s_add_u32 s97, s96, 71680
    s_lshl_b32 s70, s39, 13
    s_add_u32 s70, s70, 65536
    v_add_u32 v67, 4096, v3
    v_mov_b32 v64, 159424
    v_cndmask_b32 v22, v64, v22, s[50:51]
    v_mov_b32 v64, s54
    v_cndmask_b32 v64, 0, v64, s[50:51]
    v_mov_b32 v84, 0
    v_mov_b32 v85, 0
    v_mov_b32 v86, 0
    v_mov_b32 v87, 0
    s_setprio 1
    s_cmp_ge_u32 s42, 2
    s_cbranch_scc0 Lpr_120
    s_setprio 2
Lpr_120:
    s_barrier
    ds_read_b128 v[72:75], v21 offset:4096
L_j1_2:
    s_cmp_eq_u32 s75, 0
    s_cbranch_scc1 Lx_121
    s_add_u32 m0, s70, 0
    s_nop 0
    buffer_load_dwordx4 v2, s[4:7], s96 offen offset:0 sc1 lds
    buffer_load_dwordx4 v2, s[4:7], s96 offen offset:1024 sc1 lds
    buffer_load_dwordx4 v2, s[4:7], s96 offen offset:2048 sc1 lds
    buffer_load_dwordx4 v2, s[4:7], s96 offen offset:3072 sc1 lds
    buffer_load_dword v65, v67, s[4:7], s96 offen sc1
    s_add_u32 m0, s70, 4096
    s_nop 0
    buffer_load_dwordx4 v2, s[4:7], s97 offen offset:0 sc1 lds
    buffer_load_dwordx4 v2, s[4:7], s97 offen offset:1024 sc1 lds
    buffer_load_dwordx4 v2, s[4:7], s97 offen offset:2048 sc1 lds
    buffer_load_dwordx4 v2, s[4:7], s97 offen offset:3072 sc1 lds
    buffer_load_dword v66, v67, s[4:7], s97 offen sc1
Lx_121:
    ds_read_b128 v[80:83], v21
    v_add_u32 v21, s54, v21
    ds_read_b128 v[76:79], v21
    v_add_u32 v21, s54, v21
    ds_read_b128 v[88:91], v22 offset:2048
    s_waitcnt lgkmcnt(2)
    v_mfma_f32_32x32x16_bf16 v[96:111], v[80:83], v[72:75], v[96:111]
    s_waitcnt lgkmcnt(1)
    s_nop 6
Latt_122:
    s_waitcnt lgkmcnt(2)
    v_mfma_f32_32x32x16_bf16 v[32:47], v[76:79], v[72:75], 0
    ds_read_b128 v[76:79], v21
    v_add_u32 v21, s54, v21
    v_exp_f32 v96, v96
    v_exp_f32 v97, v97
    v_exp_f32 v98, v98
    v_exp_f32 v99, v99
    s_waitcnt lgkmcnt(2)
    v_mfma_f32_32x32x16_bf16 v[48:63], v[92:95], v[84:87], v[48:63]
    ds_read_b128 v[92:95], v22 offset:3072
    v_add_u32 v22, v64, v22
    v_exp_f32 v100, v100
    v_exp_f32 v101, v101
    v_exp_f32 v102, v102
    v_exp_f32 v103, v103
    v_exp_f32 v104, v104
    v_exp_f32 v105, v105
    v_perm_b32 v80, v97, v96, s63
    v_perm_b32 v81, v99, v98, s63
    v_perm_b32 v82, v101, v100, s63
    v_perm_b32 v83, v103, v102, s63
    v_exp_f32 v106, v106
    v_exp_f32 v107, v107
    s_waitcnt lgkmcnt(2)
    v_mfma_f32_32x32x16_bf16 v[48:63], v[88:91], v[80:83], v[48:63]
    ds_read_b128 v[88:91], v22 offset:2048
    v_exp_f32 v108, v108
    v_exp_f32 v109, v109
    v_exp_f32 v110, v110
    v_exp_f32 v111, v111
    s_sub_u32 s53, s53, 1
    v_perm_b32 v84, v105, v104, s63
    v_perm_b32 v85, v107, v106, s63
    v_perm_b32 v86, v109, v108, s63
    v_perm_b32 v87, v111, v110, s63
    s_cbranch_scc1 Lattd_123
    s_waitcnt lgkmcnt(2)
    v_mfma_f32_32x32x16_bf16 v[96:111], v[76:79], v[72:75], 0
    ds_read_b128 v[76:79], v21
    v_add_u32 v21, s54, v21
    v_exp_f32 v32, v32
    v_exp_f32 v33, v33
    v_exp_f32 v34, v34
    v_exp_f32 v35, v35
    s_waitcnt lgkmcnt(2)
    v_mfma_f32_32x32x16_bf16 v[48:63], v[92:95], v[84:87], v[48:63]
    ds_read_b128 v[92:95], v22 offset:3072
    v_add_u32 v22, v64, v22
    v_exp_f32 v36, v36
    v_exp_f32 v37, v37
    v_exp_f32 v38, v38
    v_exp_f32 v39, v39
    v_exp_f32 v40, v40
    v_exp_f32 v41, v41
    v_perm_b32 v80, v33, v32, s63
    v_perm_b32 v81, v35, v34, s63
    v_perm_b32 v82, v37, v36, s63
    v_perm_b32 v83, v39, v38, s63
    v_exp_f32 v42, v42
    v_exp_f32 v43, v43
    s_waitcnt lgkmcnt(2)
    v_mfma_f32_32x32x16_bf16 v[48:63], v[88:91], v[80:83], v[48:63]
    ds_read_b128 v[88:91], v22 offset:2048
    v_exp_f32 v44, v44
    v_exp_f32 v45, v45
    v_exp_f32 v46, v46
    v_exp_f32 v47, v47
    s_sub_u32 s53, s53, 1
    v_perm_b32 v84, v41, v40, s63
    v_perm_b32 v85, v43, v42, s63
    v_perm_b32 v86, v45, v44, s63
    v_perm_b32 v87, v47, v46, s63
    s_cbranch_scc0 Latt_122
Lattd_123:
    s_lshl_b32 s47, s40, 10
    s_add_u32 s47, s47, s76
    v_add_u32 v21, s47, v2
    s_lshl_b32 s47, s40, 8
    v_xor_b32 v22, s47, v2
    v_add_u32 v22, s76, v22
    s_sub_u32 s53, s77, 1
    s_mov_b32 s54, 4096
    v_mov_b32 v64, 159424
    v_cndmask_b32 v22, v64, v22, s[50:51]
    v_mov_b32 v64, s54
    v_cndmask_b32 v64, 0, v64, s[50:51]
    s_setprio 1
    s_cmp_lt_u32 s42, 2
    s_cbranch_scc0 Lpr_124
    s_setprio 2
Lpr_124:
    s_cmp_eq_u32 s75, 0
    s_cbranch_scc1 Lnh_128
    v_add_u32 v0, s70, v2
    s_branch Lhchk_126
Lhalo_125:
    s_add_u32 m0, s70, 0
    s_nop 0
    buffer_load_dwordx4 v2, s[4:7], s96 offen offset:0 sc1 lds
    buffer_load_dwordx4 v2, s[4:7], s96 offen offset:1024 sc1 lds
    buffer_load_dwordx4 v2, s[4:7], s96 offen offset:2048 sc1 lds
    buffer_load_dwordx4 v2, s[4:7], s96 offen offset:3072 sc1 lds
    buffer_load_dword v65, v67, s[4:7], s96 offen sc1
    s_add_u32 m0, s70, 4096
    s_nop 0
    buffer_load_dwordx4 v2, s[4:7], s97 offen offset:0 sc1 lds
    buffer_load_dwordx4 v2, s[4:7], s97 offen offset:1024 sc1 lds
    buffer_load_dwordx4 v2, s[4:7], s97 offen offset:2048 sc1 lds
    buffer_load_dwordx4 v2, s[4:7], s97 offen offset:3072 sc1 lds
    buffer_load_dword v66, v67, s[4:7], s97 offen sc1
Lhchk_126:
    s_waitcnt vmcnt(5)
    ds_read_b128 v[32:35], v0 offset:0
    ds_read_b128 v[36:39], v0 offset:1024
    ds_read_b128 v[40:43], v0 offset:2048
    ds_read_b128 v[44:47], v0 offset:3072
    s_waitcnt vmcnt(0)
    ds_read_b128 v[96:99], v0 offset:4096
    ds_read_b128 v[100:103], v0 offset:5120
    ds_read_b128 v[104:107], v0 offset:6144
    ds_read_b128 v[108:111], v0 offset:7168
    s_waitcnt lgkmcnt(7)
    v_add3_u32 v68, s43, v32, v33
    v_add3_u32 v68, v68, v34, v35
    s_waitcnt lgkmcnt(6)
    v_add3_u32 v68, v68, v36, v37
    v_add3_u32 v68, v68, v38, v39
    s_waitcnt lgkmcnt(5)
    v_add3_u32 v68, v68, v40, v41
    v_add3_u32 v68, v68, v42, v43
    s_waitcnt lgkmcnt(4)
    v_add3_u32 v68, v68, v44, v45
    v_add3_u32 v68, v68, v46, v47
    v_cmp_ne_u32 s[64:65], v65, v68
    s_waitcnt lgkmcnt(3)
    v_add3_u32 v69, s43, v96, v97
    v_add3_u32 v69, v69, v98, v99
    s_waitcnt lgkmcnt(2)
    v_add3_u32 v69, v69, v100, v101
    v_add3_u32 v69, v69, v102, v103
    s_waitcnt lgkmcnt(1)
    v_add3_u32 v69, v69, v104, v105
    v_add3_u32 v69, v69, v106, v107
    s_waitcnt lgkmcnt(0)
    v_add3_u32 v69, v69, v108, v109
    v_add3_u32 v69, v69, v110, v111
    v_cmp_ne_u32 s[66:67], v66, v69
    s_nop 0
    s_or_b64 s[64:65], s[64:65], s[66:67]
    s_cbranch_scc0 Lhdone_127
    s_sub_u32 s45, s45, 1
    s_cbranch_scc0 Lhalo_125
    s_mov_b32 s45, 0
Lhdone_127:
Lnh_128:
L_j2_2:
    v_cmp_gt_u32 vcc, s44, v1
    v_add_u32 v70, s43, 2
    s_nop 0
    v_cndmask_b32 v71, 0x40000000, v1, vcc
    s_waitcnt lgkmcnt(0)
    s_barrier
    s_cmp_eq_u32 s36, 0
    s_cbranch_scc1 Lnohalo_129
    ds_read_b128 v[80:83], v21
    v_add_u32 v21, s54, v21
    ds_read_b128 v[76:79], v21
    v_add_u32 v21, s54, v21
    ds_read_b128 v[88:91], v22 offset:2048
    s_waitcnt lgkmcnt(2)
    s_cmp_eq_u32 s36, 1
    s_cbranch_scc1 Lr1_130
    v_mfma_f32_32x32x16_bf16 v[112:127], v[80:83], v[72:75], v[112:127]
    s_branch Lr2_131
Lr1_130:
    v_mfma_f32_32x32x16_bf16 v[112:127], v[80:83], v[72:75], 0
Lr2_131:
    s_waitcnt lgkmcnt(1)
    s_nop 6
Latt_132:
    s_waitcnt lgkmcnt(2)
    v_mfma_f32_32x32x16_bf16 v[32:47], v[76:79], v[72:75], 0
    ds_read_b128 v[76:79], v21
    v_add_u32 v21, s54, v21
    v_exp_f32 v112, v112
    v_exp_f32 v113, v113
    v_exp_f32 v114, v114
    v_exp_f32 v115, v115
    s_waitcnt lgkmcnt(2)
    v_mfma_f32_32x32x16_bf16 v[48:63], v[92:95], v[84:87], v[48:63]
    ds_read_b128 v[92:95], v22 offset:3072
    v_add_u32 v22, v64, v22
    v_exp_f32 v116, v116
    v_exp_f32 v117, v117
    v_exp_f32 v118, v118
    v_exp_f32 v119, v119
    v_exp_f32 v120, v120
    v_exp_f32 v121, v121
    v_perm_b32 v80, v113, v112, s63
    v_perm_b32 v81, v115, v114, s63
    v_perm_b32 v82, v117, v116, s63
    v_perm_b32 v83, v119, v118, s63
    v_exp_f32 v122, v122
    v_exp_f32 v123, v123
    s_waitcnt lgkmcnt(2)
    v_mfma_f32_32x32x16_bf16 v[48:63], v[88:91], v[80:83], v[48:63]
    ds_read_b128 v[88:91], v22 offset:2048
    v_exp_f32 v124, v124
    v_exp_f32 v125, v125
    v_exp_f32 v126, v126
    v_exp_f32 v127, v127
    s_sub_u32 s53, s53, 1
    v_perm_b32 v84, v121, v120, s63
    v_perm_b32 v85, v123, v122, s63
    v_perm_b32 v86, v125, v124, s63
    v_perm_b32 v87, v127, v126, s63
    s_cbranch_scc1 Lattd_133
    s_waitcnt lgkmcnt(2)
    v_mfma_f32_32x32x16_bf16 v[112:127], v[76:79], v[72:75], 0
    ds_read_b128 v[76:79], v21
    v_add_u32 v21, s54, v21
    v_exp_f32 v32, v32
    v_exp_f32 v33, v33
    v_exp_f32 v34, v34
    v_exp_f32 v35, v35
    s_waitcnt lgkmcnt(2)
    v_mfma_f32_32x32x16_bf16 v[48:63], v[92:95], v[84:87], v[48:63]
    ds_read_b128 v[92:95], v22 offset:3072
    v_add_u32 v22, v64, v22
    v_exp_f32 v36, v36
    v_exp_f32 v37, v37
    v_exp_f32 v38, v38
    v_exp_f32 v39, v39
    v_exp_f32 v40, v40
    v_exp_f32 v41, v41
    v_perm_b32 v80, v33, v32, s63
    v_perm_b32 v81, v35, v34, s63
    v_perm_b32 v82, v37, v36, s63
    v_perm_b32 v83, v39, v38, s63
    v_exp_f32 v42, v42
    v_exp_f32 v43, v43
    s_waitcnt lgkmcnt(2)
    v_mfma_f32_32x32x16_bf16 v[48:63], v[88:91], v[80:83], v[48:63]
    ds_read_b128 v[88:91], v22 offset:2048
    v_exp_f32 v44, v44
    v_exp_f32 v45, v45
    v_exp_f32 v46, v46
    v_exp_f32 v47, v47
    s_sub_u32 s53, s53, 1
    v_perm_b32 v84, v41, v40, s63
    v_perm_b32 v85, v43, v42, s63
    v_perm_b32 v86, v45, v44, s63
    v_perm_b32 v87, v47, v46, s63
    s_cbranch_scc0 Latt_132
Lattd_133:
Lnohalo_129:
    s_waitcnt lgkmcnt(1)
    v_mfma_f32_32x32x16_bf16 v[48:63], v[92:95], v[84:87], v[48:63]
    s_nop 11
    v_subrev_u32 v0, 0x30800000, v56
    v_cmp_le_u32 vcc, 0x1e000000, v0
    s_cbranch_vccnz L_fb_2
L_fbr_2:
    buffer_store_dword v70, v71, s[4:7], s92 offen
    v_rcp_f32 v56, v56
    s_nop 0
    v_mul_f32 v48, v56, v48
    v_mul_f32 v49, v56, v49
    v_mul_f32 v50, v56, v50
    v_mul_f32 v51, v56, v51
    v_mul_f32 v52, v56, v52
    v_mul_f32 v53, v56, v53
    v_mul_f32 v54, v56, v54
    v_mul_f32 v55, v56, v55
    v_and_b32 v48, 0xfffe0000, v48
    v_or_b32 v48, 0x10000, v48
    v_cvt_pk_bf16_f32 v81, v50, v51
    v_cvt_pk_bf16_f32 v82, v52, v53
    v_cvt_pk_bf16_f32 v83, v54, v55
    v_cvt_pk_bf16_f32 v80, v48, v49
    v_or_b32 v80, 1, v80
    s_cmp_eq_u32 s44, 0
    s_cbranch_scc1 Lsafe_134
    buffer_store_dwordx4 v[80:83], v2, s[4:7], s91 offen
Lpub_135:
    s_setprio 0
    v_mov_b32 v23, 1
    s_mov_b64 exec, 1
    s_waitcnt lgkmcnt(0)
    ds_add_u32 v4, v23 offset:32
    s_mov_b64 exec, -1
    s_cmp_lg_u32 s40, 0
    s_cbranch_scc1 L_ax3_2
    v_and_b32 v111, 124, v3
    v_add_u32 v111, 36864, v111
    buffer_load_dword v103, v111, s[4:7], s82 offen sc1
    v_mov_b32 v128, v80
    v_mov_b32 v129, v81
    v_mov_b32 v130, v82
    v_mov_b32 v131, v83
    s_add_u32 s92, s81, 1048576
    s_lshl_b32 s93, s37, 2
    s_add_u32 s93, s93, s82
    s_add_u32 s93, s93, 12288
    s_lshl_b32 s46, s39, 2
    v_add_u32 v100, s78, v2
    v_add_u32 v101, s46, v4
Lopredo_136:
    ds_read_b128 v[64:67], v6 offset:0
    ds_read_b128 v[68:71], v6 offset:1024
    ds_read_b128 v[72:75], v6 offset:2048
    ds_read_b128 v[76:79], v6 offset:3072
    ds_read_b128 v[80:83], v6 offset:4096
    ds_read_b128 v[84:87], v6 offset:5120
    v_lshlrev_b32 v32, 16, v8
    v_and_b32 v33, 0xffff0000, v8
    v_lshlrev_b32 v34, 16, v9
    v_and_b32 v35, 0xffff0000, v9
    v_lshlrev_b32 v36, 16, v10
    v_and_b32 v37, 0xffff0000, v10
    v_lshlrev_b32 v38, 16, v11
    v_and_b32 v39, 0xffff0000, v11
    v_lshlrev_b32 v40, 16, v12
    v_and_b32 v41, 0xffff0000, v12
    v_lshlrev_b32 v42, 16, v13
    v_and_b32 v43, 0xffff0000, v13
    v_lshlrev_b32 v44, 16, v14
    v_and_b32 v45, 0xffff0000, v14
    v_lshlrev_b32 v46, 16, v15
    v_and_b32 v47, 0xffff0000, v15
    v_and_b32 v110, 124, v3
    s_add_u32 s48, s82, 36864
    s_and_b32 s49, s37, 1
    s_lshl_b32 s49, s49, 11
    s_add_u32 s89, s83, 10485760
    v_add3_u32 v108, s49, v2, 0
    s_lshr_b32 s90, s37, 1
    v_add_u32 v108, s89, v108
    s_lshl_b32 s90, s90, 12
    v_xor_b32 v109, 2048, v108
    s_add_u32 s46, s43, 2
    s_waitcnt vmcnt(0)
    v_cmp_ne_u32 vcc, s46, v103
    s_cbranch_vccz Lpolld_138
    buffer_load_dword v104, v110, s[4:7], s48 offen sc1
    s_sleep 2
Lpoll_137:
    buffer_load_dword v105, v110, s[4:7], s48 offen sc1
    s_waitcnt vmcnt(1)
    v_cmp_ne_u32 vcc, s46, v104
    s_cbranch_vccz Lpolld_138
    buffer_load_dword v104, v110, s[4:7], s48 offen sc1
    s_waitcnt vmcnt(1)
    v_cmp_ne_u32 vcc, s46, v105
    s_cbranch_vccz Lpolld_138
    s_sub_u32 s45, s45, 1
    s_cbranch_scc0 Lpoll_137
    s_mov_b32 s45, 0
Lpolld_138:
    v_mov_b32 v23, 1
    buffer_load_dwordx4 v[136:139], v109, s[4:7], s90 offen offset:0 sc1
    buffer_load_dwordx4 v[140:143], v109, s[4:7], s90 offen offset:1024 sc1
    s_add_u32 s90, s90, 4096
    s_and_b32 s90, s90, 0x7fff
    buffer_load_dwordx4 v[144:147], v108, s[4:7], s90 offen offset:0 sc1
    buffer_load_dwordx4 v[148:151], v108, s[4:7], s90 offen offset:1024 sc1
    buffer_load_dwordx4 v[152:155], v109, s[4:7], s90 offen offset:0 sc1
    buffer_load_dwordx4 v[156:159], v109, s[4:7], s90 offen offset:1024 sc1
    s_add_u32 s90, s90, 4096
    s_and_b32 s90, s90, 0x7fff
    buffer_load_dwordx4 v[160:163], v108, s[4:7], s90 offen offset:0 sc1
    buffer_load_dwordx4 v[164:167], v108, s[4:7], s90 offen offset:1024 sc1
    buffer_load_dwordx4 v[168:171], v109, s[4:7], s90 offen offset:0 sc1
    buffer_load_dwordx4 v[172:175], v109, s[4:7], s90 offen offset:1024 sc1
    s_add_u32 s90, s90, 4096
    s_and_b32 s90, s90, 0x7fff
Lhb_139:
    ds_read_b32 v102, v101 offset:0
    ds_read_b128 v[132:135], v100 offset:5120
    s_waitcnt lgkmcnt(0)
    v_cmp_gt_u32 vcc, 8, v102
    s_cbranch_vccnz Lhb_139
    v_mfma_f32_32x32x16_bf16 v[32:47], v[64:67], v[128:131], v[32:47]
    ds_read_b128 v[64:67], v6 offset:6144
    v_mfma_f32_32x32x16_bf16 v[32:47], v[68:71], v[132:135], v[32:47]
    ds_read_b128 v[68:71], v6 offset:7168
    v_bitop3_b32 v23, v23, v128, v132 bitop3:0x80
    s_waitcnt vmcnt(9)
    v_mfma_f32_32x32x16_bf16 v[32:47], v[72:75], v[136:139], v[32:47]
    buffer_load_dwordx4 v[176:179], v108, s[4:7], s90 offen offset:0 sc1
    ds_read_b128 v[72:75], v6 offset:8192
    s_waitcnt vmcnt(9)
    v_mfma_f32_32x32x16_bf16 v[32:47], v[76:79], v[140:143], v[32:47]
    buffer_load_dwordx4 v[180:183], v108, s[4:7], s90 offen offset:1024 sc1
    ds_read_b128 v[76:79], v6 offset:9216
    v_bitop3_b32 v23, v23, v136, v140 bitop3:0x80
    s_waitcnt vmcnt(9)
    v_mfma_f32_32x32x16_bf16 v[32:47], v[80:83], v[144:147], v[32:47]
    buffer_load_dwordx4 v[184:187], v109, s[4:7], s90 offen offset:0 sc1
    ds_read_b128 v[80:83], v6 offset:10240
    s_waitcnt vmcnt(9)
    v_mfma_f32_32x32x16_bf16 v[32:47], v[84:87], v[148:151], v[32:47]
    buffer_load_dwordx4 v[188:191], v109, s[4:7], s90 offen offset:1024 sc1
    s_add_u32 s90, s90, 4096
    s_and_b32 s90, s90, 0x7fff
    ds_read_b128 v[84:87], v6 offset:11264
    v_bitop3_b32 v23, v23, v144, v148 bitop3:0x80
    v_and_b32 v23, 1, v23
    v_cmp_ne_u32 vcc, 1, v23
    s_cbranch_vccnz Lver_140
Lverc_141:
    s_waitcnt vmcnt(9) lgkmcnt(5)
    v_mfma_f32_32x32x16_bf16 v[32:47], v[64:67], v[152:155], v[32:47]
    buffer_load_dwordx4 v[192:195], v108, s[4:7], s90 offen offset:0 sc1
    ds_read_b128 v[64:67], v6 offset:12288
    s_waitcnt vmcnt(9) lgkmcnt(5)
    v_mfma_f32_32x32x16_bf16 v[32:47], v[68:71], v[156:159], v[32:47]
    buffer_load_dwordx4 v[196:199], v108, s[4:7], s90 offen offset:1024 sc1
    ds_read_b128 v[68:71], v6 offset:13312
    v_bitop3_b32 v23, v23, v152, v156 bitop3:0x80
    s_waitcnt vmcnt(9) lgkmcnt(5)
    v_mfma_f32_32x32x16_bf16 v[32:47], v[72:75], v[160:163], v[32:47]
    buffer_load_dwordx4 v[200:203], v109, s[4:7], s90 offen offset:0 sc1
    ds_read_b128 v[72:75], v6 offset:14336
    s_waitcnt vmcnt(9) lgkmcnt(5)
    v_mfma_f32_32x32x16_bf16 v[32:47], v[76:79], v[164:167], v[32:47]
    buffer_load_dwordx4 v[204:207], v109, s[4:7], s90 offen offset:1024 sc1
    s_add_u32 s90, s90, 4096
    s_and_b32 s90, s90, 0x7fff
    ds_read_b128 v[76:79], v6 offset:15360
    v_bitop3_b32 v23, v23, v160, v164 bitop3:0x80
    s_waitcnt vmcnt(9) lgkmcnt(5)
    v_mfma_f32_32x32x16_bf16 v[32:47], v[80:83], v[168:171], v[32:47]
    buffer_load_dwordx4 v[208:211], v108, s[4:7], s90 offen offset:0 sc1
    ds_read_b128 v[80:83], v6 offset:16384
    s_waitcnt vmcnt(9) lgkmcnt(5)
    v_mfma_f32_32x32x16_bf16 v[32:47], v[84:87], v[172:175], v[32:47]
    buffer_load_dwordx4 v[212:215], v108, s[4:7], s90 offen offset:1024 sc1
    ds_read_b128 v[84:87], v6 offset:17408
    v_bitop3_b32 v23, v23, v168, v172 bitop3:0x80
    v_and_b32 v23, 1, v23
    v_cmp_ne_u32 vcc, 1, v23
    s_cbranch_vccnz Lver_142
Lverc_143:
    s_waitcnt vmcnt(9) lgkmcnt(5)
    v_mfma_f32_32x32x16_bf16 v[32:47], v[64:67], v[176:179], v[32:47]
    buffer_load_dwordx4 v[216:219], v109, s[4:7], s90 offen offset:0 sc1
    ds_read_b128 v[64:67], v6 offset:18432
    s_waitcnt vmcnt(9) lgkmcnt(5)
    v_mfma_f32_32x32x16_bf16 v[32:47], v[68:71], v[180:183], v[32:47]
    buffer_load_dwordx4 v[220:223], v109, s[4:7], s90 offen offset:1024 sc1
    s_add_u32 s90, s90, 4096
    s_and_b32 s90, s90, 0x7fff
    ds_read_b128 v[68:71], v6 offset:19456
    v_bitop3_b32 v23, v23, v176, v180 bitop3:0x80
    s_waitcnt vmcnt(9) lgkmcnt(5)
    v_mfma_f32_32x32x16_bf16 v[32:47], v[72:75], v[184:187], v[32:47]
    buffer_load_dwordx4 v[224:227], v108, s[4:7], s90 offen offset:0 sc1
    ds_read_b128 v[72:75], v6 offset:20480
    s_waitcnt vmcnt(9) lgkmcnt(5)
    v_mfma_f32_32x32x16_bf16 v[32:47], v[76:79], v[188:191], v[32:47]
    buffer_load_dwordx4 v[228:231], v108, s[4:7], s90 offen offset:1024 sc1
    ds_read_b128 v[76:79], v6 offset:21504
    v_bitop3_b32 v23, v23, v184, v188 bitop3:0x80
    s_waitcnt vmcnt(9) lgkmcnt(5)
    v_mfma_f32_32x32x16_bf16 v[32:47], v[80:83], v[192:195], v[32:47]
    buffer_load_dwordx4 v[232:235], v109, s[4:7], s90 offen offset:0 sc1
    ds_read_b128 v[80:83], v6 offset:22528
    s_waitcnt vmcnt(9) lgkmcnt(5)
    v_mfma_f32_32x32x16_bf16 v[32:47], v[84:87], v[196:199], v[32:47]
    buffer_load_dwordx4 v[236:239], v109, s[4:7], s90 offen offset:1024 sc1
    s_add_u32 s90, s90, 4096
    s_and_b32 s90, s90, 0x7fff
    ds_read_b128 v[84:87], v6 offset:23552
    v_bitop3_b32 v23, v23, v192, v196 bitop3:0x80
    s_waitcnt vmcnt(9) lgkmcnt(5)
    v_mfma_f32_32x32x16_bf16 v[32:47], v[64:67], v[200:203], v[32:47]
    buffer_load_dwordx4 v[240:243], v108, s[4:7], s90 offen offset:0 sc1
    ds_read_b128 v[64:67], v6 offset:24576
    s_waitcnt vmcnt(9) lgkmcnt(5)
    v_mfma_f32_32x32x16_bf16 v[32:47], v[68:71], v[204:207], v[32:47]
    buffer_load_dwordx4 v[244:247], v108, s[4:7], s90 offen offset:1024 sc1
    ds_read_b128 v[68:71], v6 offset:25600
    v_bitop3_b32 v23, v23, v200, v204 bitop3:0x80
    s_waitcnt vmcnt(9) lgkmcnt(5)
    v_mfma_f32_32x32x16_bf16 v[32:47], v[72:75], v[208:211], v[32:47]
    buffer_load_dwordx4 v[248:251], v109, s[4:7], s90 offen offset:0 sc1
    ds_read_b128 v[72:75], v6 offset:26624
    s_waitcnt vmcnt(9) lgkmcnt(5)
    v_mfma_f32_32x32x16_bf16 v[32:47], v[76:79], v[212:215], v[32:47]
    buffer_load_dwordx4 v[252:255], v109, s[4:7], s90 offen offset:1024 sc1
    ds_read_b128 v[76:79], v6 offset:27648
    v_bitop3_b32 v23, v23, v208, v212 bitop3:0x80
    s_waitcnt vmcnt(9) lgkmcnt(5)
    v_mfma_f32_32x32x16_bf16 v[32:47], v[80:83], v[216:219], v[32:47]
    ds_read_b128 v[80:83], v6 offset:28672
    s_waitcnt vmcnt(8) lgkmcnt(5)
    v_mfma_f32_32x32x16_bf16 v[32:47], v[84:87], v[220:223], v[32:47]
    ds_read_b128 v[84:87], v6 offset:29696
    v_bitop3_b32 v23, v23, v216, v220 bitop3:0x80
    s_waitcnt vmcnt(7) lgkmcnt(5)
    v_mfma_f32_32x32x16_bf16 v[32:47], v[64:67], v[224:227], v[32:47]
    ds_read_b128 v[64:67], v6 offset:30720
    v_cmp_gt_u32 vcc, s44, v1
    v_add_u32 v106, s43, 2
    s_nop 0
    v_cndmask_b32 v107, 0x40000000, v1, vcc
    s_waitcnt vmcnt(6) lgkmcnt(5)
    v_mfma_f32_32x32x16_bf16 v[32:47], v[68:71], v[228:231], v[32:47]
    ds_read_b128 v[68:71], v6 offset:31744
    v_bitop3_b32 v23, v23, v224, v228 bitop3:0x80
    v_and_b32 v111, 60, v3
    v_add_u32 v111, 12288, v111
    s_waitcnt vmcnt(5) lgkmcnt(5)
    v_mfma_f32_32x32x16_bf16 v[32:47], v[72:75], v[232:235], v[32:47]
    s_waitcnt vmcnt(4) lgkmcnt(4)
    v_mfma_f32_32x32x16_bf16 v[32:47], v[76:79], v[236:239], v[32:47]
    v_bitop3_b32 v23, v23, v232, v236 bitop3:0x80
    s_waitcnt vmcnt(3) lgkmcnt(3)
    v_mfma_f32_32x32x16_bf16 v[32:47], v[80:83], v[240:243], v[32:47]
    s_waitcnt vmcnt(2) lgkmcnt(2)
    v_mfma_f32_32x32x16_bf16 v[32:47], v[84:87], v[244:247], v[32:47]
    v_bitop3_b32 v23, v23, v240, v244 bitop3:0x80
    s_waitcnt vmcnt(1) lgkmcnt(1)
    v_mfma_f32_32x32x16_bf16 v[32:47], v[64:67], v[248:251], v[32:47]
    s_waitcnt vmcnt(0) lgkmcnt(0)
    v_mfma_f32_32x32x16_bf16 v[32:47], v[68:71], v[252:255], v[32:47]
    v_bitop3_b32 v23, v23, v248, v252 bitop3:0x80
    v_and_b32 v23, 1, v23
    v_cmp_ne_u32 vcc, 1, v23
    s_cbranch_vccnz Lver_144
Lverc_145:
    buffer_store_dword v106, v107, s[4:7], s93 offen
    ds_read_b32 v0, v4 offset:40
    s_nop 5
    v_and_b32 v128, 0xfffe0000, v32
    v_or_b32 v128, 0x10000, v128
    v_cvt_pk_bf16_f32 v128, v128, v33
    v_cvt_pk_bf16_f32 v129, v34, v35
    v_cvt_pk_bf16_f32 v130, v36, v37
    v_cvt_pk_bf16_f32 v131, v38, v39
    v_and_b32 v132, 0xfffe0000, v40
    v_or_b32 v132, 0x10000, v132
    v_cvt_pk_bf16_f32 v132, v132, v41
    v_cvt_pk_bf16_f32 v133, v42, v43
    v_cvt_pk_bf16_f32 v134, v44, v45
    v_cvt_pk_bf16_f32 v135, v46, v47
    v_or_b32 v128, 1, v128
    v_or_b32 v132, 1, v132
    s_cmp_eq_u32 s44, 0
    s_cbranch_scc1 Lsafe_146
    buffer_store_dwordx4 v[128:131], v2, s[32:35], s80 offen
    buffer_store_dwordx4 v[132:135], v2, s[32:35], s80 offen offset:1024
    buffer_load_dword v103, v111, s[4:7], s82 offen sc1
    v_pk_add_f32 v[64:65], v[32:33], v[34:35]
    v_pk_add_f32 v[66:67], v[36:37], v[38:39]
    v_pk_add_f32 v[68:69], v[40:41], v[42:43]
    v_pk_add_f32 v[70:71], v[44:45], v[46:47]
    v_pk_mul_f32 v[72:73], v[32:33], v[32:33]
    v_pk_mul_f32 v[74:75], v[34:35], v[34:35]
    v_pk_add_f32 v[64:65], v[64:65], v[66:67]
    v_pk_add_f32 v[68:69], v[68:69], v[70:71]
    v_pk_fma_f32 v[72:73], v[36:37], v[36:37], v[72:73]
    v_pk_fma_f32 v[74:75], v[38:39], v[38:39], v[74:75]
    v_pk_fma_f32 v[72:73], v[40:41], v[40:41], v[72:73]
    v_pk_fma_f32 v[74:75], v[42:43], v[42:43], v[74:75]
    v_pk_fma_f32 v[72:73], v[44:45], v[44:45], v[72:73]
    v_pk_fma_f32 v[74:75], v[46:47], v[46:47], v[74:75]
    v_pk_add_f32 v[64:65], v[64:65], v[68:69]
    v_pk_add_f32 v[72:73], v[72:73], v[74:75]
    v_add_f32 v64, v64, v65
    v_add_f32 v66, v72, v73
    s_nop 1
    v_permlane32_swap_b32 v64, v66
    v_add_f32 v64, v64, v66
    v_or_b32 v64, 1, v64
    buffer_store_dword v64, v3, s[4:7], s92 offen
Lpub_147:
    v_cvt_pk_bf16_f32 v8, v32, v33
    v_cvt_pk_bf16_f32 v9, v34, v35
    v_cvt_pk_bf16_f32 v10, v36, v37
    v_cvt_pk_bf16_f32 v11, v38, v39
    v_cvt_pk_bf16_f32 v12, v40, v41
    v_cvt_pk_bf16_f32 v13, v42, v43
    v_cvt_pk_bf16_f32 v14, v44, v45
    v_cvt_pk_bf16_f32 v15, v46, v47
    v_mov_b32 v23, 1
    s_mov_b64 exec, 1
    s_waitcnt lgkmcnt(0)
    ds_add_u32 v4, v23 offset:16
    s_mov_b64 exec, -1
    s_branch L_main_3
L_ax3_2:
    v_add_u32 v64, s78, v2
    s_lshl_b32 s46, s42, 2
    ds_write_b128 v64, v[80:83] offset:5120
    v_add_u32 v65, s46, v4
    v_mov_b32 v66, 8
    ds_write_b32 v65, v66 offset:0
    ds_write_b128 v10, v[192:195] offset:0
    ds_write_b128 v10, v[196:199] offset:1024
    ds_write_b128 v10, v[200:203] offset:8192
    ds_write_b128 v10, v[204:207] offset:9216
    ds_write_b128 v10, v[208:211] offset:16384
    ds_write_b128 v10, v[212:215] offset:17408
    ds_write_b128 v10, v[216:219] offset:24576
    ds_write_b128 v10, v[220:223] offset:25600
    ds_write_b128 v10, v[128:131] offset:32768
    ds_write_b128 v10, v[132:135] offset:33792
    ds_write_b128 v10, v[136:139] offset:40960
    ds_write_b128 v10, v[140:143] offset:41984
    ds_write_b128 v10, v[144:147] offset:49152
    ds_write_b128 v10, v[148:151] offset:50176
    ds_write_b128 v10, v[152:155] offset:57344
    ds_write_b128 v10, v[156:159] offset:58368
Llw_148:
    s_sleep 2
    ds_read_b32 v23, v4 offset:32
    s_waitcnt lgkmcnt(0)
    v_cmp_gt_u32 vcc, 16, v23
    s_cbranch_vccnz Llw_148
    v_add_u32 v0, 65536, v10
    ds_write_b128 v0, v[160:163] offset:0
    ds_write_b128 v0, v[164:167] offset:1024
    ds_write_b128 v0, v[168:171] offset:8192
    ds_write_b128 v0, v[172:175] offset:9216
    ds_write_b128 v0, v[176:179] offset:16384
    ds_write_b128 v0, v[180:183] offset:17408
    ds_write_b128 v0, v[184:187] offset:24576
    ds_write_b128 v0, v[188:191] offset:25600
    s_branch L_aux_3
L_main_3:
    v_cmp_gt_u32 vcc, 12, v0
    s_cbranch_vccz Lwr_149
Llw_150:
    ds_read_b32 v23, v4 offset:40
    s_waitcnt lgkmcnt(0)
    v_cmp_gt_u32 vcc, 12, v23
    s_cbranch_vccnz Llw_150
Lwr_149:
    v_and_b32 v0, 0x1f0, v2
    v_add_u32 v0, 157184, v0
    s_lshr_b32 s47, s83, 6
    s_add_u32 s47, s47, 73728
    v_add_u32 v21, s78, v2
    v_sub_u32 v22, v21, v2
    v_and_b32 v23, 31, v1
    v_lshl_add_u32 v22, v23, 5, v22
    v_lshrrev_b32 v23, 5, v1
    v_lshl_add_u32 v22, v23, 4, v22
    s_lshl_b32 s46, s39, 2
    v_add_u32 v120, s46, v4
    v_mov_b32 v121, 9
Lkvredo_151:
    ds_read_b128 v[88:91], v0 offset:512
    ds_read_b128 v[92:95], v0 offset:1024
    ds_read_b128 v[64:67], v2 offset:0
    ds_read_b128 v[68:71], v2 offset:32768
    ds_read_b128 v[72:75], v2 offset:1024
    ds_read_b128 v[76:79], v2 offset:33792
    ds_read_b128 v[80:83], v2 offset:2048
    ds_read_b128 v[84:87], v2 offset:34816
    v_and_b32 v110, 60, v3
    s_add_u32 s48, s82, 12288
    s_and_b32 s49, s37, 1
    s_lshl_b32 s49, s49, 11
    s_add_u32 s89, s83, 0
    v_add3_u32 v108, s49, v2, 0
    s_lshr_b32 s90, s37, 1
    v_add_u32 v108, s89, v108
    s_lshl_b32 s90, s90, 12
    v_xor_b32 v109, 2048, v108
    s_add_u32 s46, s43, 2
    s_waitcnt vmcnt(1)
    v_cmp_ne_u32 vcc, s46, v103
    s_cbranch_vccz Lpolld_153
    buffer_load_dword v104, v110, s[4:7], s48 offen sc1
    s_sleep 2
Lpoll_152:
    buffer_load_dword v105, v110, s[4:7], s48 offen sc1
    s_waitcnt vmcnt(1)
    v_cmp_ne_u32 vcc, s46, v104
    s_cbranch_vccz Lpolld_153
    buffer_load_dword v104, v110, s[4:7], s48 offen sc1
    s_waitcnt vmcnt(1)
    v_cmp_ne_u32 vcc, s46, v105
    s_cbranch_vccz Lpolld_153
    s_sub_u32 s45, s45, 1
    s_cbranch_scc0 Lpoll_152
    s_mov_b32 s45, 0
Lpolld_153:
    v_mov_b32 v23, 1
    buffer_load_dwordx4 v[136:139], v109, s[32:35], s90 offen offset:0 sc1
    buffer_load_dwordx4 v[140:143], v109, s[32:35], s90 offen offset:1024 sc1
    s_add_u32 s90, s90, 4096
    s_and_b32 s90, s90, 0x7fff
    buffer_load_dwordx4 v[144:147], v108, s[32:35], s90 offen offset:0 sc1
    buffer_load_dwordx4 v[148:151], v108, s[32:35], s90 offen offset:1024 sc1
    buffer_load_dwordx4 v[152:155], v109, s[32:35], s90 offen offset:0 sc1
    buffer_load_dwordx4 v[156:159], v109, s[32:35], s90 offen offset:1024 sc1
    s_add_u32 s90, s90, 4096
    s_and_b32 s90, s90, 0x7fff
    buffer_load_dwordx4 v[160:163], v108, s[32:35], s90 offen offset:0 sc1
    buffer_load_dwordx4 v[164:167], v108, s[32:35], s90 offen offset:1024 sc1
    s_waitcnt lgkmcnt(5)
    v_mfma_f32_32x32x16_bf16 v[32:47], v[64:67], v[128:131], 0
    ds_read_b128 v[64:67], v2 offset:3072
    v_add_f32 v88, v88, v89
    v_add_f32 v90, v90, v91
    s_waitcnt lgkmcnt(5)
    v_mfma_f32_32x32x16_bf16 v[48:63], v[128:131], v[68:71], 0
    ds_read_b128 v[68:71], v2 offset:35840
    v_add_f32 v88, v88, v90
    v_and_b32 v90, 0xffff0000, v88
    v_sub_f32 v91, v88, v90
    s_waitcnt lgkmcnt(5)
    v_mfma_f32_32x32x16_bf16 v[32:47], v[72:75], v[132:135], v[32:47]
    ds_read_b128 v[72:75], v2 offset:4096
    v_cvt_pk_bf16_f32 v88, v90, v91
    v_cvt_pk_bf16_f32 v89, v90, 0
    v_mov_b32 v90, 0
    s_waitcnt lgkmcnt(5)
    v_mfma_f32_32x32x16_bf16 v[48:63], v[132:135], v[76:79], v[48:63]
    ds_read_b128 v[76:79], v2 offset:36864
    v_mov_b32 v91, 0
    v_add_f32 v92, v92, v93
    s_waitcnt vmcnt(7) lgkmcnt(5)
    v_mfma_f32_32x32x16_bf16 v[32:47], v[80:83], v[136:139], v[32:47]
    ds_read_b128 v[80:83], v2 offset:5120
    buffer_load_dwordx4 v[168:171], v109, s[32:35], s90 offen offset:0 sc1
    v_add_f32 v94, v94, v95
    s_waitcnt lgkmcnt(5)
    v_mfma_f32_32x32x16_bf16 v[48:63], v[136:139], v[84:87], v[48:63]
    ds_read_b128 v[84:87], v2 offset:37888
    v_add_f32 v92, v92, v94
    v_and_b32 v94, 0xffff0000, v92
    v_sub_f32 v95, v92, v94
    s_waitcnt vmcnt(7) lgkmcnt(5)
    v_mfma_f32_32x32x16_bf16 v[32:47], v[64:67], v[140:143], v[32:47]
    ds_read_b128 v[64:67], v2 offset:6144
    v_bitop3_b32 v23, v23, v136, v140 bitop3:0x80
    buffer_load_dwordx4 v[172:175], v109, s[32:35], s90 offen offset:1024 sc1
    s_add_u32 s90, s90, 4096
    s_and_b32 s90, s90, 0x7fff
    v_cvt_pk_bf16_f32 v92, v94, v95
    s_waitcnt lgkmcnt(5)
    v_mfma_f32_32x32x16_bf16 v[48:63], v[140:143], v[68:71], v[48:63]
    ds_read_b128 v[68:71], v2 offset:38912
    v_cvt_pk_bf16_f32 v93, v94, 0
    v_mov_b32 v94, 0
    v_mov_b32 v95, 0
    s_waitcnt vmcnt(7) lgkmcnt(5)
    v_mfma_f32_32x32x16_bf16 v[32:47], v[72:75], v[144:147], v[32:47]
    ds_read_b128 v[72:75], v2 offset:7168
    buffer_load_dwordx4 v[176:179], v108, s[32:35], s90 offen offset:0 sc1
    v_lshlrev_b32 v98, 3, v1
    s_waitcnt lgkmcnt(5)
    v_mfma_f32_32x32x16_bf16 v[48:63], v[144:147], v[76:79], v[48:63]
    ds_read_b128 v[76:79], v2 offset:39936
    s_add_u32 s64, s43, 3
    s_waitcnt vmcnt(7) lgkmcnt(5)
    v_mfma_f32_32x32x16_bf16 v[32:47], v[80:83], v[148:151], v[32:47]
    ds_read_b128 v[80:83], v2 offset:8192
    v_bitop3_b32 v23, v23, v144, v148 bitop3:0x80
    buffer_load_dwordx4 v[180:183], v108, s[32:35], s90 offen offset:1024 sc1
    s_waitcnt lgkmcnt(5)
    v_mfma_f32_32x32x16_bf16 v[48:63], v[148:151], v[84:87], v[48:63]
    ds_read_b128 v[84:87], v2 offset:40960
    v_and_b32 v23, 1, v23
    v_cmp_ne_u32 vcc, 1, v23
    s_cbranch_vccnz Lver_154
Lverc_155:
    s_waitcnt vmcnt(7) lgkmcnt(5)
    v_mfma_f32_32x32x16_bf16 v[32:47], v[64:67], v[152:155], v[32:47]
    ds_read_b128 v[64:67], v2 offset:9216
    buffer_load_dwordx4 v[184:187], v109, s[32:35], s90 offen offset:0 sc1
    s_waitcnt lgkmcnt(5)
    v_mfma_f32_32x32x16_bf16 v[48:63], v[152:155], v[68:71], v[48:63]
    ds_read_b128 v[68:71], v2 offset:41984
    s_waitcnt vmcnt(7) lgkmcnt(5)
    v_mfma_f32_32x32x16_bf16 v[32:47], v[72:75], v[156:159], v[32:47]
    ds_read_b128 v[72:75], v2 offset:10240
    v_bitop3_b32 v23, v23, v152, v156 bitop3:0x80
    buffer_load_dwordx4 v[188:191], v109, s[32:35], s90 offen offset:1024 sc1
    s_add_u32 s90, s90, 4096
    s_and_b32 s90, s90, 0x7fff
    s_waitcnt lgkmcnt(5)
    v_mfma_f32_32x32x16_bf16 v[48:63], v[156:159], v[76:79], v[48:63]
    ds_read_b128 v[76:79], v2 offset:43008
    s_waitcnt vmcnt(7) lgkmcnt(5)
    v_mfma_f32_32x32x16_bf16 v[32:47], v[80:83], v[160:163], v[32:47]
    ds_read_b128 v[80:83], v2 offset:11264
    buffer_load_dwordx4 v[192:195], v108, s[32:35], s90 offen offset:0 sc1
    s_waitcnt lgkmcnt(5)
    v_mfma_f32_32x32x16_bf16 v[48:63], v[160:163], v[84:87], v[48:63]
    ds_read_b128 v[84:87], v2 offset:44032
    s_waitcnt vmcnt(7) lgkmcnt(5)
    v_mfma_f32_32x32x16_bf16 v[32:47], v[64:67], v[164:167], v[32:47]
    ds_read_b128 v[64:67], v2 offset:12288
    v_bitop3_b32 v23, v23, v160, v164 bitop3:0x80
    buffer_load_dwordx4 v[196:199], v108, s[32:35], s90 offen offset:1024 sc1
    s_waitcnt lgkmcnt(5)
    v_mfma_f32_32x32x16_bf16 v[48:63], v[164:167], v[68:71], v[48:63]
    ds_read_b128 v[68:71], v2 offset:45056
    s_waitcnt vmcnt(7) lgkmcnt(5)
    v_mfma_f32_32x32x16_bf16 v[32:47], v[72:75], v[168:171], v[32:47]
    ds_read_b128 v[72:75], v2 offset:13312
    buffer_load_dwordx4 v[200:203], v109, s[32:35], s90 offen offset:0 sc1
    s_waitcnt lgkmcnt(5)
    v_mfma_f32_32x32x16_bf16 v[48:63], v[168:171], v[76:79], v[48:63]
    ds_read_b128 v[76:79], v2 offset:46080
    s_waitcnt vmcnt(7) lgkmcnt(5)
    v_mfma_f32_32x32x16_bf16 v[32:47], v[80:83], v[172:175], v[32:47]
    ds_read_b128 v[80:83], v2 offset:14336
    v_bitop3_b32 v23, v23, v168, v172 bitop3:0x80
    buffer_load_dwordx4 v[204:207], v109, s[32:35], s90 offen offset:1024 sc1
    s_add_u32 s90, s90, 4096
    s_and_b32 s90, s90, 0x7fff
    s_waitcnt lgkmcnt(5)
    v_mfma_f32_32x32x16_bf16 v[48:63], v[172:175], v[84:87], v[48:63]
    ds_read_b128 v[84:87], v2 offset:47104
    v_and_b32 v23, 1, v23
    v_cmp_ne_u32 vcc, 1, v23
    s_cbranch_vccnz Lver_156
Lverc_157:
    s_waitcnt vmcnt(7) lgkmcnt(5)
    v_mfma_f32_32x32x16_bf16 v[32:47], v[64:67], v[176:179], v[32:47]
    ds_read_b128 v[64:67], v2 offset:15360
    buffer_load_dwordx4 v[208:211], v108, s[32:35], s90 offen offset:0 sc1
    s_waitcnt lgkmcnt(5)
    v_mfma_f32_32x32x16_bf16 v[48:63], v[176:179], v[68:71], v[48:63]
    ds_read_b128 v[68:71], v2 offset:48128
    s_waitcnt vmcnt(7) lgkmcnt(5)
    v_mfma_f32_32x32x16_bf16 v[32:47], v[72:75], v[180:183], v[32:47]
    ds_read_b128 v[72:75], v2 offset:16384
    v_bitop3_b32 v23, v23, v176, v180 bitop3:0x80
    buffer_load_dwordx4 v[212:215], v108, s[32:35], s90 offen offset:1024 sc1
    s_waitcnt lgkmcnt(5)
    v_mfma_f32_32x32x16_bf16 v[48:63], v[180:183], v[76:79], v[48:63]
    ds_read_b128 v[76:79], v2 offset:49152
    s_waitcnt vmcnt(7) lgkmcnt(5)
    v_mfma_f32_32x32x16_bf16 v[32:47], v[80:83], v[184:187], v[32:47]
    ds_read_b128 v[80:83], v2 offset:17408
    buffer_load_dwordx4 v[216:219], v109, s[32:35], s90 offen offset:0 sc1
    s_waitcnt lgkmcnt(5)
    v_mfma_f32_32x32x16_bf16 v[48:63], v[184:187], v[84:87], v[48:63]
    ds_read_b128 v[84:87], v2 offset:50176
    s_waitcnt vmcnt(7) lgkmcnt(5)
    v_mfma_f32_32x32x16_bf16 v[32:47], v[64:67], v[188:191], v[32:47]
    ds_read_b128 v[64:67], v2 offset:18432
    v_bitop3_b32 v23, v23, v184, v188 bitop3:0x80
    buffer_load_dwordx4 v[220:223], v109, s[32:35], s90 offen offset:1024 sc1
    s_add_u32 s90, s90, 4096
    s_and_b32 s90, s90, 0x7fff
    s_waitcnt lgkmcnt(5)
    v_mfma_f32_32x32x16_bf16 v[48:63], v[188:191], v[68:71], v[48:63]
    ds_read_b128 v[68:71], v2 offset:51200
    s_waitcnt vmcnt(7) lgkmcnt(5)
    v_mfma_f32_32x32x16_bf16 v[32:47], v[72:75], v[192:195], v[32:47]
    ds_read_b128 v[72:75], v2 offset:19456
    buffer_load_dwordx4 v[224:227], v108, s[32:35], s90 offen offset:0 sc1
    s_waitcnt lgkmcnt(5)
    v_mfma_f32_32x32x16_bf16 v[48:63], v[192:195], v[76:79], v[48:63]
    ds_read_b128 v[76:79], v2 offset:52224
    s_waitcnt vmcnt(7) lgkmcnt(5)
    v_mfma_f32_32x32x16_bf16 v[32:47], v[80:83], v[196:199], v[32:47]
    ds_read_b128 v[80:83], v2 offset:20480
    v_bitop3_b32 v23, v23, v192, v196 bitop3:0x80
    buffer_load_dwordx4 v[228:231], v108, s[32:35], s90 offen offset:1024 sc1
    s_waitcnt lgkmcnt(5)
    v_mfma_f32_32x32x16_bf16 v[48:63], v[196:199], v[84:87], v[48:63]
    ds_read_b128 v[84:87], v2 offset:53248
    s_waitcnt vmcnt(7) lgkmcnt(5)
    v_mfma_f32_32x32x16_bf16 v[32:47], v[64:67], v[200:203], v[32:47]
    ds_read_b128 v[64:67], v2 offset:21504
    buffer_load_dwordx4 v[232:235], v109, s[32:35], s90 offen offset:0 sc1
    s_waitcnt lgkmcnt(5)
    v_mfma_f32_32x32x16_bf16 v[48:63], v[200:203], v[68:71], v[48:63]
    ds_read_b128 v[68:71], v2 offset:54272
    s_waitcnt vmcnt(7) lgkmcnt(5)
    v_mfma_f32_32x32x16_bf16 v[32:47], v[72:75], v[204:207], v[32:47]
    ds_read_b128 v[72:75], v2 offset:22528
    v_bitop3_b32 v23, v23, v200, v204 bitop3:0x80
    buffer_load_dwordx4 v[236:239], v109, s[32:35], s90 offen offset:1024 sc1
    s_add_u32 s90, s90, 4096
    s_and_b32 s90, s90, 0x7fff
    s_waitcnt lgkmcnt(5)
    v_mfma_f32_32x32x16_bf16 v[48:63], v[204:207], v[76:79], v[48:63]
    ds_read_b128 v[76:79], v2 offset:55296
    s_waitcnt vmcnt(7) lgkmcnt(5)
    v_mfma_f32_32x32x16_bf16 v[32:47], v[80:83], v[208:211], v[32:47]
    ds_read_b128 v[80:83], v2 offset:23552
    buffer_load_dwordx4 v[240:243], v108, s[32:35], s90 offen offset:0 sc1
    s_waitcnt lgkmcnt(5)
    v_mfma_f32_32x32x16_bf16 v[48:63], v[208:211], v[84:87], v[48:63]
    ds_read_b128 v[84:87], v2 offset:56320
    s_waitcnt vmcnt(7) lgkmcnt(5)
    v_mfma_f32_32x32x16_bf16 v[32:47], v[64:67], v[212:215], v[32:47]
    ds_read_b128 v[64:67], v2 offset:24576
    v_bitop3_b32 v23, v23, v208, v212 bitop3:0x80
    buffer_load_dwordx4 v[244:247], v108, s[32:35], s90 offen offset:1024 sc1
    s_waitcnt lgkmcnt(5)
    v_mfma_f32_32x32x16_bf16 v[48:63], v[212:215], v[68:71], v[48:63]
    ds_read_b128 v[68:71], v2 offset:57344
    s_waitcnt vmcnt(7) lgkmcnt(5)
    v_mfma_f32_32x32x16_bf16 v[32:47], v[72:75], v[216:219], v[32:47]
    ds_read_b128 v[72:75], v2 offset:25600
    buffer_load_dwordx4 v[248:251], v109, s[32:35], s90 offen offset:0 sc1
    s_waitcnt lgkmcnt(5)
    v_mfma_f32_32x32x16_bf16 v[48:63], v[216:219], v[76:79], v[48:63]
    ds_read_b128 v[76:79], v2 offset:58368
    buffer_load_dwordx2 v[96:97], v98, s[4:7], s47 offen sc1
    s_waitcnt vmcnt(8) lgkmcnt(5)
    v_mfma_f32_32x32x16_bf16 v[32:47], v[80:83], v[220:223], v[32:47]
    ds_read_b128 v[80:83], v2 offset:26624
    v_bitop3_b32 v23, v23, v216, v220 bitop3:0x80
    buffer_load_dwordx4 v[252:255], v109, s[32:35], s90 offen offset:1024 sc1
    s_waitcnt lgkmcnt(5)
    v_mfma_f32_32x32x16_bf16 v[48:63], v[220:223], v[84:87], v[48:63]
    ds_read_b128 v[84:87], v2 offset:59392
    s_waitcnt vmcnt(8) lgkmcnt(5)
    v_mfma_f32_32x32x16_bf16 v[32:47], v[64:67], v[224:227], v[32:47]
    ds_read_b128 v[64:67], v2 offset:27648
    s_waitcnt lgkmcnt(5)
    v_mfma_f32_32x32x16_bf16 v[48:63], v[224:227], v[68:71], v[48:63]
    ds_read_b128 v[68:71], v2 offset:60416
    s_waitcnt vmcnt(7) lgkmcnt(5)
    v_mfma_f32_32x32x16_bf16 v[32:47], v[72:75], v[228:231], v[32:47]
    ds_read_b128 v[72:75], v2 offset:28672
    v_bitop3_b32 v23, v23, v224, v228 bitop3:0x80
    s_waitcnt lgkmcnt(5)
    v_mfma_f32_32x32x16_bf16 v[48:63], v[228:231], v[76:79], v[48:63]
    ds_read_b128 v[76:79], v2 offset:61440
    s_waitcnt vmcnt(6) lgkmcnt(5)
    v_mfma_f32_32x32x16_bf16 v[32:47], v[80:83], v[232:235], v[32:47]
    ds_read_b128 v[80:83], v2 offset:29696
    s_waitcnt lgkmcnt(5)
    v_mfma_f32_32x32x16_bf16 v[48:63], v[232:235], v[84:87], v[48:63]
    ds_read_b128 v[84:87], v2 offset:62464
    s_waitcnt vmcnt(5) lgkmcnt(5)
    v_mfma_f32_32x32x16_bf16 v[32:47], v[64:67], v[236:239], v[32:47]
    ds_read_b128 v[64:67], v2 offset:30720
    v_bitop3_b32 v23, v23, v232, v236 bitop3:0x80
    s_waitcnt lgkmcnt(5)
    v_mfma_f32_32x32x16_bf16 v[48:63], v[236:239], v[68:71], v[48:63]
    ds_read_b128 v[68:71], v2 offset:63488
    s_waitcnt vmcnt(4) lgkmcnt(5)
    v_mfma_f32_32x32x16_bf16 v[32:47], v[72:75], v[240:243], v[32:47]
    ds_read_b128 v[72:75], v2 offset:31744
    s_waitcnt vmcnt(1)
    v_cmp_ne_u32 vcc, s64, v97
    s_cbranch_vccnz Lfin_158
Lfinc_159:
    v_mov_b32 v97, v96
    v_mov_b32 v30, 0
    s_waitcnt lgkmcnt(5)
    v_mfma_f32_32x32x16_bf16 v[48:63], v[240:243], v[76:79], v[48:63]
    ds_read_b128 v[76:79], v2 offset:64512
    v_mov_b32 v31, 0
    v_permlane32_swap_b32 v96, v97
    v_mul_f32 v96, 0x3b000000, v96
    s_waitcnt lgkmcnt(5)
    v_mfma_f32_32x32x16_bf16 v[32:47], v[80:83], v[244:247], v[32:47]
    v_bitop3_b32 v23, v23, v240, v244 bitop3:0x80
    v_mul_f32 v97, 0x3b000000, v97
    v_fma_f32 v97, -v96, v96, v97
    v_max_f32 v97, 0, v97
    s_waitcnt lgkmcnt(4)
    v_mfma_f32_32x32x16_bf16 v[48:63], v[244:247], v[84:87], v[48:63]
    v_add_f32 v97, 0x3727c5ac, v97
    v_rsq_f32 v20, v97
    v_cndmask_b32 v96, 0, v96, s[60:61]
    s_waitcnt lgkmcnt(3)
    v_mfma_f32_32x32x16_bf16 v[32:47], v[64:67], v[248:251], v[32:47]
    v_and_b32 v98, 0xffff0000, v96
    v_sub_f32 v99, v96, v98
    v_cvt_pk_bf16_f32 v28, -v98, -v98
    s_waitcnt lgkmcnt(2)
    v_mfma_f32_32x32x16_bf16 v[48:63], v[248:251], v[68:71], v[48:63]
    v_cvt_pk_bf16_f32 v29, -v99, 0
    ds_write_b32 v25, v20
    ds_read_b128 v[96:99], v26 offset:0
    s_waitcnt vmcnt(0) lgkmcnt(3)
    v_mfma_f32_32x32x16_bf16 v[32:47], v[72:75], v[252:255], v[32:47]
    v_bitop3_b32 v23, v23, v248, v252 bitop3:0x80
    ds_read_b128 v[100:103], v26 offset:32
    ds_read_b128 v[104:107], v26 offset:64
    ds_read_b128 v[108:111], v26 offset:96
    s_waitcnt lgkmcnt(5)
    v_mfma_f32_32x32x16_bf16 v[48:63], v[252:255], v[76:79], v[48:63]
    v_mul_f32 v20, s55, v20
    v_and_b32 v23, 1, v23
    v_cmp_ne_u32 vcc, 1, v23
    s_cbranch_vccnz Lver_160
Lverc_161:
    v_mfma_f32_32x32x16_bf16 v[32:47], v[88:91], v[28:31], v[32:47]
    v_mfma_f32_32x32x16_bf16 v[48:63], v[28:31], v[92:95], v[48:63]
    s_waitcnt lgkmcnt(0)
    s_nop 9
    v_cvt_pk_bf16_f32 v116, v40, v41
    v_cvt_pk_bf16_f32 v117, v42, v43
    v_cvt_pk_bf16_f32 v118, v44, v45
    v_cvt_pk_bf16_f32 v119, v46, v47
    ds_write_b128 v21, v[116:119] offset:1024
    ds_write_b32 v120, v121 offset:0
    v_cvt_pk_bf16_f32 v112, v32, v33
    v_cvt_pk_bf16_f32 v113, v34, v35
    v_cvt_pk_bf16_f32 v114, v36, v37
    v_cvt_pk_bf16_f32 v115, v38, v39
    v_pk_mul_f32 v[48:49], v[48:49], v[96:97]
    v_pk_mul_f32 v[50:51], v[50:51], v[98:99]
    v_mfma_f32_32x32x16_bf16 v[32:47], v[16:19], v[112:115], 0
    v_pk_mul_f32 v[52:53], v[52:53], v[100:101]
    v_pk_mul_f32 v[54:55], v[54:55], v[102:103]
    v_pk_mul_f32 v[56:57], v[56:57], v[104:105]
    v_pk_mul_f32 v[58:59], v[58:59], v[106:107]
    v_pk_mul_f32 v[60:61], v[60:61], v[108:109]
    v_pk_mul_f32 v[62:63], v[62:63], v[110:111]
    v_cvt_pk_bf16_f32 v120, v48, v49
    v_cvt_pk_bf16_f32 v121, v50, v51
    v_cvt_pk_bf16_f32 v122, v52, v53
    v_cvt_pk_bf16_f32 v123, v54, v55
    ds_write_b128 v21, v[120:123] offset:2048
    v_cvt_pk_bf16_f32 v124, v56, v57
    v_cvt_pk_bf16_f32 v125, v58, v59
    v_cvt_pk_bf16_f32 v126, v60, v61
    v_cvt_pk_bf16_f32 v127, v62, v63
    ds_write_b128 v21, v[124:127] offset:3072
    s_branch L_j0_3
L_aux_3:
    v_mov_b32 v23, 1
    s_mov_b64 exec, 1
    s_waitcnt lgkmcnt(0)
    ds_add_u32 v4, v23 offset:40
    s_mov_b64 exec, -1
    v_mov_b32 v96, v12
    v_mov_b32 v97, v12
    v_mov_b32 v98, v12
    v_mov_b32 v99, v12
    v_mov_b32 v100, v12
    v_mov_b32 v101, v12
    v_mov_b32 v102, v12
    v_mov_b32 v103, v12
    v_mov_b32 v104, v12
    v_mov_b32 v105, v12
    v_mov_b32 v106, v12
    v_mov_b32 v107, v12
    v_mov_b32 v108, v12
    v_mov_b32 v109, v12
    v_mov_b32 v110, v12
    v_mov_b32 v111, v12
    v_mov_b32 v112, v12
    v_mov_b32 v113, v12
    v_mov_b32 v114, v12
    v_mov_b32 v115, v12
    v_mov_b32 v116, v12
    v_mov_b32 v117, v12
    v_mov_b32 v118, v12
    v_mov_b32 v119, v12
    v_mov_b32 v120, v12
    v_mov_b32 v121, v12
    v_mov_b32 v122, v12
    v_mov_b32 v123, v12
    v_mov_b32 v124, v12
    v_mov_b32 v125, v12
    v_mov_b32 v126, v12
    v_mov_b32 v127, v12
    v_lshrrev_b32 v91, 5, v1
    v_bfe_u32 v88, v1, 2, 2
    v_lshl_add_u32 v88, v91, 2, v88
    v_lshlrev_b32 v88, 5, v88
    v_and_b32 v89, 1, v1
    v_lshl_add_u32 v88, v89, 4, v88
    v_bfe_u32 v89, v1, 4, 1
    v_lshl_add_u32 v88, v89, 12, v88
    v_bfe_u32 v89, v1, 1, 1
    v_lshl_add_u32 v88, v89, 3, v88
    s_lshl_b32 s46, s39, 10
    s_add_u32 s46, s46, 131072
    v_add_u32 v88, s46, v88
    s_lshl_b32 s47, s39, 8
    v_xor_b32 v90, s47, v2
    v_add_u32 v89, 131072, v90
    s_lshl_b32 s46, s39, 1
    v_add_u32 v91, s46, v91
    v_and_b32 v92, 31, v1
    v_mov_b32 v93, 0x4000000
    v_cmp_eq_u32 vcc, 16, v92
    s_nop 1
    v_cndmask_b32 v91, v93, v91, vcc
    v_lshrrev_b32 v92, 8, v90
    v_mul_u32_u24 v92, 640, v92
    v_and_b32 v93, 15, v1
    v_lshl_add_u32 v90, v93, 4, v92
    v_lshl_add_u32 v92, v93, 2, v92
    v_lshlrev_b32 v93, 4, v91
    v_add_u32 v93, 2560, v93
    v_lshlrev_b32 v91, 4, v91
    v_add_u32 v91, 64, v91
    v_cndmask_b32 v91, v91, v92, s[50:51]
    v_cndmask_b32 v90, v93, v90, s[50:51]
    v_add_u32 v93, 64, v93
    v_add_u32 v92, 256, v90
    v_cndmask_b32 v93, v93, v92, s[50:51]
    s_lshl_b32 s93, s37, 4
    s_add_u32 s93, s93, s36
    s_mul_i32 s93, s93, 2688
    s_add_u32 s93, s93, 28999680
    s_lshl_b32 s47, s40, 10
    s_add_u32 s47, s47, s78
    v_add_u32 v21, s47, v2
    s_lshl_b32 s47, s40, 8
    v_xor_b32 v22, s47, v2
    v_add_u32 v22, s78, v22
    v_sub_u32 v22, v21, v2
    v_and_b32 v23, 31, v1
    v_lshl_add_u32 v22, v23, 5, v22
    v_lshrrev_b32 v23, 5, v1
    v_lshl_add_u32 v22, v23, 4, v22
    s_lshl_b32 s46, s42, 7
    s_add_u32 s46, s46, 158720
    v_and_b32 v25, 124, v3
    v_add_u32 v25, s46, v25
    s_lshl_b32 s46, s39, 2
    s_cmp_lg_u32 s46, s37
    s_cbranch_scc1 Lx_162
    s_setprio 3
    v_and_b32 v24, 60, v3
    s_add_u32 s48, s82, 12288
    s_add_u32 s46, s43, 2
    s_lshr_b32 s47, s83, 3
    s_add_u32 s47, s47, 1048576
    s_lshr_b32 s49, s83, 6
    s_add_u32 s49, s49, 73728
    v_and_b32 v82, 15, v1
    v_lshrrev_b32 v81, 4, v1
    v_lshl_add_u32 v82, v82, 2, v81
    v_lshlrev_b32 v82, 3, v82
    v_add_u32 v81, s43, 3
Lpoll_165:
    buffer_load_dword v23, v24, s[4:7], s48 offen sc1
    s_waitcnt vmcnt(0)
    v_cmp_ne_u32 vcc, s46, v23
    s_cbranch_vccz Lpolld_166
    s_sleep 1
    s_sub_u32 s45, s45, 1
    s_cbranch_scc0 Lpoll_165
    s_mov_b32 s45, 0
Lpolld_166:
Lred_163:
    buffer_load_dwordx4 v[64:67], v2, s[4:7], s47 offen offset:0 sc1
    buffer_load_dwordx4 v[68:71], v2, s[4:7], s47 offen offset:1024 sc1
    buffer_load_dwordx4 v[72:75], v2, s[4:7], s47 offen offset:2048 sc1
    buffer_load_dwordx4 v[76:79], v2, s[4:7], s47 offen offset:3072 sc1
    v_mov_b32 v23, 1
    s_waitcnt vmcnt(3)
    v_bitop3_b32 v23, v23, v64, v65 bitop3:0x80
    v_bitop3_b32 v23, v23, v66, v67 bitop3:0x80
    s_waitcnt vmcnt(2)
    v_bitop3_b32 v23, v23, v68, v69 bitop3:0x80
    v_bitop3_b32 v23, v23, v70, v71 bitop3:0x80
    v_add_f32 v64, v64, v68
    v_add_f32 v65, v65, v69
    v_add_f32 v66, v66, v70
    v_add_f32 v67, v67, v71
    s_waitcnt vmcnt(1)
    v_bitop3_b32 v23, v23, v72, v73 bitop3:0x80
    v_bitop3_b32 v23, v23, v74, v75 bitop3:0x80
    v_add_f32 v64, v64, v72
    v_add_f32 v65, v65, v73
    v_add_f32 v66, v66, v74
    v_add_f32 v67, v67, v75
    s_waitcnt vmcnt(0)
    v_bitop3_b32 v23, v23, v76, v77 bitop3:0x80
    v_bitop3_b32 v23, v23, v78, v79 bitop3:0x80
    v_add_f32 v64, v64, v76
    v_add_f32 v65, v65, v77
    v_add_f32 v66, v66, v78
    v_add_f32 v67, v67, v79
    v_and_b32 v23, 1, v23
    v_cmp_ne_u32 vcc, 1, v23
    v_permlane32_swap_b32 v64, v66
    v_permlane32_swap_b32 v65, v67
    v_add_f32 v64, v64, v66
    v_add_f32 v65, v65, v67
    s_nop 1
    v_permlane16_swap_b32 v64, v65
    v_add_f32 v80, v64, v65
    s_cbranch_vccz Lredd_164
    s_sub_u32 s45, s45, 1
    s_cbranch_scc0 Lred_163
    s_mov_b32 s45, 0
Lredd_164:
    s_cmp_eq_u32 s44, 0
    s_cbranch_scc1 Lsafe_167
    buffer_store_dwordx2 v[80:81], v82, s[4:7], s49 offen
Lpub_168:
    s_setprio 0
Lx_162:
Llw_169:
    s_sleep 2
    ds_read_b32 v23, v4 offset:16
    s_waitcnt lgkmcnt(0)
    v_cmp_gt_u32 vcc, 16, v23
    s_cbranch_vccnz Llw_169
    v_add_u32 v0, 98304, v10
    ds_write_b128 v0, v[224:227] offset:0
    ds_write_b128 v0, v[228:231] offset:1024
    ds_write_b128 v0, v[232:235] offset:8192
    ds_write_b128 v0, v[236:239] offset:9216
    ds_write_b128 v0, v[240:243] offset:16384
    ds_write_b128 v0, v[244:247] offset:17408
    ds_write_b128 v0, v[248:251] offset:24576
    ds_write_b128 v0, v[252:255] offset:25600
    s_waitcnt lgkmcnt(0)
    s_lshl_b32 s46, s42, 2
    v_add_u32 v26, s46, v4
Lpw_170:
    s_sleep 2
    ds_read_b32 v23, v26 offset:0
    ds_read_b128 v[72:75], v21
    ds_read_b32 v20, v25
    s_waitcnt lgkmcnt(1)
    v_cmp_gt_u32 vcc, 9, v23
    s_cbranch_vccnz Lpw_170
    v_mfma_f32_32x32x16_bf16 v[32:47], v[16:19], v[72:75], 0
    s_waitcnt lgkmcnt(0)
    v_mul_f32 v20, s55, v20
    s_nop 7
L_j0_3:
    s_nop 1
    v_max3_f32 v76, v32, v33, v34
    v_max3_f32 v77, v35, v36, v37
    v_max3_f32 v78, v38, v39, v40
    v_max3_f32 v79, v41, v42, v43
    v_max3_f32 v76, v76, v44, v45
    v_max3_f32 v77, v77, v46, v47
    v_max3_f32 v76, v76, v78, v79
    v_max_f32 v76, v76, v77
    v_mul_f32 v76, v20, v76
    v_pk_fma_f32 v[32:33], v[32:33], v[20:21], v[76:77] op_sel_hi:[1,0,0] neg_lo:[0,0,1] neg_hi:[0,0,1]
    v_pk_fma_f32 v[34:35], v[34:35], v[20:21], v[76:77] op_sel_hi:[1,0,0] neg_lo:[0,0,1] neg_hi:[0,0,1]
    v_exp_f32 v32, v32
    v_pk_fma_f32 v[36:37], v[36:37], v[20:21], v[76:77] op_sel_hi:[1,0,0] neg_lo:[0,0,1] neg_hi:[0,0,1]
    v_exp_f32 v33, v33
    v_exp_f32 v34, v34
    v_pk_fma_f32 v[38:39], v[38:39], v[20:21], v[76:77] op_sel_hi:[1,0,0] neg_lo:[0,0,1] neg_hi:[0,0,1]
    v_exp_f32 v35, v35
    v_exp_f32 v36, v36
    v_pk_fma_f32 v[40:41], v[40:41], v[20:21], v[76:77] op_sel_hi:[1,0,0] neg_lo:[0,0,1] neg_hi:[0,0,1]
    v_exp_f32 v37, v37
    v_pk_add_f32 v[78:79], v[32:33], v[34:35]
    v_exp_f32 v38, v38
    v_pk_fma_f32 v[42:43], v[42:43], v[20:21], v[76:77] op_sel_hi:[1,0,0] neg_lo:[0,0,1] neg_hi:[0,0,1]
    v_exp_f32 v39, v39
    v_pk_add_f32 v[78:79], v[78:79], v[36:37]
    v_exp_f32 v40, v40
    v_pk_fma_f32 v[44:45], v[44:45], v[20:21], v[76:77] op_sel_hi:[1,0,0] neg_lo:[0,0,1] neg_hi:[0,0,1]
    v_exp_f32 v41, v41
    v_pk_add_f32 v[78:79], v[78:79], v[38:39]
    v_exp_f32 v42, v42
    v_pk_fma_f32 v[46:47], v[46:47], v[20:21], v[76:77] op_sel_hi:[1,0,0] neg_lo:[0,0,1] neg_hi:[0,0,1]
    v_exp_f32 v43, v43
    v_pk_add_f32 v[78:79], v[78:79], v[40:41]
    v_exp_f32 v44, v44
    v_exp_f32 v45, v45
    v_pk_add_f32 v[78:79], v[78:79], v[42:43]
    v_exp_f32 v46, v46
    v_exp_f32 v47, v47
    v_pk_add_f32 v[78:79], v[78:79], v[44:45]
    v_pk_add_f32 v[78:79], v[78:79], v[46:47]
    v_add_f32 v78, v78, v79
    v_rcp_f32 v76, v78
    s_nop 0
    v_pk_mul_f32 v[32:33], v[32:33], v[76:77] op_sel_hi:[1,0]
    v_pk_mul_f32 v[34:35], v[34:35], v[76:77] op_sel_hi:[1,0]
    v_pk_mul_f32 v[36:37], v[36:37], v[76:77] op_sel_hi:[1,0]
    v_pk_mul_f32 v[38:39], v[38:39], v[76:77] op_sel_hi:[1,0]
    v_pk_mul_f32 v[40:41], v[40:41], v[76:77] op_sel_hi:[1,0]
    v_pk_mul_f32 v[42:43], v[42:43], v[76:77] op_sel_hi:[1,0]
    v_pk_mul_f32 v[44:45], v[44:45], v[76:77] op_sel_hi:[1,0]
    v_pk_mul_f32 v[46:47], v[46:47], v[76:77] op_sel_hi:[1,0]
    v_cvt_pk_bf16_f32 v64, v32, v33
    v_cvt_pk_bf16_f32 v65, v34, v35
    v_cvt_pk_bf16_f32 v66, v36, v37
    v_cvt_pk_bf16_f32 v67, v38, v39
    v_cvt_pk_bf16_f32 v68, v40, v41
    v_cvt_pk_bf16_f32 v69, v42, v43
    v_cvt_pk_bf16_f32 v70, v44, v45
    v_cvt_pk_bf16_f32 v71, v46, v47
Lpw_171:
    ds_write_b128 v22, v[64:67]
    ds_write_b128 v22, v[68:71] offset:4096
    s_waitcnt lgkmcnt(0)
    s_barrier
    s_cmp_lg_u32 s40, 0
    s_cbranch_scc1 L_ax1_3
    ds_read_b128 v[64:67], v5 offset:0
    ds_read_b128 v[68:71], v5 offset:1024
    ds_read_b128 v[72:75], v5 offset:2048
    ds_read_b128 v[76:79], v5 offset:3072
    ds_read_b128 v[80:83], v5 offset:4096
    s_waitcnt lgkmcnt(4)
    v_mfma_f32_32x32x16_bf16 v[48:63], v[64:67], v[128:131], 0
    ds_read_b128 v[64:67], v5 offset:5120
    ds_read_b128 v[84:87], v0
    s_add_u32 s91, s72, 10485760
    s_waitcnt lgkmcnt(5)
    v_mfma_f32_32x32x16_bf16 v[48:63], v[68:71], v[132:135], v[48:63]
    ds_read_b128 v[68:71], v5 offset:6144
    s_add_u32 s92, s73, 36864
    s_mul_i32 s96, s37, 43008
    s_waitcnt lgkmcnt(5)
    v_mfma_f32_32x32x16_bf16 v[48:63], v[72:75], v[136:139], v[48:63]
    ds_read_b128 v[72:75], v5 offset:7168
    s_add_u32 s96, s96, 28999680
    s_mov_b32 s94, 0x3f80
    s_waitcnt lgkmcnt(5)
    v_mfma_f32_32x32x16_bf16 v[48:63], v[76:79], v[140:143], v[48:63]
    ds_read_b128 v[76:79], v5 offset:8192
    s_mov_b32 s95, 0x3f800000
    s_lshl_b32 s46, s40, 4
    s_waitcnt lgkmcnt(5)
    v_mfma_f32_32x32x16_bf16 v[48:63], v[80:83], v[144:147], v[48:63]
    ds_read_b128 v[80:83], v5 offset:9216
    v_xor_b32 v99, s46, v1
    v_lshlrev_b32 v99, 5, v99
    s_waitcnt lgkmcnt(5)
    v_mfma_f32_32x32x16_bf16 v[48:63], v[64:67], v[148:151], v[48:63]
    ds_read_b128 v[64:67], v5 offset:10240
    v_add_u32 v99, 159232, v99
    v_and_b32 v100, 32, v1
    s_waitcnt lgkmcnt(4)
    v_mfma_f32_32x32x16_bf16 v[48:63], v[68:71], v[152:155], v[48:63]
    ds_read_b128 v[68:71], v5 offset:11264
    s_lshl_b32 s46, s40, 6
    s_add_u32 s46, s46, 161280
    s_waitcnt lgkmcnt(4)
    v_mfma_f32_32x32x16_bf16 v[48:63], v[72:75], v[156:159], v[48:63]
    ds_read_b128 v[72:75], v5 offset:12288
    v_add_u32 v100, s46, v100
    v_cndmask_b32 v99, v100, v99, s[50:51]
    s_waitcnt lgkmcnt(4)
    v_mfma_f32_32x32x16_bf16 v[48:63], v[76:79], v[160:163], v[48:63]
    ds_read_b128 v[76:79], v5 offset:13312
    s_mul_i32 s97, s39, 640
    s_add_u32 s97, s97, s96
    s_waitcnt lgkmcnt(4)
    v_mfma_f32_32x32x16_bf16 v[48:63], v[80:83], v[164:167], v[48:63]
    ds_read_b128 v[80:83], v5 offset:14336
    v_lshrrev_b32 v100, 4, v1
    v_and_b32 v101, 15, v1
    s_waitcnt lgkmcnt(4)
    v_mfma_f32_32x32x16_bf16 v[48:63], v[64:67], v[168:171], v[48:63]
    ds_read_b128 v[64:67], v5 offset:15360
    v_mul_u32_u24 v96, 2688, v100
    v_lshl_add_u32 v97, v101, 2, v96
    s_waitcnt lgkmcnt(4)
    v_mfma_f32_32x32x16_bf16 v[48:63], v[68:71], v[172:175], v[48:63]
    ds_read_b128 v[68:71], v5 offset:16384
    v_lshl_add_u32 v96, v101, 4, v96
    s_lshl_b32 s46, s39, 9
    s_waitcnt lgkmcnt(4)
    v_mfma_f32_32x32x16_bf16 v[48:63], v[72:75], v[176:179], v[48:63]
    ds_read_b128 v[72:75], v5 offset:17408
    s_add_u32 s46, s46, 159232
    v_lshl_add_u32 v98, v101, 5, s46
    s_waitcnt lgkmcnt(4)
    v_mfma_f32_32x32x16_bf16 v[48:63], v[76:79], v[180:183], v[48:63]
    ds_read_b128 v[76:79], v5 offset:18432
    v_lshl_add_u32 v98, v100, 3, v98
    v_lshlrev_b32 v100, 4, v1
    s_waitcnt lgkmcnt(4)
    v_mfma_f32_32x32x16_bf16 v[48:63], v[80:83], v[184:187], v[48:63]
    ds_read_b128 v[80:83], v5 offset:19456
    v_lshlrev_b32 v100, v100, s94
    v_lshrrev_b32 v101, 1, v101
    s_waitcnt lgkmcnt(4)
    v_mfma_f32_32x32x16_bf16 v[48:63], v[64:67], v[188:191], v[48:63]
    ds_read_b128 v[64:67], v5 offset:20480
    v_cmp_eq_u32 vcc, 0, v101
    s_nop 1
    v_cndmask_b32 v104, 0, v100, vcc
    v_cmp_eq_u32 vcc, 1, v101
    s_nop 1
    v_cndmask_b32 v105, 0, v100, vcc
    s_waitcnt lgkmcnt(4)
    v_mfma_f32_32x32x16_bf16 v[48:63], v[68:71], v[192:195], v[48:63]
    ds_read_b128 v[68:71], v5 offset:21504
    v_cmp_eq_u32 vcc, 2, v101
    s_nop 1
    v_cndmask_b32 v106, 0, v100, vcc
    v_cmp_eq_u32 vcc, 3, v101
    s_nop 1
    v_cndmask_b32 v107, 0, v100, vcc
    s_waitcnt lgkmcnt(4)
    v_mfma_f32_32x32x16_bf16 v[48:63], v[72:75], v[196:199], v[48:63]
    ds_read_b128 v[72:75], v5 offset:22528
    v_cmp_eq_u32 vcc, 4, v101
    s_nop 1
    v_cndmask_b32 v108, 0, v100, vcc
    v_cmp_eq_u32 vcc, 5, v101
    s_nop 1
    v_cndmask_b32 v109, 0, v100, vcc
    s_waitcnt lgkmcnt(4)
    v_mfma_f32_32x32x16_bf16 v[48:63], v[76:79], v[200:203], v[48:63]
    ds_read_b128 v[76:79], v5 offset:23552
    v_cmp_eq_u32 vcc, 6, v101
    s_nop 1
    v_cndmask_b32 v110, 0, v100, vcc
    v_cmp_eq_u32 vcc, 7, v101
    s_nop 1
    v_cndmask_b32 v111, 0, v100, vcc
    s_waitcnt lgkmcnt(4)
    v_mfma_f32_32x32x16_bf16 v[48:63], v[80:83], v[204:207], v[48:63]
    ds_read_b128 v[80:83], v5 offset:24576
    v_add_f32 v84, v84, v85
    v_add_f32 v86, v86, v87
    s_waitcnt lgkmcnt(4)
    v_mfma_f32_32x32x16_bf16 v[48:63], v[64:67], v[208:211], v[48:63]
    ds_read_b128 v[64:67], v5 offset:25600
    v_add_f32 v84, v84, v86
    v_and_b32 v86, 0xffff0000, v84
    s_waitcnt lgkmcnt(4)
    v_mfma_f32_32x32x16_bf16 v[48:63], v[68:71], v[212:215], v[48:63]
    ds_read_b128 v[68:71], v5 offset:26624
    v_sub_f32 v87, v84, v86
    v_cvt_pk_bf16_f32 v84, v86, v87
    s_waitcnt lgkmcnt(4)
    v_mfma_f32_32x32x16_bf16 v[48:63], v[72:75], v[216:219], v[48:63]
    ds_read_b128 v[72:75], v5 offset:27648
    v_cvt_pk_bf16_f32 v85, v86, 0
    v_mov_b32 v86, 0
    s_waitcnt lgkmcnt(4)
    v_mfma_f32_32x32x16_bf16 v[48:63], v[76:79], v[220:223], v[48:63]
    ds_read_b128 v[76:79], v5 offset:28672
    v_mov_b32 v87, 0
    s_waitcnt lgkmcnt(4)
    v_mfma_f32_32x32x16_bf16 v[48:63], v[80:83], v[224:227], v[48:63]
    ds_read_b128 v[80:83], v5 offset:29696
    s_waitcnt lgkmcnt(4)
    v_mfma_f32_32x32x16_bf16 v[48:63], v[64:67], v[228:231], v[48:63]
    ds_read_b128 v[64:67], v5 offset:30720
    s_waitcnt lgkmcnt(4)
    v_mfma_f32_32x32x16_bf16 v[48:63], v[68:71], v[232:235], v[48:63]
    ds_read_b128 v[68:71], v5 offset:31744
    s_waitcnt lgkmcnt(4)
    v_mfma_f32_32x32x16_bf16 v[48:63], v[72:75], v[236:239], v[48:63]
    s_waitcnt lgkmcnt(3)
    v_mfma_f32_32x32x16_bf16 v[48:63], v[76:79], v[240:243], v[48:63]
    s_waitcnt lgkmcnt(2)
    v_mfma_f32_32x32x16_bf16 v[48:63], v[80:83], v[244:247], v[48:63]
    s_waitcnt lgkmcnt(1)
    v_mfma_f32_32x32x16_bf16 v[48:63], v[64:67], v[248:251], v[48:63]
    s_waitcnt lgkmcnt(0)
    v_mfma_f32_32x32x16_bf16 v[48:63], v[68:71], v[252:255], v[48:63]
    v_mfma_f32_32x32x16_bf16 v[48:63], v[84:87], v[28:31], v[48:63]
    s_nop 11
    v_cvt_pk_bf16_f32 v76, v56, v57
    v_cvt_pk_bf16_f32 v77, v58, v59
    v_cvt_pk_bf16_f32 v78, v60, v61
    v_cvt_pk_bf16_f32 v79, v62, v63
    s_barrier
    ds_write_b128 v21, v[76:79] offset:5120
    v_cvt_pk_bf16_f32 v72, v48, v49
    v_cvt_pk_bf16_f32 v73, v50, v51
    v_cvt_pk_bf16_f32 v74, v52, v53
    v_cvt_pk_bf16_f32 v75, v54, v55
    s_nop 1
    v_mfma_f32_32x32x16_bf16 v[32:47], v[16:19], v[72:75], 0
    s_waitcnt lgkmcnt(0)
    s_barrier
    s_branch L_j1_3
L_ax1_3:
    s_cmp_ge_u32 s39, 2
    s_cbranch_scc1 L_ax1b_3
    s_setprio 3
    s_mov_b64 exec, s[50:51]
    ds_read_b128 v[96:99], v89 offset:2048
    ds_read_b128 v[100:103], v89 offset:3072
    ds_read_b128 v[104:107], v89 offset:8192
    ds_read_b128 v[108:111], v89 offset:9216
    ds_read_b128 v[112:115], v89 offset:14336
    ds_read_b128 v[116:119], v89 offset:15360
    ds_read_b128 v[120:123], v89 offset:20480
    ds_read_b128 v[124:127], v89 offset:21504
    s_mov_b64 exec, -1
    ds_read_b64_tr_b16 v[48:49], v88 offset:0
    ds_read_b64_tr_b16 v[50:51], v88 offset:256
    ds_read_b64_tr_b16 v[52:53], v88 offset:512
    ds_read_b64_tr_b16 v[54:55], v88 offset:768
    ds_read_b64_tr_b16 v[56:57], v88 offset:6144
    ds_read_b64_tr_b16 v[58:59], v88 offset:6400
    ds_read_b64_tr_b16 v[60:61], v88 offset:6656
    ds_read_b64_tr_b16 v[62:63], v88 offset:6912
    s_waitcnt lgkmcnt(6)
    v_mfma_f32_32x32x16_bf16 v[32:47], v[48:51], v[96:99], 0
    ds_read_b64_tr_b16 v[64:65], v88 offset:12288
    ds_read_b64_tr_b16 v[66:67], v88 offset:12544
    s_waitcnt lgkmcnt(6)
    v_mfma_f32_32x32x16_bf16 v[32:47], v[52:55], v[100:103], v[32:47]
    ds_read_b64_tr_b16 v[68:69], v88 offset:12800
    ds_read_b64_tr_b16 v[70:71], v88 offset:13056
    s_waitcnt lgkmcnt(6)
    v_mfma_f32_32x32x16_bf16 v[32:47], v[56:59], v[104:107], v[32:47]
    ds_read_b64_tr_b16 v[72:73], v88 offset:18432
    ds_read_b64_tr_b16 v[74:75], v88 offset:18688
    s_waitcnt lgkmcnt(6)
    v_mfma_f32_32x32x16_bf16 v[32:47], v[60:63], v[108:111], v[32:47]
    ds_read_b64_tr_b16 v[76:77], v88 offset:18944
    ds_read_b64_tr_b16 v[78:79], v88 offset:19200
    s_waitcnt lgkmcnt(6)
    v_mfma_f32_32x32x16_bf16 v[32:47], v[64:67], v[112:115], v[32:47]
    s_waitcnt lgkmcnt(4)
    v_mfma_f32_32x32x16_bf16 v[32:47], v[68:71], v[116:119], v[32:47]
    s_waitcnt lgkmcnt(2)
    v_mfma_f32_32x32x16_bf16 v[32:47], v[72:75], v[120:123], v[32:47]
    s_waitcnt lgkmcnt(0)
    v_mfma_f32_32x32x16_bf16 v[32:47], v[76:79], v[124:127], v[32:47]
    s_nop 11
    v_cvt_pk_bf16_f32 v80, v32, v33
    v_cvt_pk_bf16_f32 v81, v34, v35
    v_cvt_pk_bf16_f32 v82, v36, v37
    v_cvt_pk_bf16_f32 v83, v38, v39
    v_cvt_pk_bf16_f32 v84, v40, v41
    v_cvt_pk_bf16_f32 v85, v42, v43
    v_cvt_pk_bf16_f32 v86, v44, v45
    v_cvt_pk_bf16_f32 v87, v46, v47
    buffer_store_dwordx4 v[80:83], v90, s[4:7], s93 offen sc1
    buffer_store_dwordx4 v[84:87], v93, s[4:7], s93 offen sc1
    v_add3_u32 v92, s43, v80, v81
    v_add3_u32 v92, v92, v82, v83
    v_add3_u32 v92, v92, v84, v85
    v_add3_u32 v92, v92, v86, v87
    buffer_store_dword v92, v91, s[4:7], s93 offen offset:512 sc1
    s_setprio 0
L_ax1b_3:
    s_add_u32 s91, s72, 10485760
    s_add_u32 s92, s73, 36864
    s_mul_i32 s96, s37, 43008
    s_add_u32 s96, s96, 28999680
    s_mov_b32 s94, 0x3f80
    s_mov_b32 s95, 0x3f800000
    s_lshl_b32 s46, s40, 4
    v_xor_b32 v99, s46, v1
    v_lshlrev_b32 v99, 5, v99
    v_add_u32 v99, 159232, v99
    v_and_b32 v100, 32, v1
    s_lshl_b32 s46, s40, 6
    s_add_u32 s46, s46, 161280
    v_add_u32 v100, s46, v100
    v_cndmask_b32 v99, v100, v99, s[50:51]
    v_lshrrev_b32 v102, 4, v1
    v_mul_u32_u24 v96, 2688, v102
    v_bfe_u32 v100, v1, 3, 1
    v_and_b32 v101, 1, v1
    v_lshl_add_u32 v100, v100, 1, v101
    v_bfe_u32 v101, v1, 1, 2
    v_mul_u32_u24 v97, 10752, v100
    v_add_u32 v97, v97, v96
    v_lshl_add_u32 v97, v101, 4, v97
    v_lshlrev_b32 v98, 5, v101
    v_lshl_add_u32 v98, v100, 3, v98
    v_lshl_add_u32 v98, v102, 1, v98
    v_add_u32 v98, 161280, v98
    v_and_b32 v100, 15, v1
    v_lshl_add_u32 v96, v100, 3, v96
    s_barrier
    s_barrier
    ds_read_b128 v[72:75], v21 offset:4096
    s_waitcnt lgkmcnt(0)
    v_mfma_f32_32x32x16_bf16 v[32:47], v[16:19], v[72:75], 0
    s_nop 11
L_j1_3:
    s_nop 8
    v_max3_f32 v76, v32, v33, v34
    v_max3_f32 v77, v35, v36, v37
    v_max3_f32 v78, v38, v39, v40
    v_max3_f32 v79, v41, v42, v43
    v_max3_f32 v76, v76, v44, v45
    v_max3_f32 v77, v77, v46, v47
    v_max3_f32 v76, v76, v78, v79
    v_max_f32 v76, v76, v77
    v_mul_f32 v76, v20, v76
    v_pk_fma_f32 v[32:33], v[32:33], v[20:21], v[76:77] op_sel_hi:[1,0,0] neg_lo:[0,0,1] neg_hi:[0,0,1]
    v_pk_fma_f32 v[34:35], v[34:35], v[20:21], v[76:77] op_sel_hi:[1,0,0] neg_lo:[0,0,1] neg_hi:[0,0,1]
    v_exp_f32 v32, v32
    v_pk_fma_f32 v[36:37], v[36:37], v[20:21], v[76:77] op_sel_hi:[1,0,0] neg_lo:[0,0,1] neg_hi:[0,0,1]
    v_exp_f32 v33, v33
    v_exp_f32 v34, v34
    v_pk_fma_f32 v[38:39], v[38:39], v[20:21], v[76:77] op_sel_hi:[1,0,0] neg_lo:[0,0,1] neg_hi:[0,0,1]
    v_exp_f32 v35, v35
    v_exp_f32 v36, v36
    v_pk_fma_f32 v[40:41], v[40:41], v[20:21], v[76:77] op_sel_hi:[1,0,0] neg_lo:[0,0,1] neg_hi:[0,0,1]
    v_exp_f32 v37, v37
    v_pk_add_f32 v[78:79], v[32:33], v[34:35]
    v_exp_f32 v38, v38
    v_pk_fma_f32 v[42:43], v[42:43], v[20:21], v[76:77] op_sel_hi:[1,0,0] neg_lo:[0,0,1] neg_hi:[0,0,1]
    v_exp_f32 v39, v39
    v_pk_add_f32 v[78:79], v[78:79], v[36:37]
    v_exp_f32 v40, v40
    v_pk_fma_f32 v[44:45], v[44:45], v[20:21], v[76:77] op_sel_hi:[1,0,0] neg_lo:[0,0,1] neg_hi:[0,0,1]
    v_exp_f32 v41, v41
    v_pk_add_f32 v[78:79], v[78:79], v[38:39]
    v_exp_f32 v42, v42
    v_pk_fma_f32 v[46:47], v[46:47], v[20:21], v[76:77] op_sel_hi:[1,0,0] neg_lo:[0,0,1] neg_hi:[0,0,1]
    v_exp_f32 v43, v43
    v_pk_add_f32 v[78:79], v[78:79], v[40:41]
    v_exp_f32 v44, v44
    v_exp_f32 v45, v45
    v_pk_add_f32 v[78:79], v[78:79], v[42:43]
    v_exp_f32 v46, v46
    v_exp_f32 v47, v47
    v_pk_add_f32 v[78:79], v[78:79], v[44:45]
    v_pk_add_f32 v[78:79], v[78:79], v[46:47]
    v_add_f32 v78, v78, v79
    v_rcp_f32 v76, v78
    s_nop 0
    v_pk_mul_f32 v[32:33], v[32:33], v[76:77] op_sel_hi:[1,0]
    v_pk_mul_f32 v[34:35], v[34:35], v[76:77] op_sel_hi:[1,0]
    v_pk_mul_f32 v[36:37], v[36:37], v[76:77] op_sel_hi:[1,0]
    v_pk_mul_f32 v[38:39], v[38:39], v[76:77] op_sel_hi:[1,0]
    v_pk_mul_f32 v[40:41], v[40:41], v[76:77] op_sel_hi:[1,0]
    v_pk_mul_f32 v[42:43], v[42:43], v[76:77] op_sel_hi:[1,0]
    v_pk_mul_f32 v[44:45], v[44:45], v[76:77] op_sel_hi:[1,0]
    v_pk_mul_f32 v[46:47], v[46:47], v[76:77] op_sel_hi:[1,0]
    v_cvt_pk_bf16_f32 v112, v32, v33
    v_cvt_pk_bf16_f32 v113, v34, v35
    v_cvt_pk_bf16_f32 v114, v36, v37
    v_cvt_pk_bf16_f32 v115, v38, v39
    v_cvt_pk_bf16_f32 v116, v40, v41
    v_cvt_pk_bf16_f32 v117, v42, v43
    v_cvt_pk_bf16_f32 v118, v44, v45
    v_cvt_pk_bf16_f32 v119, v46, v47
    s_cmp_lg_u32 s40, 0
    s_cbranch_scc1 L_axz_3
Lkp_172:
    s_mov_b32 s46, s97
    buffer_load_dwordx4 v[128:131], v96, s[4:7], s46 offen sc1
    buffer_load_dwordx4 v[132:135], v96, s[4:7], s46 offen offset:256 sc1
    buffer_load_dword v136, v97, s[4:7], s46 offen offset:512 sc1
    s_add_u32 s46, s46, 10752
    buffer_load_dwordx4 v[140:143], v96, s[4:7], s46 offen sc1
    buffer_load_dwordx4 v[144:147], v96, s[4:7], s46 offen offset:256 sc1
    buffer_load_dword v148, v97, s[4:7], s46 offen offset:512 sc1
    s_add_u32 s46, s46, 10752
    buffer_load_dwordx4 v[152:155], v96, s[4:7], s46 offen sc1
    buffer_load_dwordx4 v[156:159], v96, s[4:7], s46 offen offset:256 sc1
    buffer_load_dword v160, v97, s[4:7], s46 offen offset:512 sc1
    s_add_u32 s46, s46, 10752
    buffer_load_dwordx4 v[164:167], v96, s[4:7], s46 offen sc1
    buffer_load_dwordx4 v[168:171], v96, s[4:7], s46 offen offset:256 sc1
    buffer_load_dword v172, v97, s[4:7], s46 offen offset:512 sc1
L_kpc_3:
    s_waitcnt vmcnt(10)
    v_mfma_f32_16x16x32_bf16 v[48:51], v[104:107], v[128:131], 0
    v_mfma_f32_16x16x32_bf16 v[48:51], v[108:111], v[132:135], v[48:51]
    v_add3_u32 v137, s43, v128, v129
    v_add3_u32 v137, v137, v130, v131
    v_add3_u32 v137, v137, v132, v133
    v_add3_u32 v137, v137, v134, v135
    s_waitcnt vmcnt(9)
    v_cmp_ne_u32 s[64:65], v136, v137
    s_waitcnt vmcnt(7)
    v_mfma_f32_16x16x32_bf16 v[48:51], v[104:107], v[140:143], v[48:51]
    v_mfma_f32_16x16x32_bf16 v[48:51], v[108:111], v[144:147], v[48:51]
    v_add3_u32 v149, s43, v140, v141
    v_add3_u32 v149, v149, v142, v143
    v_add3_u32 v149, v149, v144, v145
    v_add3_u32 v149, v149, v146, v147
    s_waitcnt vmcnt(6)
    v_cmp_ne_u32 s[66:67], v148, v149
    s_waitcnt vmcnt(4)
    v_mfma_f32_16x16x32_bf16 v[48:51], v[104:107], v[152:155], v[48:51]
    v_mfma_f32_16x16x32_bf16 v[48:51], v[108:111], v[156:159], v[48:51]
    v_add3_u32 v161, s43, v152, v153
    v_add3_u32 v161, v161, v154, v155
    v_add3_u32 v161, v161, v156, v157
    v_add3_u32 v161, v161, v158, v159
    s_waitcnt vmcnt(3)
    v_cmp_ne_u32 s[68:69], v160, v161
    s_or_b64 s[64:65], s[64:65], s[66:67]
    s_waitcnt vmcnt(1)
    v_mfma_f32_16x16x32_bf16 v[48:51], v[104:107], v[164:167], v[48:51]
    v_mfma_f32_16x16x32_bf16 v[48:51], v[108:111], v[168:171], v[48:51]
    v_add3_u32 v173, s43, v164, v165
    v_add3_u32 v173, v173, v166, v167
    v_add3_u32 v173, v173, v168, v169
    v_add3_u32 v173, v173, v170, v171
    s_waitcnt vmcnt(0)
    v_cmp_ne_u32 s[70:71], v172, v173
    s_or_b64 s[64:65], s[64:65], s[68:69]
    s_nop 0
    v_cvt_pk_bf16_f32 v68, v48, v49
    v_cvt_pk_bf16_f32 v69, v50, v51
    ds_write_b64 v98, v[68:69]
    s_or_b64 s[64:65], s[64:65], s[70:71]
    s_cbranch_scc0 Lkpd_173
    s_sub_u32 s45, s45, 1
    s_cbranch_scc0 Lkp_172
    s_mov_b32 s45, 0
Lkpd_173:
    s_branch L_j2_3
L_axz_3:
    s_cmp_lg_u32 s39, 2
    s_cbranch_scc1 L_j2_3
Lkz_174:
    s_mov_b32 s46, s96
    buffer_load_dword v40, v97, s[4:7], s46 offen offset:576 sc1
    buffer_load_dwordx2 v[32:33], v96, s[4:7], s46 offen offset:2560 sc1
    s_add_u32 s46, s46, 10752
    buffer_load_dwordx2 v[34:35], v96, s[4:7], s46 offen offset:2560 sc1
    s_add_u32 s46, s46, 10752
    buffer_load_dwordx2 v[36:37], v96, s[4:7], s46 offen offset:2560 sc1
    s_add_u32 s46, s46, 10752
    buffer_load_dwordx2 v[38:39], v96, s[4:7], s46 offen offset:2560 sc1
    s_waitcnt vmcnt(3)
    v_add3_u32 v52, s43, v32, v33
    v_lshlrev_b32 v48, 16, v32
    v_and_b32 v49, 0xffff0000, v32
    v_lshlrev_b32 v50, 16, v33
    v_and_b32 v51, 0xffff0000, v33
    v_sub_u32 v52, v52, v40
    s_waitcnt vmcnt(2)
    v_add3_u32 v52, v52, v34, v35
    v_dot2_f32_bf16 v48, v34, s94, v48
    v_dot2_f32_bf16 v49, v34, s95, v49
    v_dot2_f32_bf16 v50, v35, s94, v50
    v_dot2_f32_bf16 v51, v35, s95, v51
    s_waitcnt vmcnt(1)
    v_add3_u32 v52, v52, v36, v37
    v_dot2_f32_bf16 v48, v36, s94, v48
    v_dot2_f32_bf16 v49, v36, s95, v49
    v_dot2_f32_bf16 v50, v37, s94, v50
    v_dot2_f32_bf16 v51, v37, s95, v51
    s_waitcnt vmcnt(0)
    v_add3_u32 v52, v52, v38, v39
    v_dot2_f32_bf16 v48, v38, s94, v48
    v_dot2_f32_bf16 v49, v38, s95, v49
    v_dot2_f32_bf16 v50, v39, s94, v50
    v_dot2_f32_bf16 v51, v39, s95, v51
    v_add_u32_dpp v52, v52, v52 quad_perm:[1,0,3,2] row_mask:0xf bank_mask:0xf
    s_nop 0
    v_permlane32_swap_b32 v48, v50
    v_permlane32_swap_b32 v49, v51
    v_add_u32_dpp v52, v52, v52 row_ror:8 row_mask:0xf bank_mask:0xf
    v_add_f32 v48, v48, v50
    v_add_f32 v49, v49, v51
    v_cmp_ne_u32 vcc, 0, v52
    s_nop 0
    v_permlane16_swap_b32 v48, v49
    v_add_f32 v48, v48, v49
    v_cvt_pk_bf16_f32 v68, v48, v48
    ds_write_b16 v98, v68
    s_cbranch_vccz Lkzd_175
    s_sub_u32 s45, s45, 1
    s_cbranch_scc0 Lkz_174
    s_mov_b32 s45, 0
Lkzd_175:
L_j2_3:
    s_waitcnt lgkmcnt(0)
    s_barrier
    ds_read_b128 v[68:71], v99
    ds_read_b128 v[72:75], v99 offset:16
    v_cmp_gt_u32 vcc, s44, v1
    v_add_u32 v78, s43, 3
    s_nop 0
    v_cndmask_b32 v79, 0x40000000, v1, vcc
    s_waitcnt lgkmcnt(1)
    v_mfma_f32_32x32x16_bf16 v[32:47], v[68:71], v[112:115], 0
    s_waitcnt lgkmcnt(0)
    v_mfma_f32_32x32x16_bf16 v[32:47], v[72:75], v[116:119], v[32:47]
    buffer_store_dword v78, v79, s[4:7], s92 offen
    s_nop 10
    v_add_f32 v40, 0x358637bd, v40
    v_rcp_f32 v40, v40
    s_nop 0
    v_pk_mul_f32 v[32:33], v[32:33], v[40:41] op_sel_hi:[1,0]
    v_pk_mul_f32 v[34:35], v[34:35], v[40:41] op_sel_hi:[1,0]
    v_pk_mul_f32 v[36:37], v[36:37], v[40:41] op_sel_hi:[1,0]
    v_pk_mul_f32 v[38:39], v[38:39], v[40:41] op_sel_hi:[1,0]
    v_add_u32 v32, 0x10000, v32
    v_and_b32 v32, 0xfffe0000, v32
    v_cvt_pk_bf16_f32 v81, v34, v35
    v_cvt_pk_bf16_f32 v82, v36, v37
    v_cvt_pk_bf16_f32 v83, v38, v39
    v_cvt_pk_bf16_f32 v80, v32, v33
    v_and_b32 v80, -2, v80
    s_cmp_eq_u32 s44, 0
    s_cbranch_scc1 Lsafe_176
    buffer_store_dwordx4 v[80:83], v2, s[4:7], s91 offen nt
Lpub_177:
    s_cmp_lg_u32 s40, 0
    s_cbranch_scc1 L_ax3_3
    v_and_b32 v111, 124, v3
    v_add_u32 v111, 36864, v111
    buffer_load_dword v103, v111, s[4:7], s82 offen sc1
    v_mov_b32 v128, v80
    v_mov_b32 v129, v81
    v_mov_b32 v130, v82
    v_mov_b32 v131, v83
    v_and_b32 v21, 31, v1
    v_lshlrev_b32 v21, 10, v21
    v_lshrrev_b32 v22, 5, v1
    v_lshl_add_u32 v21, v22, 4, v21
    s_lshl_b32 s91, s37, 6
    s_add_u32 s91, s91, s83
    s_lshl_b32 s46, s39, 2
    v_add_u32 v100, s78, v2
    v_add_u32 v101, s46, v4
Lopredo_178:
    ds_read_b128 v[64:67], v6 offset:0
    ds_read_b128 v[68:71], v6 offset:1024
    ds_read_b128 v[72:75], v6 offset:2048
    ds_read_b128 v[76:79], v6 offset:3072
    ds_read_b128 v[80:83], v6 offset:4096
    ds_read_b128 v[84:87], v6 offset:5120
    v_lshlrev_b32 v32, 16, v8
    v_and_b32 v33, 0xffff0000, v8
    v_lshlrev_b32 v34, 16, v9
    v_and_b32 v35, 0xffff0000, v9
    v_lshlrev_b32 v36, 16, v10
    v_and_b32 v37, 0xffff0000, v10
    v_lshlrev_b32 v38, 16, v11
    v_and_b32 v39, 0xffff0000, v11
    v_lshlrev_b32 v40, 16, v12
    v_and_b32 v41, 0xffff0000, v12
    v_lshlrev_b32 v42, 16, v13
    v_and_b32 v43, 0xffff0000, v13
    v_lshlrev_b32 v44, 16, v14
    v_and_b32 v45, 0xffff0000, v14
    v_lshlrev_b32 v46, 16, v15
    v_and_b32 v47, 0xffff0000, v15
    v_and_b32 v110, 124, v3
    s_add_u32 s48, s82, 36864
    s_and_b32 s49, s37, 1
    s_lshl_b32 s49, s49, 11
    s_add_u32 s89, s83, 10485760
    v_add3_u32 v108, s49, v2, 0
    s_lshr_b32 s90, s37, 1
    v_add_u32 v108, s89, v108
    s_lshl_b32 s90, s90, 12
    v_xor_b32 v109, 2048, v108
    s_add_u32 s46, s43, 3
    s_waitcnt vmcnt(0)
    v_cmp_ne_u32 vcc, s46, v103
    s_cbranch_vccz Lpolld_180
    buffer_load_dword v104, v110, s[4:7], s48 offen sc1
    s_sleep 2
Lpoll_179:
    buffer_load_dword v105, v110, s[4:7], s48 offen sc1
    s_waitcnt vmcnt(1)
    v_cmp_ne_u32 vcc, s46, v104
    s_cbranch_vccz Lpolld_180
    buffer_load_dword v104, v110, s[4:7], s48 offen sc1
    s_waitcnt vmcnt(1)
    v_cmp_ne_u32 vcc, s46, v105
    s_cbranch_vccz Lpolld_180
    s_sub_u32 s45, s45, 1
    s_cbranch_scc0 Lpoll_179
    s_mov_b32 s45, 0
Lpolld_180:
    v_mov_b32 v23, 0
    buffer_load_dwordx4 v[136:139], v109, s[4:7], s90 offen offset:0 sc1
    buffer_load_dwordx4 v[140:143], v109, s[4:7], s90 offen offset:1024 sc1
    s_add_u32 s90, s90, 4096
    s_and_b32 s90, s90, 0x7fff
    buffer_load_dwordx4 v[144:147], v108, s[4:7], s90 offen offset:0 sc1
    buffer_load_dwordx4 v[148:151], v108, s[4:7], s90 offen offset:1024 sc1
    buffer_load_dwordx4 v[152:155], v109, s[4:7], s90 offen offset:0 sc1
    buffer_load_dwordx4 v[156:159], v109, s[4:7], s90 offen offset:1024 sc1
    s_add_u32 s90, s90, 4096
    s_and_b32 s90, s90, 0x7fff
    buffer_load_dwordx4 v[160:163], v108, s[4:7], s90 offen offset:0 sc1
    buffer_load_dwordx4 v[164:167], v108, s[4:7], s90 offen offset:1024 sc1
    buffer_load_dwordx4 v[168:171], v109, s[4:7], s90 offen offset:0 sc1
    buffer_load_dwordx4 v[172:175], v109, s[4:7], s90 offen offset:1024 sc1
    s_add_u32 s90, s90, 4096
    s_and_b32 s90, s90, 0x7fff
Lhb_181:
    ds_read_b32 v102, v101 offset:0
    ds_read_b128 v[132:135], v100 offset:5120
    s_waitcnt lgkmcnt(0)
    v_cmp_gt_u32 vcc, 10, v102
    s_cbranch_vccnz Lhb_181
    v_mfma_f32_32x32x16_bf16 v[32:47], v[64:67], v[128:131], v[32:47]
    ds_read_b128 v[64:67], v6 offset:6144
    v_mfma_f32_32x32x16_bf16 v[32:47], v[68:71], v[132:135], v[32:47]
    ds_read_b128 v[68:71], v6 offset:7168
    v_or3_b32 v23, v23, v128, v132
    s_waitcnt vmcnt(9)
    v_mfma_f32_32x32x16_bf16 v[32:47], v[72:75], v[136:139], v[32:47]
    buffer_load_dwordx4 v[176:179], v108, s[4:7], s90 offen offset:0 sc1
    ds_read_b128 v[72:75], v6 offset:8192
    s_waitcnt vmcnt(9)
    v_mfma_f32_32x32x16_bf16 v[32:47], v[76:79], v[140:143], v[32:47]
    buffer_load_dwordx4 v[180:183], v108, s[4:7], s90 offen offset:1024 sc1
    ds_read_b128 v[76:79], v6 offset:9216
    v_or3_b32 v23, v23, v136, v140
    s_waitcnt vmcnt(9)
    v_mfma_f32_32x32x16_bf16 v[32:47], v[80:83], v[144:147], v[32:47]
    buffer_load_dwordx4 v[184:187], v109, s[4:7], s90 offen offset:0 sc1
    ds_read_b128 v[80:83], v6 offset:10240
    s_waitcnt vmcnt(9)
    v_mfma_f32_32x32x16_bf16 v[32:47], v[84:87], v[148:151], v[32:47]
    buffer_load_dwordx4 v[188:191], v109, s[4:7], s90 offen offset:1024 sc1
    s_add_u32 s90, s90, 4096
    s_and_b32 s90, s90, 0x7fff
    ds_read_b128 v[84:87], v6 offset:11264
    v_or3_b32 v23, v23, v144, v148
    v_and_b32 v23, 1, v23
    v_cmp_ne_u32 vcc, 0, v23
    s_cbranch_vccnz Lver_182
Lverc_183:
    s_waitcnt vmcnt(9) lgkmcnt(5)
    v_mfma_f32_32x32x16_bf16 v[32:47], v[64:67], v[152:155], v[32:47]
    buffer_load_dwordx4 v[192:195], v108, s[4:7], s90 offen offset:0 sc1
    ds_read_b128 v[64:67], v6 offset:12288
    s_waitcnt vmcnt(9) lgkmcnt(5)
    v_mfma_f32_32x32x16_bf16 v[32:47], v[68:71], v[156:159], v[32:47]
    buffer_load_dwordx4 v[196:199], v108, s[4:7], s90 offen offset:1024 sc1
    ds_read_b128 v[68:71], v6 offset:13312
    v_or3_b32 v23, v23, v152, v156
    s_waitcnt vmcnt(9) lgkmcnt(5)
    v_mfma_f32_32x32x16_bf16 v[32:47], v[72:75], v[160:163], v[32:47]
    buffer_load_dwordx4 v[200:203], v109, s[4:7], s90 offen offset:0 sc1
    ds_read_b128 v[72:75], v6 offset:14336
    s_waitcnt vmcnt(9) lgkmcnt(5)
    v_mfma_f32_32x32x16_bf16 v[32:47], v[76:79], v[164:167], v[32:47]
    buffer_load_dwordx4 v[204:207], v109, s[4:7], s90 offen offset:1024 sc1
    s_add_u32 s90, s90, 4096
    s_and_b32 s90, s90, 0x7fff
    ds_read_b128 v[76:79], v6 offset:15360
    v_or3_b32 v23, v23, v160, v164
    s_waitcnt vmcnt(9) lgkmcnt(5)
    v_mfma_f32_32x32x16_bf16 v[32:47], v[80:83], v[168:171], v[32:47]
    buffer_load_dwordx4 v[208:211], v108, s[4:7], s90 offen offset:0 sc1
    ds_read_b128 v[80:83], v6 offset:16384
    s_waitcnt vmcnt(9) lgkmcnt(5)
    v_mfma_f32_32x32x16_bf16 v[32:47], v[84:87], v[172:175], v[32:47]
    buffer_load_dwordx4 v[212:215], v108, s[4:7], s90 offen offset:1024 sc1
    ds_read_b128 v[84:87], v6 offset:17408
    v_or3_b32 v23, v23, v168, v172
    v_and_b32 v23, 1, v23
    v_cmp_ne_u32 vcc, 0, v23
    s_cbranch_vccnz Lver_184
Lverc_185:
    s_waitcnt vmcnt(9) lgkmcnt(5)
    v_mfma_f32_32x32x16_bf16 v[32:47], v[64:67], v[176:179], v[32:47]
    buffer_load_dwordx4 v[216:219], v109, s[4:7], s90 offen offset:0 sc1
    ds_read_b128 v[64:67], v6 offset:18432
    s_waitcnt vmcnt(9) lgkmcnt(5)
    v_mfma_f32_32x32x16_bf16 v[32:47], v[68:71], v[180:183], v[32:47]
    buffer_load_dwordx4 v[220:223], v109, s[4:7], s90 offen offset:1024 sc1
    s_add_u32 s90, s90, 4096
    s_and_b32 s90, s90, 0x7fff
    ds_read_b128 v[68:71], v6 offset:19456
    v_or3_b32 v23, v23, v176, v180
    s_waitcnt vmcnt(9) lgkmcnt(5)
    v_mfma_f32_32x32x16_bf16 v[32:47], v[72:75], v[184:187], v[32:47]
    buffer_load_dwordx4 v[224:227], v108, s[4:7], s90 offen offset:0 sc1
    ds_read_b128 v[72:75], v6 offset:20480
    s_waitcnt vmcnt(9) lgkmcnt(5)
    v_mfma_f32_32x32x16_bf16 v[32:47], v[76:79], v[188:191], v[32:47]
    buffer_load_dwordx4 v[228:231], v108, s[4:7], s90 offen offset:1024 sc1
    ds_read_b128 v[76:79], v6 offset:21504
    v_or3_b32 v23, v23, v184, v188
    s_waitcnt vmcnt(9) lgkmcnt(5)
    v_mfma_f32_32x32x16_bf16 v[32:47], v[80:83], v[192:195], v[32:47]
    buffer_load_dwordx4 v[232:235], v109, s[4:7], s90 offen offset:0 sc1
    ds_read_b128 v[80:83], v6 offset:22528
    s_waitcnt vmcnt(9) lgkmcnt(5)
    v_mfma_f32_32x32x16_bf16 v[32:47], v[84:87], v[196:199], v[32:47]
    buffer_load_dwordx4 v[236:239], v109, s[4:7], s90 offen offset:1024 sc1
    s_add_u32 s90, s90, 4096
    s_and_b32 s90, s90, 0x7fff
    ds_read_b128 v[84:87], v6 offset:23552
    v_or3_b32 v23, v23, v192, v196
    s_waitcnt vmcnt(9) lgkmcnt(5)
    v_mfma_f32_32x32x16_bf16 v[32:47], v[64:67], v[200:203], v[32:47]
    buffer_load_dwordx4 v[240:243], v108, s[4:7], s90 offen offset:0 sc1
    ds_read_b128 v[64:67], v6 offset:24576
    s_waitcnt vmcnt(9) lgkmcnt(5)
    v_mfma_f32_32x32x16_bf16 v[32:47], v[68:71], v[204:207], v[32:47]
    buffer_load_dwordx4 v[244:247], v108, s[4:7], s90 offen offset:1024 sc1
    ds_read_b128 v[68:71], v6 offset:25600
    v_or3_b32 v23, v23, v200, v204
    s_waitcnt vmcnt(9) lgkmcnt(5)
    v_mfma_f32_32x32x16_bf16 v[32:47], v[72:75], v[208:211], v[32:47]
    buffer_load_dwordx4 v[248:251], v109, s[4:7], s90 offen offset:0 sc1
    ds_read_b128 v[72:75], v6 offset:26624
    s_waitcnt vmcnt(9) lgkmcnt(5)
    v_mfma_f32_32x32x16_bf16 v[32:47], v[76:79], v[212:215], v[32:47]
    buffer_load_dwordx4 v[252:255], v109, s[4:7], s90 offen offset:1024 sc1
    ds_read_b128 v[76:79], v6 offset:27648
    v_or3_b32 v23, v23, v208, v212
    s_waitcnt vmcnt(9) lgkmcnt(5)
    v_mfma_f32_32x32x16_bf16 v[32:47], v[80:83], v[216:219], v[32:47]
    ds_read_b128 v[80:83], v6 offset:28672
    s_waitcnt vmcnt(8) lgkmcnt(5)
    v_mfma_f32_32x32x16_bf16 v[32:47], v[84:87], v[220:223], v[32:47]
    ds_read_b128 v[84:87], v6 offset:29696
    v_or3_b32 v23, v23, v216, v220
    s_waitcnt vmcnt(7) lgkmcnt(5)
    v_mfma_f32_32x32x16_bf16 v[32:47], v[64:67], v[224:227], v[32:47]
    ds_read_b128 v[64:67], v6 offset:30720
    s_waitcnt vmcnt(6) lgkmcnt(5)
    v_mfma_f32_32x32x16_bf16 v[32:47], v[68:71], v[228:231], v[32:47]
    ds_read_b128 v[68:71], v6 offset:31744
    v_or3_b32 v23, v23, v224, v228
    s_waitcnt vmcnt(5) lgkmcnt(5)
    v_mfma_f32_32x32x16_bf16 v[32:47], v[72:75], v[232:235], v[32:47]
    s_waitcnt vmcnt(4) lgkmcnt(4)
    v_mfma_f32_32x32x16_bf16 v[32:47], v[76:79], v[236:239], v[32:47]
    v_or3_b32 v23, v23, v232, v236
    s_waitcnt vmcnt(3) lgkmcnt(3)
    v_mfma_f32_32x32x16_bf16 v[32:47], v[80:83], v[240:243], v[32:47]
    s_waitcnt vmcnt(2) lgkmcnt(2)
    v_mfma_f32_32x32x16_bf16 v[32:47], v[84:87], v[244:247], v[32:47]
    v_or3_b32 v23, v23, v240, v244
    s_waitcnt vmcnt(1) lgkmcnt(1)
    v_mfma_f32_32x32x16_bf16 v[32:47], v[64:67], v[248:251], v[32:47]
    s_waitcnt vmcnt(0) lgkmcnt(0)
    v_mfma_f32_32x32x16_bf16 v[32:47], v[68:71], v[252:255], v[32:47]
    v_or3_b32 v23, v23, v248, v252
    v_and_b32 v23, 1, v23
    v_cmp_ne_u32 vcc, 0, v23
    s_cbranch_vccnz Lver_186
Lverc_187:
    s_nop 7
    v_cvt_pk_bf16_f32 v128, v32, v33
    v_cvt_pk_bf16_f32 v129, v34, v35
    v_cvt_pk_bf16_f32 v130, v36, v37
    v_cvt_pk_bf16_f32 v131, v38, v39
    v_cvt_pk_bf16_f32 v132, v40, v41
    v_cvt_pk_bf16_f32 v133, v42, v43
    v_cvt_pk_bf16_f32 v134, v44, v45
    v_cvt_pk_bf16_f32 v135, v46, v47
    v_permlane32_swap_b32 v128, v130
    v_permlane32_swap_b32 v129, v131
    v_permlane32_swap_b32 v132, v134
    v_permlane32_swap_b32 v133, v135
    buffer_store_dwordx4 v[128:131], v21, s[32:35], s91 offen nt
    buffer_store_dwordx4 v[132:135], v21, s[32:35], s91 offen offset:32 nt
    s_branch L_main_4
L_ax3_3:
    v_add_u32 v64, s78, v2
    s_lshl_b32 s46, s42, 2
    ds_write_b128 v64, v[80:83] offset:5120
    v_add_u32 v65, s46, v4
    v_mov_b32 v66, 10
    ds_write_b32 v65, v66 offset:0
    s_waitcnt lgkmcnt(0)
    s_branch L_aux_4
L_main_4:
    s_or_b32 s46, s2, s38
    s_cmp_lg_u32 s46, 0
    s_cbranch_scc1 L_aux_4
    s_mov_b32 s48, 0
    v_mov_b32 v23, s43
    s_mov_b64 exec, 1
    buffer_store_dword v23, off, s[4:7], s48
    s_mov_b64 exec, -1
L_aux_4:
L_end:
    s_endpgm
Lsafe_51:
    buffer_store_dwordx4 v[80:83], v2, s[4:7], s91 offen sc1
    v_mov_b32 v23, s43
    s_mov_b64 exec, 1
    s_waitcnt vmcnt(0)
    buffer_store_dword v23, off, s[4:7], s92 sc1
    s_mov_b64 exec, -1
    s_branch Lpub_52
Lsafe_57:
    buffer_store_dwordx4 v[128:131], v2, s[32:35], s80 offen sc1
    buffer_store_dwordx4 v[132:135], v2, s[32:35], s80 offen offset:1024 sc1
    v_pk_add_f32 v[64:65], v[32:33], v[34:35]
    v_pk_add_f32 v[66:67], v[36:37], v[38:39]
    v_pk_add_f32 v[68:69], v[40:41], v[42:43]
    v_pk_add_f32 v[70:71], v[44:45], v[46:47]
    v_pk_mul_f32 v[72:73], v[32:33], v[32:33]
    v_pk_mul_f32 v[74:75], v[34:35], v[34:35]
    v_pk_add_f32 v[64:65], v[64:65], v[66:67]
    v_pk_add_f32 v[68:69], v[68:69], v[70:71]
    v_pk_fma_f32 v[72:73], v[36:37], v[36:37], v[72:73]
    v_pk_fma_f32 v[74:75], v[38:39], v[38:39], v[74:75]
    v_pk_fma_f32 v[72:73], v[40:41], v[40:41], v[72:73]
    v_pk_fma_f32 v[74:75], v[42:43], v[42:43], v[74:75]
    v_pk_fma_f32 v[72:73], v[44:45], v[44:45], v[72:73]
    v_pk_fma_f32 v[74:75], v[46:47], v[46:47], v[74:75]
    v_pk_add_f32 v[64:65], v[64:65], v[68:69]
    v_pk_add_f32 v[72:73], v[72:73], v[74:75]
    v_add_f32 v64, v64, v65
    v_add_f32 v66, v72, v73
    s_nop 1
    v_permlane32_swap_b32 v64, v66
    v_add_f32 v64, v64, v66
    v_or_b32 v64, 1, v64
    buffer_store_dword v64, v3, s[4:7], s92 offen sc1
    v_mov_b32 v23, s43
    s_mov_b64 exec, 1
    s_waitcnt vmcnt(0)
    buffer_store_dword v23, off, s[4:7], s93 sc1
    s_mov_b64 exec, -1
    s_branch Lpub_58
Lfin_67:
    buffer_load_dwordx2 v[96:97], v98, s[4:7], s47 offen sc1
    s_waitcnt vmcnt(0)
    v_cmp_ne_u32 vcc, s64, v97
    s_cbranch_vccz Lfinc_68
    s_sub_u32 s45, s45, 1
    s_cbranch_scc0 Lfin_67
    s_mov_b32 s45, 0
    s_branch Lfinc_68
Lsafe_75:
    buffer_store_dwordx2 v[80:81], v82, s[4:7], s49 offen sc1
    s_branch Lpub_76
Lsafe_83:
    buffer_store_dwordx4 v[80:83], v2, s[4:7], s91 offen sc1
    v_add_u32 v23, s43, 1
    s_mov_b64 exec, 1
    buffer_store_dword v23, off, s[4:7], s92 sc1
    s_mov_b64 exec, -1
    s_branch Lpub_84
Lsafe_95:
    buffer_store_dwordx4 v[128:131], v2, s[32:35], s80 offen sc1
    buffer_store_dwordx4 v[132:135], v2, s[32:35], s80 offen offset:1024 sc1
    v_add_u32 v23, s43, 1
    s_mov_b64 exec, 1
    buffer_store_dword v23, off, s[4:7], s93 sc1
    s_mov_b64 exec, -1
    buffer_load_dword v103, v111, s[4:7], s82 offen sc1
    v_pk_add_f32 v[64:65], v[32:33], v[34:35]
    v_pk_add_f32 v[66:67], v[36:37], v[38:39]
    v_pk_add_f32 v[68:69], v[40:41], v[42:43]
    v_pk_add_f32 v[70:71], v[44:45], v[46:47]
    v_pk_mul_f32 v[72:73], v[32:33], v[32:33]
    v_pk_mul_f32 v[74:75], v[34:35], v[34:35]
    v_pk_add_f32 v[64:65], v[64:65], v[66:67]
    v_pk_add_f32 v[68:69], v[68:69], v[70:71]
    v_pk_fma_f32 v[72:73], v[36:37], v[36:37], v[72:73]
    v_pk_fma_f32 v[74:75], v[38:39], v[38:39], v[74:75]
    v_pk_fma_f32 v[72:73], v[40:41], v[40:41], v[72:73]
    v_pk_fma_f32 v[74:75], v[42:43], v[42:43], v[74:75]
    v_pk_fma_f32 v[72:73], v[44:45], v[44:45], v[72:73]
    v_pk_fma_f32 v[74:75], v[46:47], v[46:47], v[74:75]
    v_pk_add_f32 v[64:65], v[64:65], v[68:69]
    v_pk_add_f32 v[72:73], v[72:73], v[74:75]
    v_add_f32 v64, v64, v65
    v_add_f32 v66, v72, v73
    s_nop 1
    v_permlane32_swap_b32 v64, v66
    v_add_f32 v64, v64, v66
    v_and_b32 v64, -2, v64
    buffer_store_dword v64, v3, s[4:7], s92 offen sc1
    s_branch Lpub_96
Lfin_106:
    buffer_load_dwordx2 v[96:97], v98, s[4:7], s47 offen sc1
    s_waitcnt vmcnt(0)
    v_cmp_ne_u32 vcc, s64, v97
    s_cbranch_vccz Lfinc_107
    s_sub_u32 s45, s45, 1
    s_cbranch_scc0 Lfin_106
    s_mov_b32 s45, 0
    s_branch Lfinc_107
Lsafe_117:
    buffer_store_dwordx2 v[80:81], v82, s[4:7], s49 offen sc1
    s_branch Lpub_118
Lsafe_134:
    buffer_store_dwordx4 v[80:83], v2, s[4:7], s91 offen sc1
    v_add_u32 v23, s43, 2
    s_mov_b64 exec, 1
    buffer_store_dword v23, off, s[4:7], s92 sc1
    s_mov_b64 exec, -1
    s_branch Lpub_135
Lsafe_146:
    buffer_store_dwordx4 v[128:131], v2, s[32:35], s80 offen sc1
    buffer_store_dwordx4 v[132:135], v2, s[32:35], s80 offen offset:1024 sc1
    v_add_u32 v23, s43, 2
    s_mov_b64 exec, 1
    buffer_store_dword v23, off, s[4:7], s93 sc1
    s_mov_b64 exec, -1
    buffer_load_dword v103, v111, s[4:7], s82 offen sc1
    v_pk_add_f32 v[64:65], v[32:33], v[34:35]
    v_pk_add_f32 v[66:67], v[36:37], v[38:39]
    v_pk_add_f32 v[68:69], v[40:41], v[42:43]
    v_pk_add_f32 v[70:71], v[44:45], v[46:47]
    v_pk_mul_f32 v[72:73], v[32:33], v[32:33]
    v_pk_mul_f32 v[74:75], v[34:35], v[34:35]
    v_pk_add_f32 v[64:65], v[64:65], v[66:67]
    v_pk_add_f32 v[68:69], v[68:69], v[70:71]
    v_pk_fma_f32 v[72:73], v[36:37], v[36:37], v[72:73]
    v_pk_fma_f32 v[74:75], v[38:39], v[38:39], v[74:75]
    v_pk_fma_f32 v[72:73], v[40:41], v[40:41], v[72:73]
    v_pk_fma_f32 v[74:75], v[42:43], v[42:43], v[74:75]
    v_pk_fma_f32 v[72:73], v[44:45], v[44:45], v[72:73]
    v_pk_fma_f32 v[74:75], v[46:47], v[46:47], v[74:75]
    v_pk_add_f32 v[64:65], v[64:65], v[68:69]
    v_pk_add_f32 v[72:73], v[72:73], v[74:75]
    v_add_f32 v64, v64, v65
    v_add_f32 v66, v72, v73
    s_nop 1
    v_permlane32_swap_b32 v64, v66
    v_add_f32 v64, v64, v66
    v_or_b32 v64, 1, v64
    buffer_store_dword v64, v3, s[4:7], s92 offen sc1
    s_branch Lpub_147
Lfin_158:
    buffer_load_dwordx2 v[96:97], v98, s[4:7], s47 offen sc1
    s_waitcnt vmcnt(0)
    v_cmp_ne_u32 vcc, s64, v97
    s_cbranch_vccz Lfinc_159
    s_sub_u32 s45, s45, 1
    s_cbranch_scc0 Lfin_158
    s_mov_b32 s45, 0
    s_branch Lfinc_159
Lsafe_167:
    buffer_store_dwordx2 v[80:81], v82, s[4:7], s49 offen sc1
    s_branch Lpub_168
Lsafe_176:
    buffer_store_dwordx4 v[80:83], v2, s[4:7], s91 offen sc1
    v_add_u32 v23, s43, 3
    s_mov_b64 exec, 1
    buffer_store_dword v23, off, s[4:7], s92 sc1
    s_mov_b64 exec, -1
    s_branch Lpub_177
Lver_89:
    s_waitcnt vmcnt(0) lgkmcnt(0)
    s_sub_u32 s45, s45, 1
    s_cbranch_scc0 Lopredo_85
    s_mov_b32 s45, 0
    s_branch Lverc_90
Lver_91:
    s_waitcnt vmcnt(0) lgkmcnt(0)
    s_sub_u32 s45, s45, 1
    s_cbranch_scc0 Lopredo_85
    s_mov_b32 s45, 0
    s_branch Lverc_92
Lver_93:
    s_waitcnt vmcnt(0) lgkmcnt(0)
    s_sub_u32 s45, s45, 1
    s_cbranch_scc0 Lopredo_85
    s_mov_b32 s45, 0
    s_branch Lverc_94
Lver_102:
    s_waitcnt vmcnt(0) lgkmcnt(0)
    s_sub_u32 s45, s45, 1
    s_cbranch_scc0 Lkvredo_99
    s_mov_b32 s45, 0
    s_branch Lverc_103
Lver_104:
    s_waitcnt vmcnt(0) lgkmcnt(0)
    s_sub_u32 s45, s45, 1
    s_cbranch_scc0 Lkvredo_99
    s_mov_b32 s45, 0
    s_branch Lverc_105
Lver_108:
    s_waitcnt vmcnt(0) lgkmcnt(0)
    s_sub_u32 s45, s45, 1
    s_cbranch_scc0 Lkvredo_99
    s_mov_b32 s45, 0
    s_branch Lverc_109
Lver_140:
    s_waitcnt vmcnt(0) lgkmcnt(0)
    s_sub_u32 s45, s45, 1
    s_cbranch_scc0 Lopredo_136
    s_mov_b32 s45, 0
    s_branch Lverc_141
Lver_142:
    s_waitcnt vmcnt(0) lgkmcnt(0)
    s_sub_u32 s45, s45, 1
    s_cbranch_scc0 Lopredo_136
    s_mov_b32 s45, 0
    s_branch Lverc_143
Lver_144:
    s_waitcnt vmcnt(0) lgkmcnt(0)
    s_sub_u32 s45, s45, 1
    s_cbranch_scc0 Lopredo_136
    s_mov_b32 s45, 0
    s_branch Lverc_145
Lver_154:
    s_waitcnt vmcnt(0) lgkmcnt(0)
    s_sub_u32 s45, s45, 1
    s_cbranch_scc0 Lkvredo_151
    s_mov_b32 s45, 0
    s_branch Lverc_155
Lver_156:
    s_waitcnt vmcnt(0) lgkmcnt(0)
    s_sub_u32 s45, s45, 1
    s_cbranch_scc0 Lkvredo_151
    s_mov_b32 s45, 0
    s_branch Lverc_157
Lver_160:
    s_waitcnt vmcnt(0) lgkmcnt(0)
    s_sub_u32 s45, s45, 1
    s_cbranch_scc0 Lkvredo_151
    s_mov_b32 s45, 0
    s_branch Lverc_161
Lver_182:
    s_waitcnt vmcnt(0) lgkmcnt(0)
    s_sub_u32 s45, s45, 1
    s_cbranch_scc0 Lopredo_178
    s_mov_b32 s45, 0
    s_branch Lverc_183
Lver_184:
    s_waitcnt vmcnt(0) lgkmcnt(0)
    s_sub_u32 s45, s45, 1
    s_cbranch_scc0 Lopredo_178
    s_mov_b32 s45, 0
    s_branch Lverc_185
Lver_186:
    s_waitcnt vmcnt(0) lgkmcnt(0)
    s_sub_u32 s45, s45, 1
    s_cbranch_scc0 Lopredo_178
    s_mov_b32 s45, 0
    s_branch Lverc_187
L_fb_0:
    s_waitcnt lgkmcnt(0)
    v_mov_b32 v0, 0xff800000
    v_mov_b32 v88, 0x3f803f80
    v_mov_b32 v89, v88
    v_mov_b32 v90, v88
    v_mov_b32 v91, v88
    v_mov_b32 v92, v88
    v_mov_b32 v93, v88
    v_mov_b32 v94, v88
    v_mov_b32 v95, v88
    v_subrev_f32 v96, 0x0, v27
    v_subrev_f32 v97, 0x71800000, v27
    v_subrev_f32 v98, 0x72000000, v27
    v_subrev_f32 v99, 0x72400000, v27
    v_subrev_f32 v100, 0x73000000, v27
    v_subrev_f32 v101, 0x73100000, v27
    v_subrev_f32 v102, 0x73200000, v27
    v_subrev_f32 v103, 0x73300000, v27
    v_subrev_f32 v104, 0x73800000, v27
    v_subrev_f32 v105, 0x73880000, v27
    v_subrev_f32 v106, 0x73900000, v27
    v_subrev_f32 v107, 0x73980000, v27
    v_subrev_f32 v108, 0x73c00000, v27
    v_subrev_f32 v109, 0x73c80000, v27
    v_subrev_f32 v110, 0x73d00000, v27
    v_subrev_f32 v111, 0x73d80000, v27
    v_min_f32 v96, 0, v96
    v_min_f32 v97, 0, v97
    v_min_f32 v98, 0, v98
    v_min_f32 v99, 0, v99
    v_min_f32 v100, 0, v100
    v_min_f32 v101, 0, v101
    v_min_f32 v102, 0, v102
    v_min_f32 v103, 0, v103
    v_min_f32 v104, 0, v104
    v_min_f32 v105, 0, v105
    v_min_f32 v106, 0, v106
    v_min_f32 v107, 0, v107
    v_min_f32 v108, 0, v108
    v_min_f32 v109, 0, v109
    v_min_f32 v110, 0, v110
    v_min_f32 v111, 0, v111
    v_mov_b32 v48, 0
    v_mov_b32 v49, 0
    v_mov_b32 v50, 0
    v_mov_b32 v51, 0
    v_mov_b32 v52, 0
    v_mov_b32 v53, 0
    v_mov_b32 v54, 0
    v_mov_b32 v55, 0
    v_mov_b32 v56, 0
    v_mov_b32 v57, 0
    v_mov_b32 v58, 0
    v_mov_b32 v59, 0
    v_mov_b32 v60, 0
    v_mov_b32 v61, 0
    v_mov_b32 v62, 0
    v_mov_b32 v63, 0
    v_sub_f32 v112, 0xf1800000, v27
    v_sub_f32 v113, 0x0, v27
    v_sub_f32 v114, 0x71800000, v27
    v_sub_f32 v115, 0x72000000, v27
    v_sub_f32 v116, 0x72e00000, v27
    v_sub_f32 v117, 0x73000000, v27
    v_sub_f32 v118, 0x73100000, v27
    v_sub_f32 v119, 0x73200000, v27
    v_sub_f32 v120, 0x73700000, v27
    v_sub_f32 v121, 0x73800000, v27
    v_sub_f32 v122, 0x73880000, v27
    v_sub_f32 v123, 0x73900000, v27
    v_sub_f32 v124, 0x73b80000, v27
    v_sub_f32 v125, 0x73c00000, v27
    v_sub_f32 v126, 0x73c80000, v27
    v_sub_f32 v127, 0x73d00000, v27
    v_min_f32 v112, 0, v112
    v_min_f32 v113, 0, v113
    v_min_f32 v114, 0, v114
    v_min_f32 v115, 0, v115
    v_min_f32 v116, 0, v116
    v_min_f32 v117, 0, v117
    v_min_f32 v118, 0, v118
    v_min_f32 v119, 0, v119
    v_min_f32 v120, 0, v120
    v_min_f32 v121, 0, v121
    v_min_f32 v122, 0, v122
    v_min_f32 v123, 0, v123
    v_min_f32 v124, 0, v124
    v_min_f32 v125, 0, v125
    v_min_f32 v126, 0, v126
    v_min_f32 v127, 0, v127
    s_lshl_b32 s47, s40, 10
    s_add_u32 s47, s47, s78
    v_add_u32 v21, s47, v2
    s_lshl_b32 s47, s40, 8
    v_xor_b32 v22, s47, v2
    v_add_u32 v22, s78, v22
    s_add_u32 s53, s42, 1
    s_mov_b32 s54, -6144
    v_mov_b32 v32, v96
    v_mov_b32 v33, v97
    v_mov_b32 v34, v98
    v_mov_b32 v35, v99
    v_mov_b32 v36, v100
    v_mov_b32 v37, v101
    v_mov_b32 v38, v102
    v_mov_b32 v39, v103
    v_mov_b32 v40, v104
    v_mov_b32 v41, v105
    v_mov_b32 v42, v106
    v_mov_b32 v43, v107
    v_mov_b32 v44, v108
    v_mov_b32 v45, v109
    v_mov_b32 v46, v110
    v_mov_b32 v47, v111
Lfb_188:
    ds_read_b128 v[76:79], v21
    s_waitcnt lgkmcnt(0)
    v_mfma_f32_32x32x16_bf16 v[32:47], v[76:79], v[72:75], v[32:47]
    s_nop 11
    v_max3_f32 v0, v0, v32, v33
    v_max3_f32 v0, v0, v34, v35
    v_max3_f32 v0, v0, v36, v37
    v_max3_f32 v0, v0, v38, v39
    v_max3_f32 v0, v0, v40, v41
    v_max3_f32 v0, v0, v42, v43
    v_max3_f32 v0, v0, v44, v45
    v_max3_f32 v0, v0, v46, v47
    v_mov_b32 v32, 0
    v_mov_b32 v33, 0
    v_mov_b32 v34, 0
    v_mov_b32 v35, 0
    v_mov_b32 v36, 0
    v_mov_b32 v37, 0
    v_mov_b32 v38, 0
    v_mov_b32 v39, 0
    v_mov_b32 v40, 0
    v_mov_b32 v41, 0
    v_mov_b32 v42, 0
    v_mov_b32 v43, 0
    v_mov_b32 v44, 0
    v_mov_b32 v45, 0
    v_mov_b32 v46, 0
    v_mov_b32 v47, 0
    v_add_u32 v21, s54, v21
    v_add_u32 v22, s54, v22
    s_sub_u32 s53, s53, 1
    s_cmp_lg_u32 s53, 0
    s_cbranch_scc1 Lfb_188
Lfbn_189:
    s_cmp_eq_u32 s36, 0
    s_cbranch_scc1 Lfbn_192
    s_lshl_b32 s47, s40, 10
    s_add_u32 s47, s47, s76
    v_add_u32 v21, s47, v2
    s_lshl_b32 s47, s40, 8
    v_xor_b32 v22, s47, v2
    v_add_u32 v22, s76, v22
    s_mov_b32 s53, s77
    s_mov_b32 s54, 4096
    s_cmp_eq_u32 s36, 1
    s_cbranch_scc1 Lfb_191
    v_mov_b32 v32, v112
    v_mov_b32 v33, v113
    v_mov_b32 v34, v114
    v_mov_b32 v35, v115
    v_mov_b32 v36, v116
    v_mov_b32 v37, v117
    v_mov_b32 v38, v118
    v_mov_b32 v39, v119
    v_mov_b32 v40, v120
    v_mov_b32 v41, v121
    v_mov_b32 v42, v122
    v_mov_b32 v43, v123
    v_mov_b32 v44, v124
    v_mov_b32 v45, v125
    v_mov_b32 v46, v126
    v_mov_b32 v47, v127
Lfb_191:
    ds_read_b128 v[76:79], v21
    s_waitcnt lgkmcnt(0)
    v_mfma_f32_32x32x16_bf16 v[32:47], v[76:79], v[72:75], v[32:47]
    s_nop 11
    v_max3_f32 v0, v0, v32, v33
    v_max3_f32 v0, v0, v34, v35
    v_max3_f32 v0, v0, v36, v37
    v_max3_f32 v0, v0, v38, v39
    v_max3_f32 v0, v0, v40, v41
    v_max3_f32 v0, v0, v42, v43
    v_max3_f32 v0, v0, v44, v45
    v_max3_f32 v0, v0, v46, v47
    v_mov_b32 v32, 0
    v_mov_b32 v33, 0
    v_mov_b32 v34, 0
    v_mov_b32 v35, 0
    v_mov_b32 v36, 0
    v_mov_b32 v37, 0
    v_mov_b32 v38, 0
    v_mov_b32 v39, 0
    v_mov_b32 v40, 0
    v_mov_b32 v41, 0
    v_mov_b32 v42, 0
    v_mov_b32 v43, 0
    v_mov_b32 v44, 0
    v_mov_b32 v45, 0
    v_mov_b32 v46, 0
    v_mov_b32 v47, 0
    v_add_u32 v21, s54, v21
    v_add_u32 v22, s54, v22
    s_sub_u32 s53, s53, 1
    s_cmp_lg_u32 s53, 0
    s_cbranch_scc1 Lfb_191
Lfbn_192:
    v_mov_b32 v23, v0
    s_nop 1
    v_permlane32_swap_b32 v23, v0
    v_max_f32 v0, v0, v23
    s_lshl_b32 s47, s40, 10
    s_add_u32 s47, s47, s78
    v_add_u32 v21, s47, v2
    s_lshl_b32 s47, s40, 8
    v_xor_b32 v22, s47, v2
    v_add_u32 v22, s78, v22
    s_add_u32 s53, s42, 1
    s_mov_b32 s54, -6144
    v_mov_b32 v32, v96
    v_mov_b32 v33, v97
    v_mov_b32 v34, v98
    v_mov_b32 v35, v99
    v_mov_b32 v36, v100
    v_mov_b32 v37, v101
    v_mov_b32 v38, v102
    v_mov_b32 v39, v103
    v_mov_b32 v40, v104
    v_mov_b32 v41, v105
    v_mov_b32 v42, v106
    v_mov_b32 v43, v107
    v_mov_b32 v44, v108
    v_mov_b32 v45, v109
    v_mov_b32 v46, v110
    v_mov_b32 v47, v111
Lfb_194:
    ds_read_b128 v[76:79], v21
    s_mov_b64 exec, s[50:51]
    ds_read_b128 v[88:91], v22 offset:2048
    ds_read_b128 v[92:95], v22 offset:3072
    s_mov_b64 exec, -1
    s_waitcnt lgkmcnt(0)
    v_mfma_f32_32x32x16_bf16 v[32:47], v[76:79], v[72:75], v[32:47]
    s_nop 11
    v_sub_f32 v32, v32, v0
    v_sub_f32 v33, v33, v0
    v_sub_f32 v34, v34, v0
    v_sub_f32 v35, v35, v0
    v_sub_f32 v36, v36, v0
    v_sub_f32 v37, v37, v0
    v_sub_f32 v38, v38, v0
    v_sub_f32 v39, v39, v0
    v_sub_f32 v40, v40, v0
    v_sub_f32 v41, v41, v0
    v_sub_f32 v42, v42, v0
    v_sub_f32 v43, v43, v0
    v_sub_f32 v44, v44, v0
    v_sub_f32 v45, v45, v0
    v_sub_f32 v46, v46, v0
    v_sub_f32 v47, v47, v0
    v_exp_f32 v32, v32
    v_exp_f32 v33, v33
    v_exp_f32 v34, v34
    v_exp_f32 v35, v35
    v_exp_f32 v36, v36
    v_exp_f32 v37, v37
    v_exp_f32 v38, v38
    v_exp_f32 v39, v39
    v_exp_f32 v40, v40
    v_exp_f32 v41, v41
    v_exp_f32 v42, v42
    v_exp_f32 v43, v43
    v_exp_f32 v44, v44
    v_exp_f32 v45, v45
    v_exp_f32 v46, v46
    v_exp_f32 v47, v47
    v_cvt_pk_bf16_f32 v80, v32, v33
    v_cvt_pk_bf16_f32 v81, v34, v35
    v_cvt_pk_bf16_f32 v82, v36, v37
    v_cvt_pk_bf16_f32 v83, v38, v39
    v_cvt_pk_bf16_f32 v84, v40, v41
    v_cvt_pk_bf16_f32 v85, v42, v43
    v_cvt_pk_bf16_f32 v86, v44, v45
    v_cvt_pk_bf16_f32 v87, v46, v47
    v_mfma_f32_32x32x16_bf16 v[48:63], v[88:91], v[80:83], v[48:63]
    s_nop 0
    v_mfma_f32_32x32x16_bf16 v[48:63], v[92:95], v[84:87], v[48:63]
    v_mov_b32 v32, 0
    v_mov_b32 v33, 0
    v_mov_b32 v34, 0
    v_mov_b32 v35, 0
    v_mov_b32 v36, 0
    v_mov_b32 v37, 0
    v_mov_b32 v38, 0
    v_mov_b32 v39, 0
    v_mov_b32 v40, 0
    v_mov_b32 v41, 0
    v_mov_b32 v42, 0
    v_mov_b32 v43, 0
    v_mov_b32 v44, 0
    v_mov_b32 v45, 0
    v_mov_b32 v46, 0
    v_mov_b32 v47, 0
    v_add_u32 v21, s54, v21
    v_add_u32 v22, s54, v22
    s_sub_u32 s53, s53, 1
    s_cmp_lg_u32 s53, 0
    s_cbranch_scc1 Lfb_194
Lfbn_195:
    s_cmp_eq_u32 s36, 0
    s_cbranch_scc1 Lfbn_198
    s_lshl_b32 s47, s40, 10
    s_add_u32 s47, s47, s76
    v_add_u32 v21, s47, v2
    s_lshl_b32 s47, s40, 8
    v_xor_b32 v22, s47, v2
    v_add_u32 v22, s76, v22
    s_mov_b32 s53, s77
    s_mov_b32 s54, 4096
    s_cmp_eq_u32 s36, 1
    s_cbranch_scc1 Lfb_197
    v_mov_b32 v32, v112
    v_mov_b32 v33, v113
    v_mov_b32 v34, v114
    v_mov_b32 v35, v115
    v_mov_b32 v36, v116
    v_mov_b32 v37, v117
    v_mov_b32 v38, v118
    v_mov_b32 v39, v119
    v_mov_b32 v40, v120
    v_mov_b32 v41, v121
    v_mov_b32 v42, v122
    v_mov_b32 v43, v123
    v_mov_b32 v44, v124
    v_mov_b32 v45, v125
    v_mov_b32 v46, v126
    v_mov_b32 v47, v127
Lfb_197:
    ds_read_b128 v[76:79], v21
    s_mov_b64 exec, s[50:51]
    ds_read_b128 v[88:91], v22 offset:2048
    ds_read_b128 v[92:95], v22 offset:3072
    s_mov_b64 exec, -1
    s_waitcnt lgkmcnt(0)
    v_mfma_f32_32x32x16_bf16 v[32:47], v[76:79], v[72:75], v[32:47]
    s_nop 11
    v_sub_f32 v32, v32, v0
    v_sub_f32 v33, v33, v0
    v_sub_f32 v34, v34, v0
    v_sub_f32 v35, v35, v0
    v_sub_f32 v36, v36, v0
    v_sub_f32 v37, v37, v0
    v_sub_f32 v38, v38, v0
    v_sub_f32 v39, v39, v0
    v_sub_f32 v40, v40, v0
    v_sub_f32 v41, v41, v0
    v_sub_f32 v42, v42, v0
    v_sub_f32 v43, v43, v0
    v_sub_f32 v44, v44, v0
    v_sub_f32 v45, v45, v0
    v_sub_f32 v46, v46, v0
    v_sub_f32 v47, v47, v0
    v_exp_f32 v32, v32
    v_exp_f32 v33, v33
    v_exp_f32 v34, v34
    v_exp_f32 v35, v35
    v_exp_f32 v36, v36
    v_exp_f32 v37, v37
    v_exp_f32 v38, v38
    v_exp_f32 v39, v39
    v_exp_f32 v40, v40
    v_exp_f32 v41, v41
    v_exp_f32 v42, v42
    v_exp_f32 v43, v43
    v_exp_f32 v44, v44
    v_exp_f32 v45, v45
    v_exp_f32 v46, v46
    v_exp_f32 v47, v47
    v_cvt_pk_bf16_f32 v80, v32, v33
    v_cvt_pk_bf16_f32 v81, v34, v35
    v_cvt_pk_bf16_f32 v82, v36, v37
    v_cvt_pk_bf16_f32 v83, v38, v39
    v_cvt_pk_bf16_f32 v84, v40, v41
    v_cvt_pk_bf16_f32 v85, v42, v43
    v_cvt_pk_bf16_f32 v86, v44, v45
    v_cvt_pk_bf16_f32 v87, v46, v47
    v_mfma_f32_32x32x16_bf16 v[48:63], v[88:91], v[80:83], v[48:63]
    s_nop 0
    v_mfma_f32_32x32x16_bf16 v[48:63], v[92:95], v[84:87], v[48:63]
    v_mov_b32 v32, 0
    v_mov_b32 v33, 0
    v_mov_b32 v34, 0
    v_mov_b32 v35, 0
    v_mov_b32 v36, 0
    v_mov_b32 v37, 0
    v_mov_b32 v38, 0
    v_mov_b32 v39, 0
    v_mov_b32 v40, 0
    v_mov_b32 v41, 0
    v_mov_b32 v42, 0
    v_mov_b32 v43, 0
    v_mov_b32 v44, 0
    v_mov_b32 v45, 0
    v_mov_b32 v46, 0
    v_mov_b32 v47, 0
    v_add_u32 v21, s54, v21
    v_add_u32 v22, s54, v22
    s_sub_u32 s53, s53, 1
    s_cmp_lg_u32 s53, 0
    s_cbranch_scc1 Lfb_197
Lfbn_198:
    s_branch L_fbr_0
L_fb_2:
    s_waitcnt lgkmcnt(0)
    v_mov_b32 v0, 0xff800000
    v_mov_b32 v88, 0x3f803f80
    v_mov_b32 v89, v88
    v_mov_b32 v90, v88
    v_mov_b32 v91, v88
    v_mov_b32 v92, v88
    v_mov_b32 v93, v88
    v_mov_b32 v94, v88
    v_mov_b32 v95, v88
    v_subrev_f32 v96, 0x0, v27
    v_subrev_f32 v97, 0x71800000, v27
    v_subrev_f32 v98, 0x72000000, v27
    v_subrev_f32 v99, 0x72400000, v27
    v_subrev_f32 v100, 0x73000000, v27
    v_subrev_f32 v101, 0x73100000, v27
    v_subrev_f32 v102, 0x73200000, v27
    v_subrev_f32 v103, 0x73300000, v27
    v_subrev_f32 v104, 0x73800000, v27
    v_subrev_f32 v105, 0x73880000, v27
    v_subrev_f32 v106, 0x73900000, v27
    v_subrev_f32 v107, 0x73980000, v27
    v_subrev_f32 v108, 0x73c00000, v27
    v_subrev_f32 v109, 0x73c80000, v27
    v_subrev_f32 v110, 0x73d00000, v27
    v_subrev_f32 v111, 0x73d80000, v27
    v_min_f32 v96, 0, v96
    v_min_f32 v97, 0, v97
    v_min_f32 v98, 0, v98
    v_min_f32 v99, 0, v99
    v_min_f32 v100, 0, v100
    v_min_f32 v101, 0, v101
    v_min_f32 v102, 0, v102
    v_min_f32 v103, 0, v103
    v_min_f32 v104, 0, v104
    v_min_f32 v105, 0, v105
    v_min_f32 v106, 0, v106
    v_min_f32 v107, 0, v107
    v_min_f32 v108, 0, v108
    v_min_f32 v109, 0, v109
    v_min_f32 v110, 0, v110
    v_min_f32 v111, 0, v111
    v_mov_b32 v48, 0
    v_mov_b32 v49, 0
    v_mov_b32 v50, 0
    v_mov_b32 v51, 0
    v_mov_b32 v52, 0
    v_mov_b32 v53, 0
    v_mov_b32 v54, 0
    v_mov_b32 v55, 0
    v_mov_b32 v56, 0
    v_mov_b32 v57, 0
    v_mov_b32 v58, 0
    v_mov_b32 v59, 0
    v_mov_b32 v60, 0
    v_mov_b32 v61, 0
    v_mov_b32 v62, 0
    v_mov_b32 v63, 0
    v_sub_f32 v112, 0xf1800000, v27
    v_sub_f32 v113, 0x0, v27
    v_sub_f32 v114, 0x71800000, v27
    v_sub_f32 v115, 0x72000000, v27
    v_sub_f32 v116, 0x72e00000, v27
    v_sub_f32 v117, 0x73000000, v27
    v_sub_f32 v118, 0x73100000, v27
    v_sub_f32 v119, 0x73200000, v27
    v_sub_f32 v120, 0x73700000, v27
    v_sub_f32 v121, 0x73800000, v27
    v_sub_f32 v122, 0x73880000, v27
    v_sub_f32 v123, 0x73900000, v27
    v_sub_f32 v124, 0x73b80000, v27
    v_sub_f32 v125, 0x73c00000, v27
    v_sub_f32 v126, 0x73c80000, v27
    v_sub_f32 v127, 0x73d00000, v27
    v_min_f32 v112, 0, v112
    v_min_f32 v113, 0, v113
    v_min_f32 v114, 0, v114
    v_min_f32 v115, 0, v115
    v_min_f32 v116, 0, v116
    v_min_f32 v117, 0, v117
    v_min_f32 v118, 0, v118
    v_min_f32 v119, 0, v119
    v_min_f32 v120, 0, v120
    v_min_f32 v121, 0, v121
    v_min_f32 v122, 0, v122
    v_min_f32 v123, 0, v123
    v_min_f32 v124, 0, v124
    v_min_f32 v125, 0, v125
    v_min_f32 v126, 0, v126
    v_min_f32 v127, 0, v127
    s_lshl_b32 s47, s40, 10
    s_add_u32 s47, s47, s78
    v_add_u32 v21, s47, v2
    s_lshl_b32 s47, s40, 8
    v_xor_b32 v22, s47, v2
    v_add_u32 v22, s78, v22
    s_add_u32 s53, s42, 1
    s_mov_b32 s54, -6144
    v_mov_b32 v32, v96
    v_mov_b32 v33, v97
    v_mov_b32 v34, v98
    v_mov_b32 v35, v99
    v_mov_b32 v36, v100
    v_mov_b32 v37, v101
    v_mov_b32 v38, v102
    v_mov_b32 v39, v103
    v_mov_b32 v40, v104
    v_mov_b32 v41, v105
    v_mov_b32 v42, v106
    v_mov_b32 v43, v107
    v_mov_b32 v44, v108
    v_mov_b32 v45, v109
    v_mov_b32 v46, v110
    v_mov_b32 v47, v111
Lfb_200:
    ds_read_b128 v[76:79], v21
    s_waitcnt lgkmcnt(0)
    v_mfma_f32_32x32x16_bf16 v[32:47], v[76:79], v[72:75], v[32:47]
    s_nop 11
    v_max3_f32 v0, v0, v32, v33
    v_max3_f32 v0, v0, v34, v35
    v_max3_f32 v0, v0, v36, v37
    v_max3_f32 v0, v0, v38, v39
    v_max3_f32 v0, v0, v40, v41
    v_max3_f32 v0, v0, v42, v43
    v_max3_f32 v0, v0, v44, v45
    v_max3_f32 v0, v0, v46, v47
    v_mov_b32 v32, 0
    v_mov_b32 v33, 0
    v_mov_b32 v34, 0
    v_mov_b32 v35, 0
    v_mov_b32 v36, 0
    v_mov_b32 v37, 0
    v_mov_b32 v38, 0
    v_mov_b32 v39, 0
    v_mov_b32 v40, 0
    v_mov_b32 v41, 0
    v_mov_b32 v42, 0
    v_mov_b32 v43, 0
    v_mov_b32 v44, 0
    v_mov_b32 v45, 0
    v_mov_b32 v46, 0
    v_mov_b32 v47, 0
    v_add_u32 v21, s54, v21
    v_add_u32 v22, s54, v22
    s_sub_u32 s53, s53, 1
    s_cmp_lg_u32 s53, 0
    s_cbranch_scc1 Lfb_200
Lfbn_201:
    s_cmp_eq_u32 s36, 0
    s_cbranch_scc1 Lfbn_204
    s_lshl_b32 s47, s40, 10
    s_add_u32 s47, s47, s76
    v_add_u32 v21, s47, v2
    s_lshl_b32 s47, s40, 8
    v_xor_b32 v22, s47, v2
    v_add_u32 v22, s76, v22
    s_mov_b32 s53, s77
    s_mov_b32 s54, 4096
    s_cmp_eq_u32 s36, 1
    s_cbranch_scc1 Lfb_203
    v_mov_b32 v32, v112
    v_mov_b32 v33, v113
    v_mov_b32 v34, v114
    v_mov_b32 v35, v115
    v_mov_b32 v36, v116
    v_mov_b32 v37, v117
    v_mov_b32 v38, v118
    v_mov_b32 v39, v119
    v_mov_b32 v40, v120
    v_mov_b32 v41, v121
    v_mov_b32 v42, v122
    v_mov_b32 v43, v123
    v_mov_b32 v44, v124
    v_mov_b32 v45, v125
    v_mov_b32 v46, v126
    v_mov_b32 v47, v127
Lfb_203:
    ds_read_b128 v[76:79], v21
    s_waitcnt lgkmcnt(0)
    v_mfma_f32_32x32x16_bf16 v[32:47], v[76:79], v[72:75], v[32:47]
    s_nop 11
    v_max3_f32 v0, v0, v32, v33
    v_max3_f32 v0, v0, v34, v35
    v_max3_f32 v0, v0, v36, v37
    v_max3_f32 v0, v0, v38, v39
    v_max3_f32 v0, v0, v40, v41
    v_max3_f32 v0, v0, v42, v43
    v_max3_f32 v0, v0, v44, v45
    v_max3_f32 v0, v0, v46, v47
    v_mov_b32 v32, 0
    v_mov_b32 v33, 0
    v_mov_b32 v34, 0
    v_mov_b32 v35, 0
    v_mov_b32 v36, 0
    v_mov_b32 v37, 0
    v_mov_b32 v38, 0
    v_mov_b32 v39, 0
    v_mov_b32 v40, 0
    v_mov_b32 v41, 0
    v_mov_b32 v42, 0
    v_mov_b32 v43, 0
    v_mov_b32 v44, 0
    v_mov_b32 v45, 0
    v_mov_b32 v46, 0
    v_mov_b32 v47, 0
    v_add_u32 v21, s54, v21
    v_add_u32 v22, s54, v22
    s_sub_u32 s53, s53, 1
    s_cmp_lg_u32 s53, 0
    s_cbranch_scc1 Lfb_203
Lfbn_204:
    v_mov_b32 v23, v0
    s_nop 1
    v_permlane32_swap_b32 v23, v0
    v_max_f32 v0, v0, v23
    s_lshl_b32 s47, s40, 10
    s_add_u32 s47, s47, s78
    v_add_u32 v21, s47, v2
    s_lshl_b32 s47, s40, 8
    v_xor_b32 v22, s47, v2
    v_add_u32 v22, s78, v22
    s_add_u32 s53, s42, 1
    s_mov_b32 s54, -6144
    v_mov_b32 v32, v96
    v_mov_b32 v33, v97
    v_mov_b32 v34, v98
    v_mov_b32 v35, v99
    v_mov_b32 v36, v100
    v_mov_b32 v37, v101
    v_mov_b32 v38, v102
    v_mov_b32 v39, v103
    v_mov_b32 v40, v104
    v_mov_b32 v41, v105
    v_mov_b32 v42, v106
    v_mov_b32 v43, v107
    v_mov_b32 v44, v108
    v_mov_b32 v45, v109
    v_mov_b32 v46, v110
    v_mov_b32 v47, v111
Lfb_206:
    ds_read_b128 v[76:79], v21
    s_mov_b64 exec, s[50:51]
    ds_read_b128 v[88:91], v22 offset:2048
    ds_read_b128 v[92:95], v22 offset:3072
    s_mov_b64 exec, -1
    s_waitcnt lgkmcnt(0)
    v_mfma_f32_32x32x16_bf16 v[32:47], v[76:79], v[72:75], v[32:47]
    s_nop 11
    v_sub_f32 v32, v32, v0
    v_sub_f32 v33, v33, v0
    v_sub_f32 v34, v34, v0
    v_sub_f32 v35, v35, v0
    v_sub_f32 v36, v36, v0
    v_sub_f32 v37, v37, v0
    v_sub_f32 v38, v38, v0
    v_sub_f32 v39, v39, v0
    v_sub_f32 v40, v40, v0
    v_sub_f32 v41, v41, v0
    v_sub_f32 v42, v42, v0
    v_sub_f32 v43, v43, v0
    v_sub_f32 v44, v44, v0
    v_sub_f32 v45, v45, v0
    v_sub_f32 v46, v46, v0
    v_sub_f32 v47, v47, v0
    v_exp_f32 v32, v32
    v_exp_f32 v33, v33
    v_exp_f32 v34, v34
    v_exp_f32 v35, v35
    v_exp_f32 v36, v36
    v_exp_f32 v37, v37
    v_exp_f32 v38, v38
    v_exp_f32 v39, v39
    v_exp_f32 v40, v40
    v_exp_f32 v41, v41
    v_exp_f32 v42, v42
    v_exp_f32 v43, v43
    v_exp_f32 v44, v44
    v_exp_f32 v45, v45
    v_exp_f32 v46, v46
    v_exp_f32 v47, v47
    v_cvt_pk_bf16_f32 v80, v32, v33
    v_cvt_pk_bf16_f32 v81, v34, v35
    v_cvt_pk_bf16_f32 v82, v36, v37
    v_cvt_pk_bf16_f32 v83, v38, v39
    v_cvt_pk_bf16_f32 v84, v40, v41
    v_cvt_pk_bf16_f32 v85, v42, v43
    v_cvt_pk_bf16_f32 v86, v44, v45
    v_cvt_pk_bf16_f32 v87, v46, v47
    v_mfma_f32_32x32x16_bf16 v[48:63], v[88:91], v[80:83], v[48:63]
    s_nop 0
    v_mfma_f32_32x32x16_bf16 v[48:63], v[92:95], v[84:87], v[48:63]
    v_mov_b32 v32, 0
    v_mov_b32 v33, 0
    v_mov_b32 v34, 0
    v_mov_b32 v35, 0
    v_mov_b32 v36, 0
    v_mov_b32 v37, 0
    v_mov_b32 v38, 0
    v_mov_b32 v39, 0
    v_mov_b32 v40, 0
    v_mov_b32 v41, 0
    v_mov_b32 v42, 0
    v_mov_b32 v43, 0
    v_mov_b32 v44, 0
    v_mov_b32 v45, 0
    v_mov_b32 v46, 0
    v_mov_b32 v47, 0
    v_add_u32 v21, s54, v21
    v_add_u32 v22, s54, v22
    s_sub_u32 s53, s53, 1
    s_cmp_lg_u32 s53, 0
    s_cbranch_scc1 Lfb_206
Lfbn_207:
    s_cmp_eq_u32 s36, 0
    s_cbranch_scc1 Lfbn_210
    s_lshl_b32 s47, s40, 10
    s_add_u32 s47, s47, s76
    v_add_u32 v21, s47, v2
    s_lshl_b32 s47, s40, 8
    v_xor_b32 v22, s47, v2
    v_add_u32 v22, s76, v22
    s_mov_b32 s53, s77
    s_mov_b32 s54, 4096
    s_cmp_eq_u32 s36, 1
    s_cbranch_scc1 Lfb_209
    v_mov_b32 v32, v112
    v_mov_b32 v33, v113
    v_mov_b32 v34, v114
    v_mov_b32 v35, v115
    v_mov_b32 v36, v116
    v_mov_b32 v37, v117
    v_mov_b32 v38, v118
    v_mov_b32 v39, v119
    v_mov_b32 v40, v120
    v_mov_b32 v41, v121
    v_mov_b32 v42, v122
    v_mov_b32 v43, v123
    v_mov_b32 v44, v124
    v_mov_b32 v45, v125
    v_mov_b32 v46, v126
    v_mov_b32 v47, v127
Lfb_209:
    ds_read_b128 v[76:79], v21
    s_mov_b64 exec, s[50:51]
    ds_read_b128 v[88:91], v22 offset:2048
    ds_read_b128 v[92:95], v22 offset:3072
    s_mov_b64 exec, -1
    s_waitcnt lgkmcnt(0)
    v_mfma_f32_32x32x16_bf16 v[32:47], v[76:79], v[72:75], v[32:47]
    s_nop 11
    v_sub_f32 v32, v32, v0
    v_sub_f32 v33, v33, v0
    v_sub_f32 v34, v34, v0
    v_sub_f32 v35, v35, v0
    v_sub_f32 v36, v36, v0
    v_sub_f32 v37, v37, v0
    v_sub_f32 v38, v38, v0
    v_sub_f32 v39, v39, v0
    v_sub_f32 v40, v40, v0
    v_sub_f32 v41, v41, v0
    v_sub_f32 v42, v42, v0
    v_sub_f32 v43, v43, v0
    v_sub_f32 v44, v44, v0
    v_sub_f32 v45, v45, v0
    v_sub_f32 v46, v46, v0
    v_sub_f32 v47, v47, v0
    v_exp_f32 v32, v32
    v_exp_f32 v33, v33
    v_exp_f32 v34, v34
    v_exp_f32 v35, v35
    v_exp_f32 v36, v36
    v_exp_f32 v37, v37
    v_exp_f32 v38, v38
    v_exp_f32 v39, v39
    v_exp_f32 v40, v40
    v_exp_f32 v41, v41
    v_exp_f32 v42, v42
    v_exp_f32 v43, v43
    v_exp_f32 v44, v44
    v_exp_f32 v45, v45
    v_exp_f32 v46, v46
    v_exp_f32 v47, v47
    v_cvt_pk_bf16_f32 v80, v32, v33
    v_cvt_pk_bf16_f32 v81, v34, v35
    v_cvt_pk_bf16_f32 v82, v36, v37
    v_cvt_pk_bf16_f32 v83, v38, v39
    v_cvt_pk_bf16_f32 v84, v40, v41
    v_cvt_pk_bf16_f32 v85, v42, v43
    v_cvt_pk_bf16_f32 v86, v44, v45
    v_cvt_pk_bf16_f32 v87, v46, v47
    v_mfma_f32_32x32x16_bf16 v[48:63], v[88:91], v[80:83], v[48:63]
    s_nop 0
    v_mfma_f32_32x32x16_bf16 v[48:63], v[92:95], v[84:87], v[48:63]
    v_mov_b32 v32, 0
    v_mov_b32 v33, 0
    v_mov_b32 v34, 0
    v_mov_b32 v35, 0
    v_mov_b32 v36, 0
    v_mov_b32 v37, 0
    v_mov_b32 v38, 0
    v_mov_b32 v39, 0
    v_mov_b32 v40, 0
    v_mov_b32 v41, 0
    v_mov_b32 v42, 0
    v_mov_b32 v43, 0
    v_mov_b32 v44, 0
    v_mov_b32 v45, 0
    v_mov_b32 v46, 0
    v_mov_b32 v47, 0
    v_add_u32 v21, s54, v21
    v_add_u32 v22, s54, v22
    s_sub_u32 s53, s53, 1
    s_cmp_lg_u32 s53, 0
    s_cbranch_scc1 Lfb_209
Lfbn_210:
    s_branch L_fbr_2
.section .rodata,"a"
.p2align 6
.amdhsa_kernel interleave_layers__sliding_block__linear_kernel_hedgehog__prompt_kernel
  .amdhsa_next_free_vgpr 256
  .amdhsa_next_free_sgpr 102
  .amdhsa_accum_offset 256
  .amdhsa_group_segment_fixed_size 0
  .amdhsa_kernarg_size 80
  .amdhsa_user_sgpr_count 2
  .amdhsa_user_sgpr_kernarg_segment_ptr 1
  .amdhsa_system_sgpr_workgroup_id_x 1
.end_amdhsa_kernel
```
